```python
import torch

def _softmax(x, axis=-1):
    return torch.softmax(x, dim=axis)

def _gelu(x):
    return torch.nn.functional.gelu(x, approximate='tanh')

def _silu(x):
    return torch.nn.functional.silu(x)

def _sigmoid(x):
    return torch.sigmoid(x)

def _layernorm(x, axis=-1, eps=1e-05):
    m = x.mean(dim=axis, keepdim=True)
    v = x.var(dim=axis, keepdim=True, unbiased=False)
    return (x - m) / torch.sqrt(v + eps)

def _scatter_add(tgt, idx, src, axis=0):
    return tgt.clone().index_add_(axis, idx, src)

def _segment_sum(src, seg, n):
    out = torch.zeros((n,) + src.shape[1:], dtype=src.dtype)
    return out.index_add_(0, seg, src)

def _pad(x, pw):
    flat = tuple((v for pair in reversed(pw) for v in pair))
    return torch.nn.functional.pad(x, flat)
kernel_name = 'gated_mix__memory_aug_recurrent_mem_tr__moe_arch_mod__prompt'

def setup_inputs():

    _w = lambda a: (lambda t: t.to(torch.bfloat16) if t.is_floating_point() else t)(torch.as_tensor(a))

    def _A_setup():
        B, S, Dm = (1, 2048, 640)
        H, Dh = (32, 192)
        M, seg = (8, 32)
        seg = min(seg, S)
        S = S // seg * seg
        return {'x': _w((lambda *s: torch.randn(*s, dtype=torch.bfloat16) * 0.05)(B, S, Dm)), 'mem0': _w((lambda *s: torch.randn(*s, dtype=torch.bfloat16) * 0.8)(B, M, Dm)), 'Wq': _w((lambda *s: torch.randn(*s, dtype=torch.bfloat16) * 3.2)(Dm, H, Dh) * Dm ** (-0.5)), 'Wk': _w((lambda *s: torch.randn(*s, dtype=torch.bfloat16) * 3.2)(Dm, H, Dh) * Dm ** (-0.5)), 'Wv': _w((lambda *s: torch.randn(*s, dtype=torch.bfloat16) * 0.8)(Dm, H, Dh) * Dm ** (-0.5)), 'Wo': _w((lambda *s: torch.randn(*s, dtype=torch.bfloat16) * 0.8)(H, Dh, Dm) * (H * Dh) ** (-0.5)), 'seg_len': seg}
    _A_in = _A_setup()

    def _B_setup():
        B, S, D, F, C = (1, 2048, 640, 1536, 8)
        return {'x': _w((lambda *s: torch.randn(*s, dtype=torch.bfloat16) * 0.05)(B, S, D)), 'w_r': _w((lambda *s: torch.randn(*s, dtype=torch.bfloat16) * 1.6)(D)), 'w_gate': _w((lambda *s: torch.randn(*s, dtype=torch.bfloat16) * 0.2)(D, F)), 'w_up': _w((lambda *s: torch.randn(*s, dtype=torch.bfloat16) * 0.2)(D, F)), 'w_down': _w((lambda *s: torch.randn(*s, dtype=torch.bfloat16) * 0.2)(F, D))}
    _B_in = _B_setup()
    return {'A_x': _A_in['x'], 'A_mem0': _A_in['mem0'], 'A_Wq': _A_in['Wq'], 'A_Wk': _A_in['Wk'], 'A_Wv': _A_in['Wv'], 'A_Wo': _A_in['Wo'], 'A_seg_len': _A_in['seg_len'], 'B_x': _B_in['x'], 'B_w_r': _B_in['w_r'], 'B_w_gate': _B_in['w_gate'], 'B_w_up': _B_in['w_up'], 'B_w_down': _B_in['w_down'], 'gate_w': _w((lambda *s: torch.randn(*s, dtype=torch.bfloat16) * 0.05)(640) * 16.0)}

def reference(A_x, A_mem0, A_Wq, A_Wk, A_Wv, A_Wo, A_seg_len, B_x, B_w_r, B_w_gate, B_w_up, B_w_down, gate_w):

    def _A_ref(x, mem0, Wq, Wk, Wv, Wo, seg_len):
        B, S, Dm = x.shape
        H, Dh = (Wq.shape[1], Wq.shape[2])
        M = mem0.shape[1]
        scale = Dh ** (-0.5)
        n_seg = S // seg_len
        L = M + seg_len
        idx = torch.arange(L)
        mask = (idx[:, None] < M) | (idx[:, None] >= idx[None, :])
        mem = mem0
        outs = []
        for s in range(n_seg):
            xs = x[:, s * seg_len:(s + 1) * seg_len, :].clone()
            h = torch.concatenate([mem, xs], axis=1)
            q = torch.einsum('btd,dhe->bhte', h, Wq)
            k = torch.einsum('btd,dhe->bhte', h, Wk)
            v = torch.einsum('btd,dhe->bhte', h, Wv)
            scores = torch.einsum('bhqe,bhke->bhqk', q, k) * scale
            scores = torch.where(mask[None, None], scores, -1000000000.0)
            p = _softmax(scores, axis=-1)
            o = torch.einsum('bhqk,bhke->bhqe', p, v)
            o = torch.einsum('bhte,hed->btd', o, Wo)
            mem = o[:, :M, :].clone()
            outs.append(o[:, M:, :])
        return torch.concatenate(outs, axis=1)

    def _B_ref(x, w_r, w_gate, w_up, w_down):
        B, S, D = x.shape
        C = 8
        r = x @ w_r
        idx = torch.argsort(-r, axis=-1)[:, :C]
        idx_e = (lambda x, n, axis: torch.repeat_interleave(x, n, dim=axis))(idx.reshape(B, C, 1), D, axis=2)
        x_sel = (lambda x, i, axis: torch.take_along_dim(x, i, dim=axis))(x, idx_e, axis=1)
        g = _silu(x_sel @ w_gate)
        u = x_sel @ w_up
        y = g * u @ w_down
        r_sel = _sigmoid((lambda x, i, axis: torch.take_along_dim(x, i, dim=axis))(r, idx, axis=1))
        y = y * r_sel.reshape(B, C, 1)
        b_off = (torch.arange(B) * S).reshape(B, 1)
        flat_idx = (idx + b_off).reshape(B * C)
        zero = (x * 0.0).reshape(B * S, D)
        upd = _scatter_add(zero, flat_idx, y.reshape(B * C, D), axis=0)
        return x + upd.reshape(B, S, D)
    x = A_x
    g = _sigmoid((x * gate_w).sum(-1, keepdims=True))
    a = _A_ref(x, A_mem0, A_Wq, A_Wk, A_Wv, A_Wo, A_seg_len)
    b = _B_ref(x, B_w_r, B_w_gate, B_w_up, B_w_down)
    return g * a + (1 - g) * b
```

```asm
; @launch grid=(256,1,1) block=(256,1,1) lds=163840
.amdgcn_target "amdgcn-amd-amdhsa--gfx950"
.text
.globl gated_mix__memory_aug_recurrent_mem_tr__moe_arch_mod__prompt_kernel
.p2align 8
.type gated_mix__memory_aug_recurrent_mem_tr__moe_arch_mod__prompt_kernel,@function
gated_mix__memory_aug_recurrent_mem_tr__moe_arch_mod__prompt_kernel:

    s_cmp_ge_u32 s2, 256
    s_cbranch_scc1 L_end
    s_load_dwordx2 s[4:5], s[0:1], 120
    s_load_dwordx2 s[8:9], s[0:1], 112
    v_lshrrev_b32 v1, 6, v0
    s_mov_b32 s6, 192937984
    s_mov_b32 s7, 0x20000
    v_readfirstlane_b32 s12, v1
    s_mov_b32 s10, 256
    s_mov_b32 s11, 0x20000
    v_and_b32 v1, 63, v0
    s_getreg_b32 s32, hwreg(HW_REG_XCC_ID, 2, 1)
    s_waitcnt lgkmcnt(0)
    s_add_u32 s4, s4, 0x1fffff
    s_addc_u32 s5, s5, 0
    s_and_b32 s4, s4, 0xffe00000
    s_cmp_lg_u32 s12, 0
    s_cbranch_scc1 L_tk_wait
    s_lshl_b32 s33, s32, 2
    v_mov_b32 v2, s33
    v_mov_b32 v3, 1
    s_mov_b64 exec, 1
    buffer_atomic_add v3, v2, s[8:11], 0 offen sc0 sc1
    s_waitcnt vmcnt(0)
    v_mov_b32 v4, 0
    ds_write_b32 v4, v3
    s_waitcnt lgkmcnt(0)
    s_mov_b64 exec, -1
L_tk_wait:
    s_barrier
    v_mov_b32 v4, 0
    ds_read_b32 v3, v4
    s_waitcnt lgkmcnt(0)
    v_readfirstlane_b32 s13, v3
    s_sub_u32 s33, 255, s13
    s_cmp_eq_u32 s32, 0
    s_cselect_b32 s13, s13, s33
    s_mov_b32 s3, s13
    s_barrier
    s_cmp_ge_u32 s13, 128
    s_cbranch_scc1 L_bulk
    s_mov_b32 s14, s13
    s_cmp_lt_u32 s13, 40
    s_cbranch_scc1 L_r
    s_sub_u32 s14, s13, 40
    s_cmp_lt_u32 s13, 64
    s_cbranch_scc1 L_x
    s_sub_u32 s14, s13, 96
    s_cmp_ge_u32 s13, 96
    s_cbranch_scc1 L_cv
    s_sub_u32 s14, s13, 64
    s_load_dwordx2 s[16:17], s[0:1], 16
    s_mov_b32 s18, 7864320
    s_mov_b32 s19, 0x20000
    s_load_dwordx2 s[20:21], s[0:1], 24
    s_mov_b32 s22, 7864320
    s_mov_b32 s23, 0x20000
    v_add_u32 v16, 0, v1
    v_mul_u32_u24 v17, 2731, v16
    v_lshrrev_b32 v17, 16, v17
    v_mul_u32_u24 v18, 24, v17
    v_sub_u32 v16, v16, v18
    v_lshlrev_b32 v16, 4, v16
    v_mul_u32_u24 v17, 12288, v17
    v_add_u32 v4, v16, v17
    v_add_u32 v16, 64, v1
    v_mul_u32_u24 v17, 2731, v16
    v_lshrrev_b32 v17, 16, v17
    v_mul_u32_u24 v18, 24, v17
    v_sub_u32 v16, v16, v18
    v_lshlrev_b32 v16, 4, v16
    v_mul_u32_u24 v17, 12288, v17
    v_add_u32 v5, v16, v17
    v_add_u32 v16, 128, v1
    v_mul_u32_u24 v17, 2731, v16
    v_lshrrev_b32 v17, 16, v17
    v_mul_u32_u24 v18, 24, v17
    v_sub_u32 v16, v16, v18
    v_lshlrev_b32 v16, 4, v16
    v_mul_u32_u24 v17, 12288, v17
    v_add_u32 v6, v16, v17
    v_lshrrev_b32 v16, 4, v1
    v_lshlrev_b32 v16, 3, v16
    v_bfe_u32 v17, v1, 2, 2
    v_add_u32 v16, v16, v17
    v_mul_u32_u24 v16, 384, v16
    v_and_b32 v17, 3, v1
    v_lshlrev_b32 v17, 3, v17
    s_mul_i32 s32, s12, 96
    v_add3_u32 v7, v16, v17, s32
    s_mul_i32 s40, s14, 384
    s_mul_i32 s32, s12, 196608
    s_add_u32 s40, s40, s32
    s_mul_i32 s41, s12, 6144
    s_waitcnt lgkmcnt(0)
    s_add_u32 m0, s41, 0
    s_add_u32 s37, s40, 0
    buffer_load_dwordx4 v4, s[16:19], s37 offen lds
    s_add_u32 m0, s41, 1024
    s_add_u32 s37, s40, 0
    buffer_load_dwordx4 v5, s[16:19], s37 offen lds
    s_add_u32 m0, s41, 2048
    s_add_u32 s37, s40, 0
    buffer_load_dwordx4 v6, s[16:19], s37 offen lds
    s_add_u32 m0, s41, 3072
    s_add_u32 s37, s40, 98304
    buffer_load_dwordx4 v4, s[16:19], s37 offen lds
    s_add_u32 m0, s41, 4096
    s_add_u32 s37, s40, 98304
    buffer_load_dwordx4 v5, s[16:19], s37 offen lds
    s_add_u32 m0, s41, 5120
    s_add_u32 s37, s40, 98304
    buffer_load_dwordx4 v6, s[16:19], s37 offen lds
    s_add_u32 m0, s41, 24576
    s_add_u32 s37, s40, 0
    buffer_load_dwordx4 v4, s[20:23], s37 offen lds
    s_add_u32 m0, s41, 25600
    s_add_u32 s37, s40, 0
    buffer_load_dwordx4 v5, s[20:23], s37 offen lds
    s_add_u32 m0, s41, 26624
    s_add_u32 s37, s40, 0
    buffer_load_dwordx4 v6, s[20:23], s37 offen lds
    s_add_u32 m0, s41, 27648
    s_add_u32 s37, s40, 98304
    buffer_load_dwordx4 v4, s[20:23], s37 offen lds
    s_add_u32 m0, s41, 28672
    s_add_u32 s37, s40, 98304
    buffer_load_dwordx4 v5, s[20:23], s37 offen lds
    s_add_u32 m0, s41, 29696
    s_add_u32 s37, s40, 98304
    buffer_load_dwordx4 v6, s[20:23], s37 offen lds
    s_add_u32 m0, s41, 49152
    s_add_u32 s37, s40, 786432
    buffer_load_dwordx4 v4, s[16:19], s37 offen lds
    s_add_u32 m0, s41, 50176
    s_add_u32 s37, s40, 786432
    buffer_load_dwordx4 v5, s[16:19], s37 offen lds
    s_add_u32 m0, s41, 51200
    s_add_u32 s37, s40, 786432
    buffer_load_dwordx4 v6, s[16:19], s37 offen lds
    s_add_u32 m0, s41, 52224
    s_add_u32 s37, s40, 884736
    buffer_load_dwordx4 v4, s[16:19], s37 offen lds
    s_add_u32 m0, s41, 53248
    s_add_u32 s37, s40, 884736
    buffer_load_dwordx4 v5, s[16:19], s37 offen lds
    s_add_u32 m0, s41, 54272
    s_add_u32 s37, s40, 884736
    buffer_load_dwordx4 v6, s[16:19], s37 offen lds
    s_add_u32 m0, s41, 73728
    s_add_u32 s37, s40, 786432
    buffer_load_dwordx4 v4, s[20:23], s37 offen lds
    s_add_u32 m0, s41, 74752
    s_add_u32 s37, s40, 786432
    buffer_load_dwordx4 v5, s[20:23], s37 offen lds
    s_add_u32 m0, s41, 75776
    s_add_u32 s37, s40, 786432
    buffer_load_dwordx4 v6, s[20:23], s37 offen lds
    s_add_u32 m0, s41, 76800
    s_add_u32 s37, s40, 884736
    buffer_load_dwordx4 v4, s[20:23], s37 offen lds
    s_add_u32 m0, s41, 77824
    s_add_u32 s37, s40, 884736
    buffer_load_dwordx4 v5, s[20:23], s37 offen lds
    s_add_u32 m0, s41, 78848
    s_add_u32 s37, s40, 884736
    buffer_load_dwordx4 v6, s[20:23], s37 offen lds
    s_add_u32 m0, s41, 98304
    s_add_u32 s37, s40, 1572864
    buffer_load_dwordx4 v4, s[16:19], s37 offen lds
    s_add_u32 m0, s41, 99328
    s_add_u32 s37, s40, 1572864
    buffer_load_dwordx4 v5, s[16:19], s37 offen lds
    s_add_u32 m0, s41, 100352
    s_add_u32 s37, s40, 1572864
    buffer_load_dwordx4 v6, s[16:19], s37 offen lds
    s_add_u32 m0, s41, 101376
    s_add_u32 s37, s40, 1671168
    buffer_load_dwordx4 v4, s[16:19], s37 offen lds
    s_add_u32 m0, s41, 102400
    s_add_u32 s37, s40, 1671168
    buffer_load_dwordx4 v5, s[16:19], s37 offen lds
    s_add_u32 m0, s41, 103424
    s_add_u32 s37, s40, 1671168
    buffer_load_dwordx4 v6, s[16:19], s37 offen lds
    s_add_u32 m0, s41, 122880
    s_add_u32 s37, s40, 1572864
    buffer_load_dwordx4 v4, s[20:23], s37 offen lds
    s_add_u32 m0, s41, 123904
    s_add_u32 s37, s40, 1572864
    buffer_load_dwordx4 v5, s[20:23], s37 offen lds
    s_add_u32 m0, s41, 124928
    s_add_u32 s37, s40, 1572864
    buffer_load_dwordx4 v6, s[20:23], s37 offen lds
    s_add_u32 m0, s41, 125952
    s_add_u32 s37, s40, 1671168
    buffer_load_dwordx4 v4, s[20:23], s37 offen lds
    s_add_u32 m0, s41, 126976
    s_add_u32 s37, s40, 1671168
    buffer_load_dwordx4 v5, s[20:23], s37 offen lds
    s_add_u32 m0, s41, 128000
    s_add_u32 s37, s40, 1671168
    buffer_load_dwordx4 v6, s[20:23], s37 offen lds
    s_waitcnt vmcnt(30)
    s_barrier
    v_add_u32 v3, 0, v7
    ds_read_b64_tr_b16 a[0:1], v3 offset:0
    ds_read_b64_tr_b16 a[2:3], v3 offset:1536
    ds_read_b64_tr_b16 a[4:5], v3 offset:12288
    ds_read_b64_tr_b16 a[6:7], v3 offset:13824
    ds_read_b64_tr_b16 a[8:9], v3 offset:32
    ds_read_b64_tr_b16 a[10:11], v3 offset:1568
    ds_read_b64_tr_b16 a[12:13], v3 offset:12320
    ds_read_b64_tr_b16 a[14:15], v3 offset:13856
    ds_read_b64_tr_b16 a[16:17], v3 offset:64
    ds_read_b64_tr_b16 a[18:19], v3 offset:1600
    ds_read_b64_tr_b16 a[20:21], v3 offset:12352
    ds_read_b64_tr_b16 a[22:23], v3 offset:13888
    s_waitcnt lgkmcnt(0)
    s_waitcnt vmcnt(24)
    s_barrier
    v_add_u32 v3, 24576, v7
    ds_read_b64_tr_b16 v[96:97], v3 offset:0
    ds_read_b64_tr_b16 v[98:99], v3 offset:1536
    ds_read_b64_tr_b16 v[100:101], v3 offset:12288
    ds_read_b64_tr_b16 v[102:103], v3 offset:13824
    ds_read_b64_tr_b16 a[224:225], v3 offset:32
    ds_read_b64_tr_b16 a[226:227], v3 offset:1568
    ds_read_b64_tr_b16 a[228:229], v3 offset:12320
    ds_read_b64_tr_b16 a[230:231], v3 offset:13856
    ds_read_b64_tr_b16 v[176:177], v3 offset:64
    ds_read_b64_tr_b16 v[178:179], v3 offset:1600
    ds_read_b64_tr_b16 v[180:181], v3 offset:12352
    ds_read_b64_tr_b16 v[182:183], v3 offset:13888
    s_add_u32 m0, s41, 0
    s_add_u32 s37, s40, 2359296
    buffer_load_dwordx4 v4, s[16:19], s37 offen lds
    s_add_u32 m0, s41, 1024
    s_add_u32 s37, s40, 2359296
    buffer_load_dwordx4 v5, s[16:19], s37 offen lds
    s_add_u32 m0, s41, 2048
    s_add_u32 s37, s40, 2359296
    buffer_load_dwordx4 v6, s[16:19], s37 offen lds
    s_add_u32 m0, s41, 3072
    s_add_u32 s37, s40, 2457600
    buffer_load_dwordx4 v4, s[16:19], s37 offen lds
    s_add_u32 m0, s41, 4096
    s_add_u32 s37, s40, 2457600
    buffer_load_dwordx4 v5, s[16:19], s37 offen lds
    s_add_u32 m0, s41, 5120
    s_add_u32 s37, s40, 2457600
    buffer_load_dwordx4 v6, s[16:19], s37 offen lds
    s_waitcnt lgkmcnt(0)
    s_waitcnt vmcnt(24)
    s_barrier
    v_add_u32 v3, 49152, v7
    ds_read_b64_tr_b16 a[24:25], v3 offset:0
    ds_read_b64_tr_b16 a[26:27], v3 offset:1536
    ds_read_b64_tr_b16 a[28:29], v3 offset:12288
    ds_read_b64_tr_b16 a[30:31], v3 offset:13824
    ds_read_b64_tr_b16 a[32:33], v3 offset:32
    ds_read_b64_tr_b16 a[34:35], v3 offset:1568
    ds_read_b64_tr_b16 a[36:37], v3 offset:12320
    ds_read_b64_tr_b16 a[38:39], v3 offset:13856
    ds_read_b64_tr_b16 v[16:17], v3 offset:64
    ds_read_b64_tr_b16 v[18:19], v3 offset:1600
    ds_read_b64_tr_b16 v[20:21], v3 offset:12352
    ds_read_b64_tr_b16 v[22:23], v3 offset:13888
    s_add_u32 m0, s41, 24576
    s_add_u32 s37, s40, 2359296
    buffer_load_dwordx4 v4, s[20:23], s37 offen lds
    s_add_u32 m0, s41, 25600
    s_add_u32 s37, s40, 2359296
    buffer_load_dwordx4 v5, s[20:23], s37 offen lds
    s_add_u32 m0, s41, 26624
    s_add_u32 s37, s40, 2359296
    buffer_load_dwordx4 v6, s[20:23], s37 offen lds
    s_add_u32 m0, s41, 27648
    s_add_u32 s37, s40, 2457600
    buffer_load_dwordx4 v4, s[20:23], s37 offen lds
    s_add_u32 m0, s41, 28672
    s_add_u32 s37, s40, 2457600
    buffer_load_dwordx4 v5, s[20:23], s37 offen lds
    s_add_u32 m0, s41, 29696
    s_add_u32 s37, s40, 2457600
    buffer_load_dwordx4 v6, s[20:23], s37 offen lds
    s_waitcnt lgkmcnt(0)
    s_waitcnt vmcnt(24)
    s_barrier
    v_add_u32 v3, 73728, v7
    ds_read_b64_tr_b16 a[160:161], v3 offset:0
    ds_read_b64_tr_b16 a[162:163], v3 offset:1536
    ds_read_b64_tr_b16 a[164:165], v3 offset:12288
    ds_read_b64_tr_b16 a[166:167], v3 offset:13824
    ds_read_b64_tr_b16 a[232:233], v3 offset:32
    ds_read_b64_tr_b16 a[234:235], v3 offset:1568
    ds_read_b64_tr_b16 a[236:237], v3 offset:12320
    ds_read_b64_tr_b16 a[238:239], v3 offset:13856
    ds_read_b64_tr_b16 v[184:185], v3 offset:64
    ds_read_b64_tr_b16 v[186:187], v3 offset:1600
    ds_read_b64_tr_b16 v[188:189], v3 offset:12352
    ds_read_b64_tr_b16 v[190:191], v3 offset:13888
    s_add_u32 m0, s41, 49152
    s_add_u32 s37, s40, 3145728
    buffer_load_dwordx4 v4, s[16:19], s37 offen lds
    s_add_u32 m0, s41, 50176
    s_add_u32 s37, s40, 3145728
    buffer_load_dwordx4 v5, s[16:19], s37 offen lds
    s_add_u32 m0, s41, 51200
    s_add_u32 s37, s40, 3145728
    buffer_load_dwordx4 v6, s[16:19], s37 offen lds
    s_add_u32 m0, s41, 52224
    s_add_u32 s37, s40, 3244032
    buffer_load_dwordx4 v4, s[16:19], s37 offen lds
    s_add_u32 m0, s41, 53248
    s_add_u32 s37, s40, 3244032
    buffer_load_dwordx4 v5, s[16:19], s37 offen lds
    s_add_u32 m0, s41, 54272
    s_add_u32 s37, s40, 3244032
    buffer_load_dwordx4 v6, s[16:19], s37 offen lds
    s_waitcnt lgkmcnt(0)
    s_waitcnt vmcnt(24)
    s_barrier
    v_add_u32 v3, 98304, v7
    ds_read_b64_tr_b16 a[40:41], v3 offset:0
    ds_read_b64_tr_b16 a[42:43], v3 offset:1536
    ds_read_b64_tr_b16 a[44:45], v3 offset:12288
    ds_read_b64_tr_b16 a[46:47], v3 offset:13824
    ds_read_b64_tr_b16 v[24:25], v3 offset:32
    ds_read_b64_tr_b16 v[26:27], v3 offset:1568
    ds_read_b64_tr_b16 v[28:29], v3 offset:12320
    ds_read_b64_tr_b16 v[30:31], v3 offset:13856
    ds_read_b64_tr_b16 a[48:49], v3 offset:64
    ds_read_b64_tr_b16 a[50:51], v3 offset:1600
    ds_read_b64_tr_b16 a[52:53], v3 offset:12352
    ds_read_b64_tr_b16 a[54:55], v3 offset:13888
    s_add_u32 m0, s41, 73728
    s_add_u32 s37, s40, 3145728
    buffer_load_dwordx4 v4, s[20:23], s37 offen lds
    s_add_u32 m0, s41, 74752
    s_add_u32 s37, s40, 3145728
    buffer_load_dwordx4 v5, s[20:23], s37 offen lds
    s_add_u32 m0, s41, 75776
    s_add_u32 s37, s40, 3145728
    buffer_load_dwordx4 v6, s[20:23], s37 offen lds
    s_add_u32 m0, s41, 76800
    s_add_u32 s37, s40, 3244032
    buffer_load_dwordx4 v4, s[20:23], s37 offen lds
    s_add_u32 m0, s41, 77824
    s_add_u32 s37, s40, 3244032
    buffer_load_dwordx4 v5, s[20:23], s37 offen lds
    s_add_u32 m0, s41, 78848
    s_add_u32 s37, s40, 3244032
    buffer_load_dwordx4 v6, s[20:23], s37 offen lds
    s_waitcnt lgkmcnt(0)
    s_waitcnt vmcnt(24)
    s_barrier
    v_add_u32 v3, 122880, v7
    ds_read_b64_tr_b16 a[168:169], v3 offset:0
    ds_read_b64_tr_b16 a[170:171], v3 offset:1536
    ds_read_b64_tr_b16 a[172:173], v3 offset:12288
    ds_read_b64_tr_b16 a[174:175], v3 offset:13824
    ds_read_b64_tr_b16 a[240:241], v3 offset:32
    ds_read_b64_tr_b16 a[242:243], v3 offset:1568
    ds_read_b64_tr_b16 a[244:245], v3 offset:12320
    ds_read_b64_tr_b16 a[246:247], v3 offset:13856
    ds_read_b64_tr_b16 v[192:193], v3 offset:64
    ds_read_b64_tr_b16 v[194:195], v3 offset:1600
    ds_read_b64_tr_b16 v[196:197], v3 offset:12352
    ds_read_b64_tr_b16 v[198:199], v3 offset:13888
    s_add_u32 m0, s41, 98304
    s_add_u32 s37, s40, 3932160
    buffer_load_dwordx4 v4, s[16:19], s37 offen lds
    s_add_u32 m0, s41, 99328
    s_add_u32 s37, s40, 3932160
    buffer_load_dwordx4 v5, s[16:19], s37 offen lds
    s_add_u32 m0, s41, 100352
    s_add_u32 s37, s40, 3932160
    buffer_load_dwordx4 v6, s[16:19], s37 offen lds
    s_add_u32 m0, s41, 101376
    s_add_u32 s37, s40, 4030464
    buffer_load_dwordx4 v4, s[16:19], s37 offen lds
    s_add_u32 m0, s41, 102400
    s_add_u32 s37, s40, 4030464
    buffer_load_dwordx4 v5, s[16:19], s37 offen lds
    s_add_u32 m0, s41, 103424
    s_add_u32 s37, s40, 4030464
    buffer_load_dwordx4 v6, s[16:19], s37 offen lds
    s_waitcnt lgkmcnt(0)
    s_waitcnt vmcnt(24)
    s_barrier
    v_add_u32 v3, 0, v7
    ds_read_b64_tr_b16 a[56:57], v3 offset:0
    ds_read_b64_tr_b16 a[58:59], v3 offset:1536
    ds_read_b64_tr_b16 a[60:61], v3 offset:12288
    ds_read_b64_tr_b16 a[62:63], v3 offset:13824
    ds_read_b64_tr_b16 v[32:33], v3 offset:32
    ds_read_b64_tr_b16 v[34:35], v3 offset:1568
    ds_read_b64_tr_b16 v[36:37], v3 offset:12320
    ds_read_b64_tr_b16 v[38:39], v3 offset:13856
    ds_read_b64_tr_b16 a[64:65], v3 offset:64
    ds_read_b64_tr_b16 a[66:67], v3 offset:1600
    ds_read_b64_tr_b16 a[68:69], v3 offset:12352
    ds_read_b64_tr_b16 a[70:71], v3 offset:13888
    s_add_u32 m0, s41, 122880
    s_add_u32 s37, s40, 3932160
    buffer_load_dwordx4 v4, s[20:23], s37 offen lds
    s_add_u32 m0, s41, 123904
    s_add_u32 s37, s40, 3932160
    buffer_load_dwordx4 v5, s[20:23], s37 offen lds
    s_add_u32 m0, s41, 124928
    s_add_u32 s37, s40, 3932160
    buffer_load_dwordx4 v6, s[20:23], s37 offen lds
    s_add_u32 m0, s41, 125952
    s_add_u32 s37, s40, 4030464
    buffer_load_dwordx4 v4, s[20:23], s37 offen lds
    s_add_u32 m0, s41, 126976
    s_add_u32 s37, s40, 4030464
    buffer_load_dwordx4 v5, s[20:23], s37 offen lds
    s_add_u32 m0, s41, 128000
    s_add_u32 s37, s40, 4030464
    buffer_load_dwordx4 v6, s[20:23], s37 offen lds
    s_waitcnt lgkmcnt(0)
    s_waitcnt vmcnt(24)
    s_barrier
    v_add_u32 v3, 24576, v7
    ds_read_b64_tr_b16 a[176:177], v3 offset:0
    ds_read_b64_tr_b16 a[178:179], v3 offset:1536
    ds_read_b64_tr_b16 a[180:181], v3 offset:12288
    ds_read_b64_tr_b16 a[182:183], v3 offset:13824
    ds_read_b64_tr_b16 a[248:249], v3 offset:32
    ds_read_b64_tr_b16 a[250:251], v3 offset:1568
    ds_read_b64_tr_b16 a[252:253], v3 offset:12320
    ds_read_b64_tr_b16 a[254:255], v3 offset:13856
    ds_read_b64_tr_b16 v[200:201], v3 offset:64
    ds_read_b64_tr_b16 v[202:203], v3 offset:1600
    ds_read_b64_tr_b16 v[204:205], v3 offset:12352
    ds_read_b64_tr_b16 v[206:207], v3 offset:13888
    s_add_u32 m0, s41, 0
    s_add_u32 s37, s40, 4718592
    buffer_load_dwordx4 v4, s[16:19], s37 offen lds
    s_add_u32 m0, s41, 1024
    s_add_u32 s37, s40, 4718592
    buffer_load_dwordx4 v5, s[16:19], s37 offen lds
    s_add_u32 m0, s41, 2048
    s_add_u32 s37, s40, 4718592
    buffer_load_dwordx4 v6, s[16:19], s37 offen lds
    s_add_u32 m0, s41, 3072
    s_add_u32 s37, s40, 4816896
    buffer_load_dwordx4 v4, s[16:19], s37 offen lds
    s_add_u32 m0, s41, 4096
    s_add_u32 s37, s40, 4816896
    buffer_load_dwordx4 v5, s[16:19], s37 offen lds
    s_add_u32 m0, s41, 5120
    s_add_u32 s37, s40, 4816896
    buffer_load_dwordx4 v6, s[16:19], s37 offen lds
    s_waitcnt lgkmcnt(0)
    s_waitcnt vmcnt(24)
    s_barrier
    v_add_u32 v3, 49152, v7
    ds_read_b64_tr_b16 v[40:41], v3 offset:0
    ds_read_b64_tr_b16 v[42:43], v3 offset:1536
    ds_read_b64_tr_b16 v[44:45], v3 offset:12288
    ds_read_b64_tr_b16 v[46:47], v3 offset:13824
    ds_read_b64_tr_b16 a[72:73], v3 offset:32
    ds_read_b64_tr_b16 a[74:75], v3 offset:1568
    ds_read_b64_tr_b16 a[76:77], v3 offset:12320
    ds_read_b64_tr_b16 a[78:79], v3 offset:13856
    ds_read_b64_tr_b16 a[80:81], v3 offset:64
    ds_read_b64_tr_b16 a[82:83], v3 offset:1600
    ds_read_b64_tr_b16 a[84:85], v3 offset:12352
    ds_read_b64_tr_b16 a[86:87], v3 offset:13888
    s_add_u32 m0, s41, 24576
    s_add_u32 s37, s40, 4718592
    buffer_load_dwordx4 v4, s[20:23], s37 offen lds
    s_add_u32 m0, s41, 25600
    s_add_u32 s37, s40, 4718592
    buffer_load_dwordx4 v5, s[20:23], s37 offen lds
    s_add_u32 m0, s41, 26624
    s_add_u32 s37, s40, 4718592
    buffer_load_dwordx4 v6, s[20:23], s37 offen lds
    s_add_u32 m0, s41, 27648
    s_add_u32 s37, s40, 4816896
    buffer_load_dwordx4 v4, s[20:23], s37 offen lds
    s_add_u32 m0, s41, 28672
    s_add_u32 s37, s40, 4816896
    buffer_load_dwordx4 v5, s[20:23], s37 offen lds
    s_add_u32 m0, s41, 29696
    s_add_u32 s37, s40, 4816896
    buffer_load_dwordx4 v6, s[20:23], s37 offen lds
    s_waitcnt lgkmcnt(0)
    s_waitcnt vmcnt(24)
    s_barrier
    v_add_u32 v3, 73728, v7
    ds_read_b64_tr_b16 a[184:185], v3 offset:0
    ds_read_b64_tr_b16 a[186:187], v3 offset:1536
    ds_read_b64_tr_b16 a[188:189], v3 offset:12288
    ds_read_b64_tr_b16 a[190:191], v3 offset:13824
    ds_read_b64_tr_b16 v[128:129], v3 offset:32
    ds_read_b64_tr_b16 v[130:131], v3 offset:1568
    ds_read_b64_tr_b16 v[132:133], v3 offset:12320
    ds_read_b64_tr_b16 v[134:135], v3 offset:13856
    ds_read_b64_tr_b16 v[208:209], v3 offset:64
    ds_read_b64_tr_b16 v[210:211], v3 offset:1600
    ds_read_b64_tr_b16 v[212:213], v3 offset:12352
    ds_read_b64_tr_b16 v[214:215], v3 offset:13888
    s_add_u32 m0, s41, 49152
    s_add_u32 s37, s40, 5505024
    buffer_load_dwordx4 v4, s[16:19], s37 offen lds
    s_add_u32 m0, s41, 50176
    s_add_u32 s37, s40, 5505024
    buffer_load_dwordx4 v5, s[16:19], s37 offen lds
    s_add_u32 m0, s41, 51200
    s_add_u32 s37, s40, 5505024
    buffer_load_dwordx4 v6, s[16:19], s37 offen lds
    s_add_u32 m0, s41, 52224
    s_add_u32 s37, s40, 5603328
    buffer_load_dwordx4 v4, s[16:19], s37 offen lds
    s_add_u32 m0, s41, 53248
    s_add_u32 s37, s40, 5603328
    buffer_load_dwordx4 v5, s[16:19], s37 offen lds
    s_add_u32 m0, s41, 54272
    s_add_u32 s37, s40, 5603328
    buffer_load_dwordx4 v6, s[16:19], s37 offen lds
    s_waitcnt lgkmcnt(0)
    s_waitcnt vmcnt(24)
    s_barrier
    v_add_u32 v3, 98304, v7
    ds_read_b64_tr_b16 v[48:49], v3 offset:0
    ds_read_b64_tr_b16 v[50:51], v3 offset:1536
    ds_read_b64_tr_b16 v[52:53], v3 offset:12288
    ds_read_b64_tr_b16 v[54:55], v3 offset:13824
    ds_read_b64_tr_b16 a[88:89], v3 offset:32
    ds_read_b64_tr_b16 a[90:91], v3 offset:1568
    ds_read_b64_tr_b16 a[92:93], v3 offset:12320
    ds_read_b64_tr_b16 a[94:95], v3 offset:13856
    ds_read_b64_tr_b16 v[56:57], v3 offset:64
    ds_read_b64_tr_b16 v[58:59], v3 offset:1600
    ds_read_b64_tr_b16 v[60:61], v3 offset:12352
    ds_read_b64_tr_b16 v[62:63], v3 offset:13888
    s_add_u32 m0, s41, 73728
    s_add_u32 s37, s40, 5505024
    buffer_load_dwordx4 v4, s[20:23], s37 offen lds
    s_add_u32 m0, s41, 74752
    s_add_u32 s37, s40, 5505024
    buffer_load_dwordx4 v5, s[20:23], s37 offen lds
    s_add_u32 m0, s41, 75776
    s_add_u32 s37, s40, 5505024
    buffer_load_dwordx4 v6, s[20:23], s37 offen lds
    s_add_u32 m0, s41, 76800
    s_add_u32 s37, s40, 5603328
    buffer_load_dwordx4 v4, s[20:23], s37 offen lds
    s_add_u32 m0, s41, 77824
    s_add_u32 s37, s40, 5603328
    buffer_load_dwordx4 v5, s[20:23], s37 offen lds
    s_add_u32 m0, s41, 78848
    s_add_u32 s37, s40, 5603328
    buffer_load_dwordx4 v6, s[20:23], s37 offen lds
    s_waitcnt lgkmcnt(0)
    s_waitcnt vmcnt(24)
    s_barrier
    v_add_u32 v3, 122880, v7
    ds_read_b64_tr_b16 a[192:193], v3 offset:0
    ds_read_b64_tr_b16 a[194:195], v3 offset:1536
    ds_read_b64_tr_b16 a[196:197], v3 offset:12288
    ds_read_b64_tr_b16 a[198:199], v3 offset:13824
    ds_read_b64_tr_b16 v[136:137], v3 offset:32
    ds_read_b64_tr_b16 v[138:139], v3 offset:1568
    ds_read_b64_tr_b16 v[140:141], v3 offset:12320
    ds_read_b64_tr_b16 v[142:143], v3 offset:13856
    ds_read_b64_tr_b16 v[216:217], v3 offset:64
    ds_read_b64_tr_b16 v[218:219], v3 offset:1600
    ds_read_b64_tr_b16 v[220:221], v3 offset:12352
    ds_read_b64_tr_b16 v[222:223], v3 offset:13888
    s_add_u32 m0, s41, 98304
    s_add_u32 s37, s40, 6291456
    buffer_load_dwordx4 v4, s[16:19], s37 offen lds
    s_add_u32 m0, s41, 99328
    s_add_u32 s37, s40, 6291456
    buffer_load_dwordx4 v5, s[16:19], s37 offen lds
    s_add_u32 m0, s41, 100352
    s_add_u32 s37, s40, 6291456
    buffer_load_dwordx4 v6, s[16:19], s37 offen lds
    s_add_u32 m0, s41, 101376
    s_add_u32 s37, s40, 6389760
    buffer_load_dwordx4 v4, s[16:19], s37 offen lds
    s_add_u32 m0, s41, 102400
    s_add_u32 s37, s40, 6389760
    buffer_load_dwordx4 v5, s[16:19], s37 offen lds
    s_add_u32 m0, s41, 103424
    s_add_u32 s37, s40, 6389760
    buffer_load_dwordx4 v6, s[16:19], s37 offen lds
    s_waitcnt lgkmcnt(0)
    s_waitcnt vmcnt(24)
    s_barrier
    v_add_u32 v3, 0, v7
    ds_read_b64_tr_b16 a[96:97], v3 offset:0
    ds_read_b64_tr_b16 a[98:99], v3 offset:1536
    ds_read_b64_tr_b16 a[100:101], v3 offset:12288
    ds_read_b64_tr_b16 a[102:103], v3 offset:13824
    ds_read_b64_tr_b16 a[104:105], v3 offset:32
    ds_read_b64_tr_b16 a[106:107], v3 offset:1568
    ds_read_b64_tr_b16 a[108:109], v3 offset:12320
    ds_read_b64_tr_b16 a[110:111], v3 offset:13856
    ds_read_b64_tr_b16 v[64:65], v3 offset:64
    ds_read_b64_tr_b16 v[66:67], v3 offset:1600
    ds_read_b64_tr_b16 v[68:69], v3 offset:12352
    ds_read_b64_tr_b16 v[70:71], v3 offset:13888
    s_add_u32 m0, s41, 122880
    s_add_u32 s37, s40, 6291456
    buffer_load_dwordx4 v4, s[20:23], s37 offen lds
    s_add_u32 m0, s41, 123904
    s_add_u32 s37, s40, 6291456
    buffer_load_dwordx4 v5, s[20:23], s37 offen lds
    s_add_u32 m0, s41, 124928
    s_add_u32 s37, s40, 6291456
    buffer_load_dwordx4 v6, s[20:23], s37 offen lds
    s_add_u32 m0, s41, 125952
    s_add_u32 s37, s40, 6389760
    buffer_load_dwordx4 v4, s[20:23], s37 offen lds
    s_add_u32 m0, s41, 126976
    s_add_u32 s37, s40, 6389760
    buffer_load_dwordx4 v5, s[20:23], s37 offen lds
    s_add_u32 m0, s41, 128000
    s_add_u32 s37, s40, 6389760
    buffer_load_dwordx4 v6, s[20:23], s37 offen lds
    s_waitcnt lgkmcnt(0)
    s_waitcnt vmcnt(24)
    s_barrier
    v_add_u32 v3, 24576, v7
    ds_read_b64_tr_b16 a[200:201], v3 offset:0
    ds_read_b64_tr_b16 a[202:203], v3 offset:1536
    ds_read_b64_tr_b16 a[204:205], v3 offset:12288
    ds_read_b64_tr_b16 a[206:207], v3 offset:13824
    ds_read_b64_tr_b16 v[144:145], v3 offset:32
    ds_read_b64_tr_b16 v[146:147], v3 offset:1568
    ds_read_b64_tr_b16 v[148:149], v3 offset:12320
    ds_read_b64_tr_b16 v[150:151], v3 offset:13856
    ds_read_b64_tr_b16 v[224:225], v3 offset:64
    ds_read_b64_tr_b16 v[226:227], v3 offset:1600
    ds_read_b64_tr_b16 v[228:229], v3 offset:12352
    ds_read_b64_tr_b16 v[230:231], v3 offset:13888
    s_add_u32 m0, s41, 0
    s_add_u32 s37, s40, 7077888
    buffer_load_dwordx4 v4, s[16:19], s37 offen lds
    s_add_u32 m0, s41, 1024
    s_add_u32 s37, s40, 7077888
    buffer_load_dwordx4 v5, s[16:19], s37 offen lds
    s_add_u32 m0, s41, 2048
    s_add_u32 s37, s40, 7077888
    buffer_load_dwordx4 v6, s[16:19], s37 offen lds
    s_add_u32 m0, s41, 3072
    s_add_u32 s37, s40, 7176192
    buffer_load_dwordx4 v4, s[16:19], s37 offen lds
    s_add_u32 m0, s41, 4096
    s_add_u32 s37, s40, 7176192
    buffer_load_dwordx4 v5, s[16:19], s37 offen lds
    s_add_u32 m0, s41, 5120
    s_add_u32 s37, s40, 7176192
    buffer_load_dwordx4 v6, s[16:19], s37 offen lds
    s_waitcnt lgkmcnt(0)
    s_waitcnt vmcnt(24)
    s_barrier
    v_add_u32 v3, 49152, v7
    ds_read_b64_tr_b16 a[112:113], v3 offset:0
    ds_read_b64_tr_b16 a[114:115], v3 offset:1536
    ds_read_b64_tr_b16 a[116:117], v3 offset:12288
    ds_read_b64_tr_b16 a[118:119], v3 offset:13824
    ds_read_b64_tr_b16 v[72:73], v3 offset:32
    ds_read_b64_tr_b16 v[74:75], v3 offset:1568
    ds_read_b64_tr_b16 v[76:77], v3 offset:12320
    ds_read_b64_tr_b16 v[78:79], v3 offset:13856
    ds_read_b64_tr_b16 a[120:121], v3 offset:64
    ds_read_b64_tr_b16 a[122:123], v3 offset:1600
    ds_read_b64_tr_b16 a[124:125], v3 offset:12352
    ds_read_b64_tr_b16 a[126:127], v3 offset:13888
    s_add_u32 m0, s41, 24576
    s_add_u32 s37, s40, 7077888
    buffer_load_dwordx4 v4, s[20:23], s37 offen lds
    s_add_u32 m0, s41, 25600
    s_add_u32 s37, s40, 7077888
    buffer_load_dwordx4 v5, s[20:23], s37 offen lds
    s_add_u32 m0, s41, 26624
    s_add_u32 s37, s40, 7077888
    buffer_load_dwordx4 v6, s[20:23], s37 offen lds
    s_add_u32 m0, s41, 27648
    s_add_u32 s37, s40, 7176192
    buffer_load_dwordx4 v4, s[20:23], s37 offen lds
    s_add_u32 m0, s41, 28672
    s_add_u32 s37, s40, 7176192
    buffer_load_dwordx4 v5, s[20:23], s37 offen lds
    s_add_u32 m0, s41, 29696
    s_add_u32 s37, s40, 7176192
    buffer_load_dwordx4 v6, s[20:23], s37 offen lds
    s_waitcnt lgkmcnt(0)
    s_waitcnt vmcnt(24)
    s_barrier
    v_add_u32 v3, 73728, v7
    ds_read_b64_tr_b16 a[208:209], v3 offset:0
    ds_read_b64_tr_b16 a[210:211], v3 offset:1536
    ds_read_b64_tr_b16 a[212:213], v3 offset:12288
    ds_read_b64_tr_b16 a[214:215], v3 offset:13824
    ds_read_b64_tr_b16 v[152:153], v3 offset:32
    ds_read_b64_tr_b16 v[154:155], v3 offset:1568
    ds_read_b64_tr_b16 v[156:157], v3 offset:12320
    ds_read_b64_tr_b16 v[158:159], v3 offset:13856
    ds_read_b64_tr_b16 v[232:233], v3 offset:64
    ds_read_b64_tr_b16 v[234:235], v3 offset:1600
    ds_read_b64_tr_b16 v[236:237], v3 offset:12352
    ds_read_b64_tr_b16 v[238:239], v3 offset:13888
    s_waitcnt lgkmcnt(0)
    s_waitcnt vmcnt(18)
    s_barrier
    v_add_u32 v3, 98304, v7
    ds_read_b64_tr_b16 a[128:129], v3 offset:0
    ds_read_b64_tr_b16 a[130:131], v3 offset:1536
    ds_read_b64_tr_b16 a[132:133], v3 offset:12288
    ds_read_b64_tr_b16 a[134:135], v3 offset:13824
    ds_read_b64_tr_b16 v[80:81], v3 offset:32
    ds_read_b64_tr_b16 v[82:83], v3 offset:1568
    ds_read_b64_tr_b16 v[84:85], v3 offset:12320
    ds_read_b64_tr_b16 v[86:87], v3 offset:13856
    ds_read_b64_tr_b16 a[136:137], v3 offset:64
    ds_read_b64_tr_b16 a[138:139], v3 offset:1600
    ds_read_b64_tr_b16 a[140:141], v3 offset:12352
    ds_read_b64_tr_b16 a[142:143], v3 offset:13888
    s_waitcnt lgkmcnt(0)
    s_waitcnt vmcnt(12)
    s_barrier
    v_add_u32 v3, 122880, v7
    ds_read_b64_tr_b16 a[216:217], v3 offset:0
    ds_read_b64_tr_b16 a[218:219], v3 offset:1536
    ds_read_b64_tr_b16 a[220:221], v3 offset:12288
    ds_read_b64_tr_b16 a[222:223], v3 offset:13824
    ds_read_b64_tr_b16 v[160:161], v3 offset:32
    ds_read_b64_tr_b16 v[162:163], v3 offset:1568
    ds_read_b64_tr_b16 v[164:165], v3 offset:12320
    ds_read_b64_tr_b16 v[166:167], v3 offset:13856
    ds_read_b64_tr_b16 v[240:241], v3 offset:64
    ds_read_b64_tr_b16 v[242:243], v3 offset:1600
    ds_read_b64_tr_b16 v[244:245], v3 offset:12352
    ds_read_b64_tr_b16 v[246:247], v3 offset:13888
    s_waitcnt lgkmcnt(0)
    s_waitcnt vmcnt(6)
    s_barrier
    v_add_u32 v3, 0, v7
    ds_read_b64_tr_b16 v[88:89], v3 offset:0
    ds_read_b64_tr_b16 v[90:91], v3 offset:1536
    ds_read_b64_tr_b16 v[92:93], v3 offset:12288
    ds_read_b64_tr_b16 v[94:95], v3 offset:13824
    ds_read_b64_tr_b16 a[144:145], v3 offset:32
    ds_read_b64_tr_b16 a[146:147], v3 offset:1568
    ds_read_b64_tr_b16 a[148:149], v3 offset:12320
    ds_read_b64_tr_b16 a[150:151], v3 offset:13856
    ds_read_b64_tr_b16 a[152:153], v3 offset:64
    ds_read_b64_tr_b16 a[154:155], v3 offset:1600
    ds_read_b64_tr_b16 a[156:157], v3 offset:12352
    ds_read_b64_tr_b16 a[158:159], v3 offset:13888
    s_waitcnt lgkmcnt(0)
    s_waitcnt vmcnt(0)
    s_barrier
    v_add_u32 v3, 24576, v7
    ds_read_b64_tr_b16 v[104:105], v3 offset:0
    ds_read_b64_tr_b16 v[106:107], v3 offset:1536
    ds_read_b64_tr_b16 v[108:109], v3 offset:12288
    ds_read_b64_tr_b16 v[110:111], v3 offset:13824
    ds_read_b64_tr_b16 v[168:169], v3 offset:32
    ds_read_b64_tr_b16 v[170:171], v3 offset:1568
    ds_read_b64_tr_b16 v[172:173], v3 offset:12320
    ds_read_b64_tr_b16 v[174:175], v3 offset:13856
    ds_read_b64_tr_b16 v[248:249], v3 offset:64
    ds_read_b64_tr_b16 v[250:251], v3 offset:1600
    ds_read_b64_tr_b16 v[252:253], v3 offset:12352
    ds_read_b64_tr_b16 v[254:255], v3 offset:13888
    s_waitcnt lgkmcnt(0)
    s_barrier
    v_lshlrev_b32 v9, 4, v1
    s_mul_i32 s32, s12, 24576
    v_add_u32 v120, s32, v9
    ds_write_b128 v120, v[16:19] offset:0
    ds_write_b128 v120, v[20:23] offset:1024
    ds_write_b128 v120, v[24:27] offset:2048
    ds_write_b128 v120, v[28:31] offset:3072
    ds_write_b128 v120, v[32:35] offset:4096
    ds_write_b128 v120, v[36:39] offset:5120
    ds_write_b128 v120, v[40:43] offset:6144
    ds_write_b128 v120, v[44:47] offset:7168
    s_waitcnt lgkmcnt(0)
    ds_write_b128 v120, v[48:51] offset:8192
    ds_write_b128 v120, v[52:55] offset:9216
    ds_write_b128 v120, v[56:59] offset:10240
    ds_write_b128 v120, v[60:63] offset:11264
    ds_write_b128 v120, v[64:67] offset:12288
    ds_write_b128 v120, v[68:71] offset:13312
    ds_write_b128 v120, v[72:75] offset:14336
    ds_write_b128 v120, v[76:79] offset:15360
    s_waitcnt lgkmcnt(0)
    ds_write_b128 v120, v[80:83] offset:16384
    ds_write_b128 v120, v[84:87] offset:17408
    ds_write_b128 v120, v[88:91] offset:18432
    ds_write_b128 v120, v[92:95] offset:19456
    ds_write_b128 v120, v[96:99] offset:20480
    ds_write_b128 v120, v[100:103] offset:21504
    ds_write_b128 v120, v[104:107] offset:22528
    ds_write_b128 v120, v[108:111] offset:23552
    s_waitcnt lgkmcnt(0)
    v_mov_b32 v4, 128
    s_mov_b32 s39, 0
rp_1:
    buffer_load_dwordx2 v[2:3], v4, s[8:11], 0 offen sc1
    s_waitcnt vmcnt(0)
    v_readfirstlane_b32 s32, v2
    v_readfirstlane_b32 s58, v3
    s_cmp_lt_u32 s32, 40
    s_cbranch_scc1 rpa_3
    s_cmp_ge_u32 s58, 1792
    s_cbranch_scc1 rpo_2
rpa_3:
    s_sleep 8
    s_add_u32 s39, s39, 1
    s_cmp_lt_u32 s39, 20000
    s_cbranch_scc1 rp_1
    s_branch L_end
rpo_2:
    s_and_b32 s58, s58, 0xff
    s_cmp_gt_u32 s58, 3
    s_cselect_b32 s58, 0x2000, 0
    s_mul_i32 s32, s12, 2560
    v_lshlrev_b32 v16, 4, v1
    v_add_u32 v16, s32, v16
    v_add_u32 v17, 1024, v16
    v_add_u32 v18, 2048, v16
    v_lshrrev_b32 v19, 13, v16
    v_lshlrev_b32 v19, 14, v19
    v_and_b32 v4, 0x1fff, v16
    v_or3_b32 v4, v4, v19, s58
    v_lshrrev_b32 v19, 13, v17
    v_lshlrev_b32 v19, 14, v19
    v_and_b32 v5, 0x1fff, v17
    v_or3_b32 v5, v5, v19, s58
    v_lshrrev_b32 v19, 13, v18
    v_lshlrev_b32 v19, 14, v19
    v_and_b32 v6, 0x1fff, v18
    v_or3_b32 v6, v6, v19, s58
    v_and_b32 v16, 8, v1
    v_mov_b32 v17, 0x4444
    v_mov_b32 v18, 0xeeee
    v_cmp_eq_u32 vcc, 0, v16
    s_nop 1
    v_cndmask_b32 v10, v18, v17, vcc
    s_mov_b32 s56, 0x3dd53b95
    s_mov_b32 s57, 0xbdd53b95
    s_mov_b32 s45, 0x42800000
    s_mul_i32 s44, s12, 2560
    s_mul_i32 s32, s12, 1920
    s_add_u32 s32, s32, 108544
    v_and_b32 v16, 15, v1
    v_mul_u32_u24 v17, 40, v16
    v_lshrrev_b32 v18, 4, v1
    v_lshlrev_b32 v19, 3, v18
    v_add3_u32 v8, v17, v19, s32
    v_lshrrev_b32 v17, 2, v1
    v_mul_u32_u24 v17, 40, v17
    v_and_b32 v19, 3, v1
    v_lshlrev_b32 v19, 3, v19
    v_add3_u32 v12, v17, v19, s32
    s_mul_i32 s32, s12, 768
    s_add_u32 s32, s32, 116224
    v_lshlrev_b32 v17, 4, v16
    v_and_b32 v19, 1, v18
    v_lshlrev_b32 v19, 3, v19
    v_lshrrev_b32 v20, 1, v18
    v_lshlrev_b32 v20, 2, v20
    v_add3_u32 v17, v17, v19, v20
    v_add_u32 v11, s32, v17
    v_lshrrev_b32 v17, 2, v1
    v_lshlrev_b32 v17, 4, v17
    v_and_b32 v19, 1, v1
    v_lshlrev_b32 v19, 3, v19
    v_add3_u32 v127, v17, v19, s32
    v_mul_u32_u24 v17, 384, v18
    v_lshlrev_b32 v19, 4, v16
    s_mul_i32 s32, s12, 1536
    s_add_u32 s32, s32, 119296
    v_add3_u32 v126, v17, v19, s32
    v_and_b32 v16, 7, v1
    v_lshrrev_b32 v17, 3, v1
    v_lshrrev_b32 v18, 2, v17
    v_and_b32 v19, 3, v17
    v_mul_u32_u24 v20, 1536, v18
    v_mul_u32_u24 v21, 384, v19
    v_lshlrev_b32 v22, 4, v16
    v_add3_u32 v122, v20, v21, v22
    v_add_u32 v122, 135680, v122
    v_mul_u32_u24 v20, 384, v18
    v_lshlrev_b32 v21, 2, v19
    v_add3_u32 v123, v21, v20, v22
    v_add_u32 v123, 119296, v123
    s_mul_i32 s32, s14, 640
    v_and_b32 v20, 15, v1
    v_lshlrev_b32 v20, 4, v20
    v_lshlrev_b32 v21, 8, v18
    v_add3_u32 v20, v20, v21, s32
    v_lshlrev_b32 v21, 6, v18
    v_lshlrev_b32 v23, 3, v16
    v_add3_u32 v21, v21, v23, s32
    v_add_u32 v21, 512, v21
    v_lshrrev_b32 v23, 13, v20
    v_lshlrev_b32 v23, 14, v23
    v_and_b32 v13, 0x1fff, v20
    v_or3_b32 v13, v13, v23, s58
    v_lshrrev_b32 v23, 13, v21
    v_lshlrev_b32 v23, 14, v23
    v_and_b32 v14, 0x1fff, v21
    v_or3_b32 v14, v14, v23, s58
    v_bfe_u32 v20, v17, 1, 1
    v_mul_u32_u24 v20, 49152, v20
    v_add_u32 v13, v13, v20
    v_add_u32 v14, v14, v20
    s_mul_i32 s42, s14, 12288
    v_min_u32 v20, 47, v1
    v_cmp_le_u32 vcc, 24, v20
    v_mov_b32 v21, 4194304
    v_mov_b32 v22, 29357056
    v_lshlrev_b32 v20, 7, v20
    v_cndmask_b32 v21, v21, v22, vcc
    s_mul_i32 s32, s12, 3072
    v_add3_u32 v0, v20, v21, s32
    s_mov_b32 s36, 0
    s_mov_b32 s38, 0
    s_mov_b32 s59, 0
    s_add_u32 s43, s36, 1
    s_min_u32 s43, s43, 64
    s_cmp_ge_u32 s38, s43
    s_cbranch_scc1 kq_ok_4
    s_mov_b32 s39, 0
    s_lshl_b32 s32, s14, 7
    s_add_u32 s32, s32, 2162688
    v_mov_b32 v16, s32
    s_mov_b32 s33, 0x1000
kq_5:
    buffer_load_dword v17, v16, s[4:7], 0 offen sc1
    buffer_load_dword v18, v16, s[4:7], s33 offen sc1
    s_waitcnt vmcnt(0)
    v_min_u32 v17, v17, v18
    s_nop 0
    v_readfirstlane_b32 s38, v17
    s_cmp_ge_u32 s38, s43
    s_cbranch_scc1 kq_ok_4
    s_sleep 2
    s_add_u32 s39, s39, 1
    s_cmp_lt_u32 s39, 20000
    s_cbranch_scc1 kq_5
    s_branch L_end
kq_ok_4:
    s_mul_i32 s32, s12, 3072
    v_add_u32 v2, s32, v9
    s_mul_i32 s37, s36, 393216
    s_add_u32 s37, s37, s42
    s_add_u32 s32, s37, 29360128
    buffer_load_dwordx4 v[96:99], v2, s[4:7], s32 offen offset:0 sc1
    buffer_load_dwordx4 v[100:103], v2, s[4:7], s32 offen offset:1024 sc1
    buffer_load_dwordx4 v[104:107], v2, s[4:7], s32 offen offset:2048 sc1
    s_add_u32 s32, s37, 4194304
    buffer_load_dwordx4 v[108:111], v2, s[4:7], s32 offen offset:0 sc1
    buffer_load_dwordx4 v[112:115], v2, s[4:7], s32 offen offset:1024 sc1
    buffer_load_dwordx4 v[116:119], v2, s[4:7], s32 offen offset:2048 sc1
    s_memrealtime s[62:63]
    s_waitcnt lgkmcnt(0)
    s_sub_u32 s61, s62, 100
    v_mov_b32 v2, 162560
    v_mov_b32 v16, 0
    v_mov_b32 v17, 0
    ds_write_b64 v2, v[16:17]
    v_mov_b32 v16, 0
    v_mov_b32 v17, 0
    v_mov_b32 v18, 0
    v_mov_b32 v19, 0
    v_mov_b32 v20, 0
    v_mov_b32 v21, 0
    v_mov_b32 v22, 0
    v_mov_b32 v23, 0
    v_mov_b32 v24, 0
    v_mov_b32 v25, 0
    v_mov_b32 v26, 0
    v_mov_b32 v27, 0
    v_mov_b32 v28, 0
    v_mov_b32 v29, 0
    v_mov_b32 v30, 0
    v_mov_b32 v31, 0
    v_mov_b32 v32, 0
    v_mov_b32 v33, 0
    v_mov_b32 v34, 0
    v_mov_b32 v35, 0
    v_mov_b32 v36, 0
    v_mov_b32 v37, 0
    v_mov_b32 v38, 0
    v_mov_b32 v39, 0
    v_mov_b32 v40, 0
    v_mov_b32 v41, 0
    v_mov_b32 v42, 0
    v_mov_b32 v43, 0
    v_mov_b32 v44, 0
    v_mov_b32 v45, 0
    s_mov_b32 s47, 192937984
    v_mov_b32 v56, 0
    v_mov_b32 v57, 0
    v_mov_b32 v58, 0
    v_mov_b32 v59, 0
    v_mov_b32 v60, 0
    v_mov_b32 v61, 0
    v_mov_b32 v62, 0
    v_mov_b32 v63, 0
    v_mov_b32 v64, 0
    v_mov_b32 v65, 0
    v_mov_b32 v66, 0
    v_mov_b32 v67, 0
    v_mov_b32 v68, 0
    v_mov_b32 v69, 0
    v_mov_b32 v70, 0
    v_mov_b32 v71, 0
    v_mov_b32 v72, 0
    v_mov_b32 v73, 0
    v_mov_b32 v74, 0
    v_mov_b32 v75, 0
    v_mov_b32 v76, 0
    v_mov_b32 v77, 0
    v_mov_b32 v78, 0
    v_mov_b32 v79, 0
    s_lshl_b32 s25, s14, 7
    s_add_u32 s25, s25, 2162688
    s_mul_i32 s16, s12, 7680
    s_add_u32 s16, s16, 6144
    s_lshr_b32 s32, s12, 1
    s_mul_i32 s18, s32, 4608
    s_and_b32 s33, s12, 1
    s_lshl_b32 s33, s33, 7
    s_add_u32 s18, s18, s33
    s_sub_u32 s17, s18, 8704
    s_add_u32 s18, s18, 6144
    s_lshl_b32 s19, s32, 10
    s_add_u32 s19, s19, s33
    s_lshl_b32 s20, s12, 7
    s_add_u32 s20, s20, 2048
    s_mul_i32 s21, s12, 3072
    s_add_u32 s22, s21, 1024
    s_mul_i32 s23, s12, 1536
    s_add_u32 s23, s23, 16384
    v_and_b32 v2, 7, v1
    s_lshl_b32 s32, s12, 3
    v_add_u32 v2, s32, v2
    v_lshrrev_b32 v3, 3, v1
    v_lshlrev_b32 v3, 2, v3
    v_sub_u32 v2, v2, v3
    v_cmp_gt_i32 s[64:65], 0, v2
    v_cmp_gt_i32 s[66:67], 1, v2
    v_cmp_gt_i32 s[68:69], 2, v2
    v_cmp_gt_i32 s[70:71], 3, v2
cq_loop_6:
    ds_read_b128 v[80:83], v120 offset:0
    ds_read_b128 v[84:87], v120 offset:1024
    ds_read_b128 v[88:91], v120 offset:2048
    ds_read_b128 v[92:95], v120 offset:3072
    v_add_u32 v15, s23, v126
    s_add_u32 s32, s36, 1
    s_min_u32 s32, s32, 63
    s_mul_i32 s32, s32, 393216
    s_add_u32 s24, s32, s42
wu_12:
    s_memrealtime s[62:63]
    s_waitcnt lgkmcnt(0)
    s_sub_u32 s32, s62, s61
    s_cmp_ge_u32 s32, 0xfffff000
    s_cbranch_scc1 wu_12
    s_mov_b32 s54, s32
    s_mul_i32 s37, s59, 65536
    s_add_u32 m0, s44, 98304
    s_nop 0
    buffer_load_dwordx4 v4, s[4:7], s37 offen sc1 lds
    s_add_u32 m0, m0, 1024
    s_nop 0
    buffer_load_dwordx4 v5, s[4:7], s37 offen sc1 lds
    s_add_u32 m0, m0, 1024
    s_mov_b32 exec_hi, 0
    buffer_load_dwordx4 v6, s[4:7], s37 offen sc1 lds
    s_mov_b32 exec_hi, -1
    v_add_f32 v16, v16, v20
    v_add_f32 v17, v17, v21
    v_add_f32 v18, v18, v22
    v_add_f32 v19, v19, v23
    v_add_f32 v32, v32, v33
    v_add_f32 v24, v24, v28
    v_add_f32 v25, v25, v29
    v_add_f32 v26, v26, v30
    v_add_f32 v27, v27, v31
    v_add_f32 v34, v34, v35
    v_add_f32 v16, v16, v24
    v_add_f32 v17, v17, v25
    v_add_f32 v18, v18, v26
    v_add_f32 v19, v19, v27
    v_add_f32 v20, v32, v34
    v_cndmask_b32 v16, v16, v43, s[64:65]
    v_cndmask_b32 v17, v17, v43, s[66:67]
    v_cndmask_b32 v18, v18, v43, s[68:69]
    v_cndmask_b32 v19, v19, v43, s[70:71]
    v_max3_f32 v21, v16, v17, v18
    v_max3_f32 v21, v21, v19, v20
    s_nop 1
    v_max_f32_dpp v21, v21, v21 row_ror:8 row_mask:0xf bank_mask:0xf
    v_mov_b32 v22, v21
    s_nop 1
    v_permlane16_swap_b32 v21, v22
    v_max_f32 v21, v21, v22
    v_mov_b32 v22, v21
    s_nop 1
    v_permlane32_swap_b32 v21, v22
    v_max_f32 v21, v21, v22
    v_mul_f32 v21, s57, v21
    v_fma_f32 v16, v16, s56, v21
    v_fma_f32 v17, v17, s56, v21
    v_fma_f32 v18, v18, s56, v21
    v_fma_f32 v19, v19, s56, v21
    v_fma_f32 v20, v20, s56, v21
    v_exp_f32 v16, v16
    v_exp_f32 v17, v17
    v_exp_f32 v18, v18
    v_exp_f32 v19, v19
    v_exp_f32 v20, v20
    v_add_f32 v21, v16, v17
    v_add_f32 v22, v18, v19
    v_add_f32 v21, v21, v20
    v_add_f32 v21, v21, v22
    s_nop 1
    v_add_f32_dpp v21, v21, v21 row_ror:8 row_mask:0xf bank_mask:0xf
    v_mov_b32 v22, v21
    s_nop 1
    v_permlane16_swap_b32 v21, v22
    v_add_f32 v21, v21, v22
    v_mov_b32 v22, v21
    s_nop 1
    v_permlane32_swap_b32 v21, v22
    v_add_f32 v21, v21, v22
    v_rcp_f32 v21, v21
    s_nop 0
    v_mul_f32 v16, v16, v21
    v_mul_f32 v17, v17, v21
    v_mul_f32 v18, v18, v21
    v_mul_f32 v19, v19, v21
    v_mul_f32 v20, v20, v21
    v_cvt_pk_bf16_f32 v24, v16, v17
    v_cvt_pk_bf16_f32 v26, v18, v19
    v_mov_b32_dpp v28, v20 row_ror:8 row_mask:0xf bank_mask:0xf
    v_mov_b32_dpp v25, v24 row_ror:8 row_mask:0xf bank_mask:0xf
    v_mov_b32_dpp v27, v26 row_ror:8 row_mask:0xf bank_mask:0xf
    v_cvt_pk_bf16_f32 v28, v20, v28
    s_mov_b32 exec_lo, 0x00ff00ff
    s_mov_b32 exec_hi, 0x00ff00ff
    buffer_store_dwordx4 v[24:27], v44, s[4:7], s47 offen sc1
    s_mov_b64 exec, -1
    v_mov_b32 v30, v28
    s_nop 1
    v_permlane16_swap_b32 v28, v30
    v_mov_b32 v29, v28
    v_mov_b32 v31, v30
    s_nop 0
    v_permlane32_swap_b32 v28, v29
    v_permlane32_swap_b32 v30, v31
    s_mov_b64 exec, 0xff
    buffer_store_dwordx4 v[28:31], v45, s[4:7], s47 offen sc1
    s_mov_b64 exec, -1
    s_mov_b32 s55, 0
    s_waitcnt vmcnt(2)
    v_add_u32 v7, 98304, v9
cq_go_8:
    s_barrier
    ds_read_b128 v[16:19], v7 offset:0
    ds_read_b128 v[20:23], v7 offset:1024
    ds_read_b128 v[24:27], v7 offset:2048
    ds_read_b128 v[28:31], v7 offset:3072
    ds_read_b128 v[32:35], v7 offset:4096
    s_waitcnt lgkmcnt(4)
    v_smfmac_f32_16x16x64_bf16 v[56:59], v[16:19], a[0:7], v10
    ds_read_b128 v[36:39], v7 offset:5120
    v_smfmac_f32_16x16x64_bf16 v[60:63], v[16:19], a[8:15], v10
    ds_read_b128 v[40:43], v7 offset:6144
    v_smfmac_f32_16x16x64_bf16 v[64:67], v[16:19], a[16:23], v10
    ds_read_b128 v[44:47], v7 offset:7168
    s_waitcnt lgkmcnt(6)
    v_smfmac_f32_16x16x64_bf16 v[56:59], v[20:23], a[24:31], v10
    ds_read_b128 v[48:51], v7 offset:8192
    v_smfmac_f32_16x16x64_bf16 v[60:63], v[20:23], a[32:39], v10
    ds_read_b128 v[52:55], v7 offset:9216
    v_smfmac_f32_16x16x64_bf16 v[64:67], v[20:23], v[80:87], v10
    ds_read_b128 v[80:83], v120 offset:4096
    s_waitcnt lgkmcnt(8)
    v_smfmac_f32_16x16x64_bf16 v[56:59], v[24:27], a[40:47], v10
    ds_read_b128 v[84:87], v120 offset:5120
    v_smfmac_f32_16x16x64_bf16 v[60:63], v[24:27], v[88:95], v10
    ds_read_b128 v[88:91], v120 offset:6144
    v_max3_u32 v121, v19, v23, v27
    v_smfmac_f32_16x16x64_bf16 v[64:67], v[24:27], a[48:55], v10
    ds_read_b128 v[92:95], v120 offset:7168
    s_waitcnt lgkmcnt(9)
    v_max3_u32 v121, v121, v31, v35
    v_smfmac_f32_16x16x64_bf16 v[56:59], v[28:31], a[56:63], v10
    s_waitcnt lgkmcnt(7)
    v_max3_u32 v121, v121, v39, v43
    s_waitcnt lgkmcnt(2)
    v_smfmac_f32_16x16x64_bf16 v[60:63], v[28:31], v[80:87], v10
    ds_read_b128 v[80:83], v120 offset:8192
    v_max3_u32 v121, v121, v47, v51
    v_smfmac_f32_16x16x64_bf16 v[64:67], v[28:31], a[64:71], v10
    ds_read_b128 v[84:87], v120 offset:9216
    v_max_u32 v121, v121, v55
    s_waitcnt lgkmcnt(2)
    v_smfmac_f32_16x16x64_bf16 v[56:59], v[32:35], v[88:95], v10
    ds_read_b128 v[88:91], v120 offset:10240
    v_cmp_eq_u32 vcc, -1, v121
    v_smfmac_f32_16x16x64_bf16 v[60:63], v[32:35], a[72:79], v10
    ds_read_b128 v[92:95], v120 offset:11264
    s_cbranch_vccnz cq_retry_9
    s_mov_b32 m0, 162304
    s_nop 0
    buffer_load_dword v0, s[4:7], s24 offen sc1 lds
    v_smfmac_f32_16x16x64_bf16 v[64:67], v[32:35], a[80:87], v10
    s_waitcnt lgkmcnt(2)
    v_smfmac_f32_16x16x64_bf16 v[56:59], v[36:39], v[80:87], v10
    ds_read_b128 v[80:83], v120 offset:12288
    v_smfmac_f32_16x16x64_bf16 v[60:63], v[36:39], a[88:95], v10
    ds_read_b128 v[84:87], v120 offset:13312
    s_waitcnt lgkmcnt(2)
    v_smfmac_f32_16x16x64_bf16 v[64:67], v[36:39], v[88:95], v10
    ds_read_b128 v[88:91], v120 offset:14336
    v_smfmac_f32_16x16x64_bf16 v[56:59], v[40:43], a[96:103], v10
    ds_read_b128 v[92:95], v120 offset:15360
    v_smfmac_f32_16x16x64_bf16 v[60:63], v[40:43], a[104:111], v10
    s_waitcnt lgkmcnt(2)
    v_smfmac_f32_16x16x64_bf16 v[64:67], v[40:43], v[80:87], v10
    ds_read_b128 v[80:83], v120 offset:16384
    v_smfmac_f32_16x16x64_bf16 v[56:59], v[44:47], a[112:119], v10
    ds_read_b128 v[84:87], v120 offset:17408
    s_waitcnt lgkmcnt(2)
    v_smfmac_f32_16x16x64_bf16 v[60:63], v[44:47], v[88:95], v10
    ds_read_b128 v[88:91], v120 offset:18432
    v_smfmac_f32_16x16x64_bf16 v[64:67], v[44:47], a[120:127], v10
    ds_read_b128 v[92:95], v120 offset:19456
    v_smfmac_f32_16x16x64_bf16 v[56:59], v[48:51], a[128:135], v10
    s_waitcnt lgkmcnt(2)
    v_smfmac_f32_16x16x64_bf16 v[60:63], v[48:51], v[80:87], v10
    ds_read_b128 v[80:83], v120 offset:20480
    v_smfmac_f32_16x16x64_bf16 v[64:67], v[48:51], a[136:143], v10
    ds_read_b128 v[84:87], v120 offset:21504
    s_waitcnt lgkmcnt(2)
    v_smfmac_f32_16x16x64_bf16 v[56:59], v[52:55], v[88:95], v10
    ds_read_b128 v[88:91], v120 offset:22528
    v_smfmac_f32_16x16x64_bf16 v[60:63], v[52:55], a[144:151], v10
    ds_read_b128 v[92:95], v120 offset:23552
    v_smfmac_f32_16x16x64_bf16 v[64:67], v[52:55], a[152:159], v10
    s_waitcnt lgkmcnt(2)
    v_smfmac_f32_16x16x64_bf16 v[68:71], v[16:19], v[80:87], v10
    s_nop 1
    v_smfmac_f32_16x16x64_bf16 v[68:71], v[20:23], a[160:167], v10
    s_nop 1
    v_smfmac_f32_16x16x64_bf16 v[68:71], v[24:27], a[168:175], v10
    v_cvt_pk_bf16_f32 v56, v56, v57
    v_cvt_pk_bf16_f32 v57, v58, v59
    v_smfmac_f32_16x16x64_bf16 v[68:71], v[28:31], a[176:183], v10
    ds_write_b64 v8, v[56:57] offset:0
    v_cvt_pk_bf16_f32 v60, v60, v61
    v_smfmac_f32_16x16x64_bf16 v[68:71], v[32:35], a[184:191], v10
    v_cvt_pk_bf16_f32 v61, v62, v63
    ds_write_b64 v8, v[60:61] offset:640
    v_smfmac_f32_16x16x64_bf16 v[68:71], v[36:39], a[192:199], v10
    v_cvt_pk_bf16_f32 v64, v64, v65
    v_cvt_pk_bf16_f32 v65, v66, v67
    v_smfmac_f32_16x16x64_bf16 v[68:71], v[40:43], a[200:207], v10
    ds_write_b64 v8, v[64:65] offset:1280
    ds_read_b64_tr_b16 v[60:61], v12
    v_smfmac_f32_16x16x64_bf16 v[68:71], v[44:47], a[208:215], v10
    ds_read_b64_tr_b16 v[62:63], v12 offset:640
    ds_read_b64_tr_b16 v[124:125], v12 offset:1280
    v_smfmac_f32_16x16x64_bf16 v[68:71], v[48:51], a[216:223], v10
    s_waitcnt lgkmcnt(6)
    v_smfmac_f32_16x16x64_bf16 v[68:71], v[52:55], v[88:95], v10
    v_smfmac_f32_16x16x64_bf16 v[72:75], v[16:19], a[224:231], v10
    s_nop 1
    v_smfmac_f32_16x16x64_bf16 v[72:75], v[20:23], a[232:239], v10
    s_nop 1
    v_smfmac_f32_16x16x64_bf16 v[72:75], v[24:27], a[240:247], v10
    s_waitcnt lgkmcnt(0)
    v_mfma_f32_16x16x32_bf16 v[56:59], v[96:99], v[60:63], 0
    v_permlane32_swap_b32 v68, v69
    v_mfma_f32_16x16x32_bf16 v[64:67], v[100:103], v[60:63], 0
    v_permlane32_swap_b32 v70, v71
    v_smfmac_f32_16x16x64_bf16 v[72:75], v[28:31], a[248:255], v10
    v_add_f32 v68, v68, v69
    v_add_f32 v70, v70, v71
    v_mfma_f32_16x16x16_bf16 v[56:59], v[104:105], v[124:125], v[56:59]
    v_cvt_pk_bf16_f32 v68, v68, v70
    v_mfma_f32_16x16x16_bf16 v[64:67], v[106:107], v[124:125], v[64:67]
    ds_write_b32 v11, v68 offset:0
    v_smfmac_f32_16x16x64_bf16 v[72:75], v[32:35], v[128:135], v10
    s_nop 1
    v_smfmac_f32_16x16x64_bf16 v[72:75], v[36:39], v[136:143], v10
    s_nop 0
    v_add_f32_dpp v56, v56, v56 row_ror:8 row_mask:0xf bank_mask:0xf
    v_add_f32_dpp v57, v57, v57 row_ror:8 row_mask:0xf bank_mask:0xf
    v_smfmac_f32_16x16x64_bf16 v[72:75], v[40:43], v[144:151], v10
    v_add_f32_dpp v58, v58, v58 row_ror:8 row_mask:0xf bank_mask:0xf
    v_add_f32_dpp v59, v59, v59 row_ror:8 row_mask:0xf bank_mask:0xf
    v_smfmac_f32_16x16x64_bf16 v[72:75], v[44:47], v[152:159], v10
    ds_write_b128 v15, v[56:59]
    v_add_f32_dpp v64, v64, v64 row_ror:8 row_mask:0xf bank_mask:0xf
    v_smfmac_f32_16x16x64_bf16 v[72:75], v[48:51], v[160:167], v10
    v_add_f32_dpp v65, v65, v65 row_ror:8 row_mask:0xf bank_mask:0xf
    v_add_f32_dpp v66, v66, v66 row_ror:8 row_mask:0xf bank_mask:0xf
    v_smfmac_f32_16x16x64_bf16 v[72:75], v[52:55], v[168:175], v10
    v_add_f32_dpp v67, v67, v67 row_ror:8 row_mask:0xf bank_mask:0xf
    ds_write_b128 v15, v[64:67] offset:1536
    v_smfmac_f32_16x16x64_bf16 v[76:79], v[16:19], v[176:183], v10
    s_nop 1
    v_smfmac_f32_16x16x64_bf16 v[76:79], v[20:23], v[184:191], v10
    s_nop 1
    v_smfmac_f32_16x16x64_bf16 v[76:79], v[24:27], v[192:199], v10
    v_permlane32_swap_b32 v72, v73
    v_smfmac_f32_16x16x64_bf16 v[76:79], v[28:31], v[200:207], v10
    s_waitcnt vmcnt(1)
    s_waitcnt lgkmcnt(0)
    s_barrier
    ds_read_b128 v[80:83], v122 offset:0
    ds_read_b128 v[84:87], v122 offset:3072
    v_permlane32_swap_b32 v74, v75
    v_smfmac_f32_16x16x64_bf16 v[76:79], v[32:35], v[208:215], v10
    ds_read_b128 v[88:91], v122 offset:6144
    v_add_f32 v72, v72, v73
    v_smfmac_f32_16x16x64_bf16 v[76:79], v[36:39], v[216:223], v10
    ds_read_b128 v[92:95], v122 offset:9216
    v_add_f32 v74, v74, v75
    v_smfmac_f32_16x16x64_bf16 v[76:79], v[40:43], v[224:231], v10
    v_cvt_pk_bf16_f32 v72, v72, v74
    v_smfmac_f32_16x16x64_bf16 v[76:79], v[44:47], v[232:239], v10
    ds_write_b32 v11, v72 offset:256
    v_smfmac_f32_16x16x64_bf16 v[76:79], v[48:51], v[240:247], v10
    ds_read_b64_tr_b16 v[68:69], v127
    v_smfmac_f32_16x16x64_bf16 v[76:79], v[52:55], v[248:255], v10
    ds_read_b64_tr_b16 v[70:71], v127 offset:256
    s_waitcnt lgkmcnt(5)
    v_add_f32 v80, v80, v84
    v_add_f32 v81, v81, v85
    v_add_f32 v82, v82, v86
    v_add_f32 v83, v83, v87
    s_waitcnt lgkmcnt(3)
    v_add_f32 v88, v88, v92
    v_add_f32 v89, v89, v93
    v_add_f32 v90, v90, v94
    v_add_f32 v91, v91, v95
    v_permlane32_swap_b32 v76, v77
    v_permlane32_swap_b32 v78, v79
    v_add_f32 v76, v76, v77
    v_add_f32 v78, v78, v79
    v_cvt_pk_bf16_f32 v76, v76, v78
    ds_write_b32 v11, v76 offset:512
    ds_read_b64_tr_b16 v[74:75], v127 offset:512
    s_waitcnt lgkmcnt(2)
    v_mfma_f32_16x16x32_bf16 v[56:59], v[68:71], v[60:63], 0
    v_add_f32 v80, v80, v88
    v_add_f32 v81, v81, v89
    v_add_f32 v82, v82, v90
    v_add_f32 v83, v83, v91
    v_mul_f32 v84, s56, v80
    v_mul_f32 v85, s56, v81
    v_mul_f32 v86, s56, v82
    v_mul_f32 v87, s56, v83
    v_max3_f32 v88, abs(v84), abs(v85), abs(v86)
    v_max_f32 v88, v88, abs(v87)
    s_waitcnt lgkmcnt(0)
    v_mfma_f32_16x16x16_bf16 v[56:59], v[74:75], v[124:125], v[56:59]
    v_exp_f32 v84, v84
    v_exp_f32 v85, v85
    s_mul_i32 s37, s59, 98304
    s_add_u32 s37, s37, 196608
    s_memrealtime s[62:63]
    s_nop 2
    v_add_f32_dpp v56, v56, v56 row_ror:8 row_mask:0xf bank_mask:0xf
    v_add_f32_dpp v57, v57, v57 row_ror:8 row_mask:0xf bank_mask:0xf
    v_add_f32_dpp v58, v58, v58 row_ror:8 row_mask:0xf bank_mask:0xf
    v_add_f32_dpp v59, v59, v59 row_ror:8 row_mask:0xf bank_mask:0xf
    s_mov_b32 exec_hi, 0
    ds_write_b128 v126, v[56:59]
    s_mov_b32 exec_hi, -1
    v_exp_f32 v86, v86
    v_exp_f32 v87, v87
    v_add_f32 v89, v84, v85
    s_waitcnt lgkmcnt(0)
    s_barrier
    ds_read_b32 v92, v123 offset:0
    ds_read_b32 v93, v123 offset:1536
    ds_read_b32 v94, v123 offset:3072
    ds_read_b32 v95, v123 offset:4608
    v_add_f32 v90, v86, v87
    v_add_f32 v89, v89, v90
    s_waitcnt lgkmcnt(2)
    v_add_f32 v92, v92, v93
    s_waitcnt lgkmcnt(0)
    v_add_f32 v94, v94, v95
    v_add_f32 v92, v92, v94
    v_mul_f32 v93, s56, v92
    v_max_f32 v88, v88, abs(v93)
    v_exp_f32 v93, v93
    v_cmp_nge_f32 vcc, s45, v88
    s_cbranch_vccnz cq_slow_10
    v_add_f32 v89, v89, v93
    s_nop 1
    v_add_f32_dpp v89, v89, v89 row_ror:8 row_mask:0xf bank_mask:0xf
    v_mov_b32 v90, v89
    s_nop 1
    v_permlane16_swap_b32 v89, v90
    v_add_f32 v89, v89, v90
    v_mov_b32 v90, v89
    s_nop 1
    v_permlane32_swap_b32 v89, v90
    v_add_f32 v89, v89, v90
    v_rcp_f32 v89, v89
    s_nop 0
    v_mul_f32 v93, v93, v89
    v_mul_f32 v84, v84, v89
    v_mul_f32 v85, v85, v89
    v_mul_f32 v86, v86, v89
    v_mul_f32 v87, v87, v89
cq_back_11:
    v_mov_b32_dpp v40, v93 row_ror:8 row_mask:0xf bank_mask:0xf
    v_cvt_pk_bf16_f32 v36, v84, v85
    v_cvt_pk_bf16_f32 v37, v86, v87
    v_cvt_pk_bf16_f32 v40, v93, v40
    v_mov_b32 v38, v36
    v_mov_b32 v39, v37
    v_mov_b32 v41, v40
    v_permlane16_swap_b32 v36, v38
    v_permlane16_swap_b32 v37, v39
    v_permlane16_swap_b32 v40, v41
    s_cmp_gt_u32 s12, 1
    s_cbranch_scc1 n0_13
    s_cmp_eq_u32 s12, 1
    s_cbranch_scc1 n0_13m
    buffer_store_dwordx4 v[36:39], v13, s[4:7], s37 offen sc1
    s_branch n0_13
n0_13m:
    s_mov_b32 exec_lo, 0x00ff00ff
    s_mov_b32 exec_hi, 0x00ff00ff
    buffer_store_dwordx2 v[40:41], v14, s[4:7], s37 offen sc1
    s_mov_b64 exec, -1
n0_13:
    v_mfma_f32_16x16x32_bf16 v[16:19], v[68:71], v[108:111], 0
    v_add_u32 v15, s16, v126
    v_add_u32 v40, s17, v122
    v_mfma_f32_16x16x32_bf16 v[20:23], v[96:99], v[108:111], 0
    v_add_u32 v41, s18, v123
    v_and_b32 v45, 7, v1
    v_mfma_f32_16x16x32_bf16 v[80:83], v[68:71], v[112:115], 0
    v_lshlrev_b32 v45, 4, v45
    v_lshrrev_b32 v44, 4, v1
    v_mfma_f32_16x16x32_bf16 v[84:87], v[96:99], v[112:115], 0
    v_lshlrev_b32 v44, 8, v44
    v_add3_u32 v44, v44, v45, s19
    v_mfma_f32_16x16x32_bf16 v[88:91], v[100:103], v[112:115], 0
    v_add_u32 v45, s20, v45
    v_mov_b32 v43, 0xf149f2ca
    v_mfma_f32_16x16x16_bf16 v[16:19], v[74:75], v[116:117], v[16:19]
    v_add_u32 v2, s21, v9
    v_mfma_f32_16x16x16_bf16 v[20:23], v[104:105], v[116:117], v[20:23]
    v_mfma_f32_16x16x16_bf16 v[80:83], v[74:75], v[118:119], v[80:83]
    v_mfma_f32_16x16x16_bf16 v[84:87], v[104:105], v[118:119], v[84:87]
    v_mfma_f32_16x16x16_bf16 v[88:91], v[106:107], v[118:119], v[88:91]
    s_lshl_b32 s32, s36, 5
    s_add_u32 s32, s32, s14
    s_mul_i32 s47, s32, 2560
    s_add_u32 s47, s47, 163577856
    s_mov_b32 s35, s36
    s_add_u32 s36, s36, 1
    v_mov_b32 v3, 162560
    ds_read_b64 v[46:47], v3
    s_waitcnt lgkmcnt(0)
    v_min_u32 v46, v46, v47
    s_nop 0
    v_readfirstlane_b32 s32, v46
    s_max_u32 s38, s38, s32
    s_cmp_lg_u32 s12, 2
    s_cbranch_scc1 n1_14
    s_and_b32 s32, s35, 1
    s_lshl_b32 s32, s32, 14
    s_lshl_b32 s33, s14, 7
    s_add_u32 s32, s32, s33
    s_add_u32 s32, s32, s58
    s_add_u32 s32, s32, 1867776
    v_mov_b32 v46, s62
    v_mov_b32 v47, s35
    v_mov_b32 v48, 0
    s_mov_b64 exec, 1
    buffer_store_dwordx2 v[46:47], v48, s[4:7], s32 offen sc1
    s_mov_b64 exec, -1
n1_14:
    s_and_b32 s46, s35, 3
    s_lshl_b32 s46, s46, 14
    s_add_u32 s46, s46, s58
    s_add_u32 s46, s46, 1802240
    v_min_u32 v54, 39, v1
    v_lshlrev_b32 v54, 7, v54
    buffer_load_dwordx2 v[52:53], v54, s[4:7], s46 offen sc1
    s_add_u32 s43, s36, 1
    s_min_u32 s43, s43, 64
    s_cmp_ge_u32 s38, s43
    s_cbranch_scc1 kq_ok_15
    s_mov_b32 s39, 0
    s_lshl_b32 s32, s14, 7
    s_add_u32 s32, s32, 2162688
    v_mov_b32 v46, s32
    s_mov_b32 s33, 0x1000
kq_16:
    buffer_load_dword v47, v46, s[4:7], 0 offen sc1
    buffer_load_dword v48, v46, s[4:7], s33 offen sc1
    s_waitcnt vmcnt(0)
    v_min_u32 v47, v47, v48
    s_nop 0
    v_readfirstlane_b32 s38, v47
    s_cmp_ge_u32 s38, s43
    s_cbranch_scc1 kq_ok_15
    s_sleep 2
    s_add_u32 s39, s39, 1
    s_cmp_lt_u32 s39, 20000
    s_cbranch_scc1 kq_16
    s_branch L_end
kq_ok_15:
    s_min_u32 s32, s36, 63
    s_mul_i32 s37, s32, 393216
    s_add_u32 s37, s37, s42
    s_add_u32 s32, s37, 29360128
    s_mov_b32 exec_hi, 0
    ds_write_b128 v15, v[16:19] offset:0
    s_mov_b32 exec_hi, -1
    buffer_load_dwordx4 v[96:99], v2, s[4:7], s32 offen offset:0 sc1
    ds_write_b128 v15, v[20:23] offset:1536
    buffer_load_dwordx4 v[100:103], v2, s[4:7], s32 offen offset:1024 sc1
    s_mov_b32 exec_hi, 0
    ds_write_b128 v15, v[80:83] offset:4608
    s_mov_b32 exec_hi, -1
    buffer_load_dwordx4 v[104:107], v2, s[4:7], s32 offen offset:2048 sc1
    s_add_u32 s32, s37, 4194304
    ds_write_b128 v15, v[84:87] offset:6144
    buffer_load_dwordx4 v[108:111], v2, s[4:7], s32 offen offset:0 sc1
    ds_write_b128 v15, v[88:91] offset:7680
    buffer_load_dwordx4 v[112:115], v2, s[4:7], s32 offen offset:1024 sc1
    buffer_load_dwordx4 v[116:119], v2, s[4:7], s32 offen offset:2048 sc1
    s_waitcnt lgkmcnt(0)
    s_barrier
    ds_read_b128 v[16:19], v40 offset:0
    ds_read_b32 v32, v41 offset:0
    ds_read_b128 v[20:23], v40 offset:9216
    ds_read_b32 v33, v41 offset:9216
    ds_read_b128 v[24:27], v40 offset:18432
    ds_read_b32 v34, v41 offset:18432
    ds_read_b128 v[28:31], v40 offset:27648
    ds_read_b32 v35, v41 offset:27648
    v_mov_b32 v56, 0
    v_mov_b32 v57, 0
    v_mov_b32 v58, 0
    v_mov_b32 v59, 0
    v_mov_b32 v60, 0
    v_mov_b32 v61, 0
    v_mov_b32 v62, 0
    v_mov_b32 v63, 0
    v_mov_b32 v64, 0
    v_mov_b32 v65, 0
    v_mov_b32 v66, 0
    v_mov_b32 v67, 0
    v_mov_b32 v68, 0
    v_mov_b32 v69, 0
    v_mov_b32 v70, 0
    v_mov_b32 v71, 0
    v_mov_b32 v72, 0
    v_mov_b32 v73, 0
    v_mov_b32 v74, 0
    v_mov_b32 v75, 0
    v_mov_b32 v76, 0
    v_mov_b32 v77, 0
    v_mov_b32 v78, 0
    v_mov_b32 v79, 0
    s_mov_b32 s39, 0
    s_waitcnt vmcnt(6)
hr_17:
    v_cmp_ne_u32 vcc, s35, v53
    s_cbranch_vccz hro_18
    buffer_load_dwordx2 v[52:53], v54, s[4:7], s46 offen sc1
    s_add_u32 s39, s39, 1
    s_cmp_lt_u32 s39, 20000
    s_waitcnt vmcnt(0)
    s_cbranch_scc1 hr_17
    s_branch L_end
hro_18:
    v_readfirstlane_b32 s34, v52
    s_nop 1
    v_subrev_u32 v52, s34, v52
    s_nop 1
    v_max_i32_dpp v52, v52, v52 quad_perm:[1,0,3,2] row_mask:0xf bank_mask:0xf
    s_nop 1
    v_max_i32_dpp v52, v52, v52 quad_perm:[2,3,0,1] row_mask:0xf bank_mask:0xf
    s_nop 1
    v_max_i32_dpp v52, v52, v52 row_half_mirror row_mask:0xf bank_mask:0xf
    s_nop 1
    v_max_i32_dpp v52, v52, v52 row_mirror row_mask:0xf bank_mask:0xf
    s_nop 0
    v_readlane_b32 s32, v52, 0
    v_readlane_b32 s33, v52, 16
    s_max_i32 s32, s32, s33
    v_readlane_b32 s33, v52, 32
    s_max_i32 s32, s32, s33
    v_readlane_b32 s33, v52, 48
    s_max_i32 s32, s32, s33
    s_add_u32 s32, s32, s34
    s_add_u32 s61, s32, 0
    s_cmp_lg_u32 s12, 3
    s_cbranch_scc1 n3_19
    v_mov_b32 v36, -1
    v_mov_b32 v37, -1
    v_mov_b32 v38, -1
    v_mov_b32 v39, -1
    s_add_u32 s34, s59, 2
    s_cmp_ge_u32 s34, 3
    s_cselect_b32 s32, 3, 0
    s_sub_u32 s34, s34, s32
    s_mul_i32 s37, s34, 98304
    s_add_u32 s37, s37, 196608
    buffer_store_dwordx4 v[36:39], v13, s[4:7], s37 offen sc1
    s_mov_b32 exec_lo, 0x00ff00ff
    s_mov_b32 exec_hi, 0x00ff00ff
    buffer_store_dwordx2 v[36:37], v14, s[4:7], s37 offen sc1
    s_mov_b64 exec, -1
n3_19:
    s_add_u32 s32, s36, 5
    s_min_u32 s32, s32, 64
    s_cmp_ge_u32 s38, s32
    s_cbranch_scc1 npg_20
    s_mov_b32 m0, 162560
    v_mov_b32 v3, 2179200
    s_mov_b64 exec, 3
    buffer_load_dword v3, s[4:7], 0 offen sc1 lds
    s_mov_b64 exec, -1
npg_20:
    s_waitcnt lgkmcnt(0)
    s_barrier
    s_add_u32 s59, s59, 1
    s_cmp_eq_u32 s59, 3
    s_cselect_b32 s59, 0, s59
    s_cmp_lt_u32 s36, 64
    s_cbranch_scc1 cq_loop_6
    v_add_f32 v16, v16, v20
    v_add_f32 v17, v17, v21
    v_add_f32 v18, v18, v22
    v_add_f32 v19, v19, v23
    v_add_f32 v32, v32, v33
    v_add_f32 v24, v24, v28
    v_add_f32 v25, v25, v29
    v_add_f32 v26, v26, v30
    v_add_f32 v27, v27, v31
    v_add_f32 v34, v34, v35
    v_add_f32 v16, v16, v24
    v_add_f32 v17, v17, v25
    v_add_f32 v18, v18, v26
    v_add_f32 v19, v19, v27
    v_add_f32 v20, v32, v34
    v_cndmask_b32 v16, v16, v43, s[64:65]
    v_cndmask_b32 v17, v17, v43, s[66:67]
    v_cndmask_b32 v18, v18, v43, s[68:69]
    v_cndmask_b32 v19, v19, v43, s[70:71]
    v_max3_f32 v21, v16, v17, v18
    v_max3_f32 v21, v21, v19, v20
    s_nop 1
    v_max_f32_dpp v21, v21, v21 row_ror:8 row_mask:0xf bank_mask:0xf
    v_mov_b32 v22, v21
    s_nop 1
    v_permlane16_swap_b32 v21, v22
    v_max_f32 v21, v21, v22
    v_mov_b32 v22, v21
    s_nop 1
    v_permlane32_swap_b32 v21, v22
    v_max_f32 v21, v21, v22
    v_mul_f32 v21, s57, v21
    v_fma_f32 v16, v16, s56, v21
    v_fma_f32 v17, v17, s56, v21
    v_fma_f32 v18, v18, s56, v21
    v_fma_f32 v19, v19, s56, v21
    v_fma_f32 v20, v20, s56, v21
    v_exp_f32 v16, v16
    v_exp_f32 v17, v17
    v_exp_f32 v18, v18
    v_exp_f32 v19, v19
    v_exp_f32 v20, v20
    v_add_f32 v21, v16, v17
    v_add_f32 v22, v18, v19
    v_add_f32 v21, v21, v20
    v_add_f32 v21, v21, v22
    s_nop 1
    v_add_f32_dpp v21, v21, v21 row_ror:8 row_mask:0xf bank_mask:0xf
    v_mov_b32 v22, v21
    s_nop 1
    v_permlane16_swap_b32 v21, v22
    v_add_f32 v21, v21, v22
    v_mov_b32 v22, v21
    s_nop 1
    v_permlane32_swap_b32 v21, v22
    v_add_f32 v21, v21, v22
    v_rcp_f32 v21, v21
    s_nop 0
    v_mul_f32 v16, v16, v21
    v_mul_f32 v17, v17, v21
    v_mul_f32 v18, v18, v21
    v_mul_f32 v19, v19, v21
    v_mul_f32 v20, v20, v21
    v_cvt_pk_bf16_f32 v24, v16, v17
    v_cvt_pk_bf16_f32 v26, v18, v19
    v_mov_b32_dpp v28, v20 row_ror:8 row_mask:0xf bank_mask:0xf
    v_mov_b32_dpp v25, v24 row_ror:8 row_mask:0xf bank_mask:0xf
    v_mov_b32_dpp v27, v26 row_ror:8 row_mask:0xf bank_mask:0xf
    v_cvt_pk_bf16_f32 v28, v20, v28
    s_mov_b32 exec_lo, 0x00ff00ff
    s_mov_b32 exec_hi, 0x00ff00ff
    buffer_store_dwordx4 v[24:27], v44, s[4:7], s47 offen sc1
    s_mov_b64 exec, -1
    v_mov_b32 v30, v28
    s_nop 1
    v_permlane16_swap_b32 v28, v30
    v_mov_b32 v29, v28
    v_mov_b32 v31, v30
    s_nop 0
    v_permlane32_swap_b32 v28, v29
    v_permlane32_swap_b32 v30, v31
    s_mov_b64 exec, 0xff
    buffer_store_dwordx4 v[28:31], v45, s[4:7], s47 offen sc1
    s_mov_b64 exec, -1
    s_waitcnt vmcnt(0)
    s_barrier
    s_cmp_lg_u32 s12, 0
    s_cbranch_scc1 fs_21
    s_lshl_b32 s32, s14, 7
    s_add_u32 s32, s32, 2187264
    v_mov_b32 v2, 1
    s_mov_b64 exec, 1
    buffer_store_dword v2, off, s[4:7], s32 sc1
    s_mov_b64 exec, -1
fs_21:
    s_endpgm
cq_retry_9:
    s_mul_i32 s37, s59, 65536
    s_add_u32 s37, s37, 32768
    s_waitcnt lgkmcnt(0)
    v_mov_b32 v24, 0
    v_mov_b32 v25, 0
    v_mov_b32 v26, 0
    v_mov_b32 v27, 0
    v_add_u32 v7, 125440, v9
    v_add_u32 v28, s44, v7
fb_22:
    buffer_load_dwordx4 v[16:19], v4, s[4:7], s37 offen sc1
    buffer_load_dwordx4 v[20:23], v5, s[4:7], s37 offen sc1
    s_mov_b32 exec_hi, 0
    buffer_load_dwordx4 v[24:27], v6, s[4:7], s37 offen sc1
    s_mov_b32 exec_hi, -1
    s_add_u32 s55, s55, 1
    s_cmp_gt_u32 s55, 20000
    s_cbranch_scc1 L_end
    s_cmp_lt_u32 s55, 24
    s_cbranch_scc1 ns_23
    s_sleep 2
ns_23:
    s_waitcnt vmcnt(0)
    v_max3_u32 v29, v16, v17, v18
    v_max3_u32 v29, v29, v19, v20
    v_max3_u32 v29, v29, v21, v22
    v_max3_u32 v29, v29, v23, v24
    v_max3_u32 v29, v29, v25, v26
    v_max_u32 v29, v29, v27
    v_cmp_eq_u32 vcc, -1, v29
    s_cbranch_vccnz fb_22
    ds_write_b128 v28, v[16:19]
    ds_write_b128 v28, v[20:23] offset:1024
    s_mov_b32 exec_hi, 0
    ds_write_b128 v28, v[24:27] offset:2048
    s_mov_b32 exec_hi, -1
    ds_read_b128 v[80:83], v120 offset:0
    ds_read_b128 v[84:87], v120 offset:1024
    ds_read_b128 v[88:91], v120 offset:2048
    ds_read_b128 v[92:95], v120 offset:3072
    v_mov_b32 v56, 0
    v_mov_b32 v57, 0
    v_mov_b32 v58, 0
    v_mov_b32 v59, 0
    v_mov_b32 v60, 0
    v_mov_b32 v61, 0
    v_mov_b32 v62, 0
    v_mov_b32 v63, 0
    v_mov_b32 v64, 0
    v_mov_b32 v65, 0
    v_mov_b32 v66, 0
    v_mov_b32 v67, 0
    s_waitcnt lgkmcnt(0)
    s_branch cq_go_8
cq_slow_10:
    v_mov_b32 v84, v80
    v_mov_b32 v85, v81
    v_mov_b32 v86, v82
    v_mov_b32 v87, v83
    v_mov_b32 v93, v92
    v_max3_f32 v88, v84, v85, v86
    v_max3_f32 v88, v88, v87, v93
    s_nop 1
    v_max_f32_dpp v88, v88, v88 row_ror:8 row_mask:0xf bank_mask:0xf
    v_mov_b32 v89, v88
    s_nop 1
    v_permlane16_swap_b32 v88, v89
    v_max_f32 v88, v88, v89
    v_mov_b32 v89, v88
    s_nop 1
    v_permlane32_swap_b32 v88, v89
    v_max_f32 v88, v88, v89
    v_mul_f32 v88, s57, v88
    v_fma_f32 v84, v84, s56, v88
    v_fma_f32 v85, v85, s56, v88
    v_fma_f32 v86, v86, s56, v88
    v_fma_f32 v87, v87, s56, v88
    v_fma_f32 v93, v93, s56, v88
    v_exp_f32 v84, v84
    v_exp_f32 v85, v85
    v_exp_f32 v86, v86
    v_exp_f32 v87, v87
    v_exp_f32 v93, v93
    v_add_f32 v88, v84, v85
    v_add_f32 v89, v86, v87
    v_add_f32 v88, v88, v93
    v_add_f32 v88, v88, v89
    s_nop 1
    v_add_f32_dpp v88, v88, v88 row_ror:8 row_mask:0xf bank_mask:0xf
    v_mov_b32 v89, v88
    s_nop 1
    v_permlane16_swap_b32 v88, v89
    v_add_f32 v88, v88, v89
    v_mov_b32 v89, v88
    s_nop 1
    v_permlane32_swap_b32 v88, v89
    v_add_f32 v88, v88, v89
    v_rcp_f32 v88, v88
    s_nop 0
    v_mul_f32 v84, v84, v88
    v_mul_f32 v85, v85, v88
    v_mul_f32 v86, v86, v88
    v_mul_f32 v87, v87, v88
    v_mul_f32 v93, v93, v88
    s_nop 0
    s_branch cq_back_11
L_end:
    s_endpgm
L_cv:
    s_load_dwordx2 s[16:17], s[0:1], 32
    s_mov_b32 s18, 7864320
    s_mov_b32 s19, 0x20000
    s_load_dwordx2 s[20:21], s[0:1], 40
    s_mov_b32 s22, 7864320
    s_mov_b32 s23, 0x20000
    v_add_u32 v16, 0, v1
    v_mul_u32_u24 v17, 2731, v16
    v_lshrrev_b32 v17, 16, v17
    v_mul_u32_u24 v18, 24, v17
    v_sub_u32 v16, v16, v18
    v_lshlrev_b32 v16, 4, v16
    v_mul_u32_u24 v17, 12288, v17
    v_add_u32 v4, v16, v17
    v_add_u32 v16, 64, v1
    v_mul_u32_u24 v17, 2731, v16
    v_lshrrev_b32 v17, 16, v17
    v_mul_u32_u24 v18, 24, v17
    v_sub_u32 v16, v16, v18
    v_lshlrev_b32 v16, 4, v16
    v_mul_u32_u24 v17, 12288, v17
    v_add_u32 v5, v16, v17
    v_add_u32 v16, 128, v1
    v_mul_u32_u24 v17, 2731, v16
    v_lshrrev_b32 v17, 16, v17
    v_mul_u32_u24 v18, 24, v17
    v_sub_u32 v16, v16, v18
    v_lshlrev_b32 v16, 4, v16
    v_mul_u32_u24 v17, 12288, v17
    v_add_u32 v6, v16, v17
    v_lshrrev_b32 v16, 4, v1
    v_lshlrev_b32 v16, 3, v16
    v_bfe_u32 v17, v1, 2, 2
    v_add_u32 v16, v16, v17
    v_mul_u32_u24 v16, 384, v16
    v_and_b32 v17, 3, v1
    v_lshlrev_b32 v17, 3, v17
    s_mul_i32 s32, s12, 96
    v_add3_u32 v7, v16, v17, s32
    s_mul_i32 s40, s14, 384
    s_mul_i32 s32, s12, 196608
    s_add_u32 s40, s40, s32
    s_mul_i32 s41, s12, 6144
    v_lshlrev_b32 v9, 4, v1
    s_waitcnt lgkmcnt(0)
    s_mul_i32 s42, s14, 245760
    s_mul_i32 s44, s12, 10240
    s_add_u32 s42, s42, s44
    v_lshrrev_b32 v2, 4, v1
    v_lshlrev_b32 v2, 3, v2
    v_bfe_u32 v3, v1, 2, 2
    v_add_u32 v2, v2, v3
    v_mul_u32_u24 v2, 1280, v2
    v_and_b32 v3, 3, v1
    v_lshlrev_b32 v3, 3, v3
    s_mul_i32 s32, s12, 320
    v_add3_u32 v8, v2, v3, s32
    s_add_u32 m0, s41, 0
    s_add_u32 s37, s40, 0
    buffer_load_dwordx4 v4, s[16:19], s37 offen lds
    s_add_u32 m0, s41, 1024
    s_add_u32 s37, s40, 0
    buffer_load_dwordx4 v5, s[16:19], s37 offen lds
    s_add_u32 m0, s41, 2048
    s_add_u32 s37, s40, 0
    buffer_load_dwordx4 v6, s[16:19], s37 offen lds
    s_add_u32 m0, s41, 3072
    s_add_u32 s37, s40, 98304
    buffer_load_dwordx4 v4, s[16:19], s37 offen lds
    s_add_u32 m0, s41, 4096
    s_add_u32 s37, s40, 98304
    buffer_load_dwordx4 v5, s[16:19], s37 offen lds
    s_add_u32 m0, s41, 5120
    s_add_u32 s37, s40, 98304
    buffer_load_dwordx4 v6, s[16:19], s37 offen lds
    s_add_u32 m0, s44, 24576
    s_add_u32 s37, s42, 0
    buffer_load_dwordx4 v9, s[20:23], s37 offen offset:0 lds
    buffer_load_dwordx4 v9, s[20:23], s37 offen offset:1024 lds
    buffer_load_dwordx4 v9, s[20:23], s37 offen offset:2048 lds
    buffer_load_dwordx4 v9, s[20:23], s37 offen offset:3072 lds
    s_add_u32 m0, s44, 28672
    s_add_u32 s37, s42, 4096
    buffer_load_dwordx4 v9, s[20:23], s37 offen offset:0 lds
    buffer_load_dwordx4 v9, s[20:23], s37 offen offset:1024 lds
    buffer_load_dwordx4 v9, s[20:23], s37 offen offset:2048 lds
    buffer_load_dwordx4 v9, s[20:23], s37 offen offset:3072 lds
    s_add_u32 m0, s44, 32768
    s_add_u32 s37, s42, 8192
    buffer_load_dwordx4 v9, s[20:23], s37 offen offset:0 lds
    buffer_load_dwordx4 v9, s[20:23], s37 offen offset:1024 lds
    s_add_u32 m0, s41, 65536
    s_add_u32 s37, s40, 786432
    buffer_load_dwordx4 v4, s[16:19], s37 offen lds
    s_add_u32 m0, s41, 66560
    s_add_u32 s37, s40, 786432
    buffer_load_dwordx4 v5, s[16:19], s37 offen lds
    s_add_u32 m0, s41, 67584
    s_add_u32 s37, s40, 786432
    buffer_load_dwordx4 v6, s[16:19], s37 offen lds
    s_add_u32 m0, s41, 68608
    s_add_u32 s37, s40, 884736
    buffer_load_dwordx4 v4, s[16:19], s37 offen lds
    s_add_u32 m0, s41, 69632
    s_add_u32 s37, s40, 884736
    buffer_load_dwordx4 v5, s[16:19], s37 offen lds
    s_add_u32 m0, s41, 70656
    s_add_u32 s37, s40, 884736
    buffer_load_dwordx4 v6, s[16:19], s37 offen lds
    s_add_u32 m0, s41, 90112
    s_add_u32 s37, s40, 1572864
    buffer_load_dwordx4 v4, s[16:19], s37 offen lds
    s_add_u32 m0, s41, 91136
    s_add_u32 s37, s40, 1572864
    buffer_load_dwordx4 v5, s[16:19], s37 offen lds
    s_add_u32 m0, s41, 92160
    s_add_u32 s37, s40, 1572864
    buffer_load_dwordx4 v6, s[16:19], s37 offen lds
    s_add_u32 m0, s41, 93184
    s_add_u32 s37, s40, 1671168
    buffer_load_dwordx4 v4, s[16:19], s37 offen lds
    s_add_u32 m0, s41, 94208
    s_add_u32 s37, s40, 1671168
    buffer_load_dwordx4 v5, s[16:19], s37 offen lds
    s_add_u32 m0, s41, 95232
    s_add_u32 s37, s40, 1671168
    buffer_load_dwordx4 v6, s[16:19], s37 offen lds
    s_add_u32 m0, s44, 114688
    s_add_u32 s37, s42, 40960
    buffer_load_dwordx4 v9, s[20:23], s37 offen offset:0 lds
    buffer_load_dwordx4 v9, s[20:23], s37 offen offset:1024 lds
    buffer_load_dwordx4 v9, s[20:23], s37 offen offset:2048 lds
    buffer_load_dwordx4 v9, s[20:23], s37 offen offset:3072 lds
    s_add_u32 m0, s44, 118784
    s_add_u32 s37, s42, 45056
    buffer_load_dwordx4 v9, s[20:23], s37 offen offset:0 lds
    buffer_load_dwordx4 v9, s[20:23], s37 offen offset:1024 lds
    buffer_load_dwordx4 v9, s[20:23], s37 offen offset:2048 lds
    buffer_load_dwordx4 v9, s[20:23], s37 offen offset:3072 lds
    s_add_u32 m0, s44, 122880
    s_add_u32 s37, s42, 49152
    buffer_load_dwordx4 v9, s[20:23], s37 offen offset:0 lds
    buffer_load_dwordx4 v9, s[20:23], s37 offen offset:1024 lds
    s_waitcnt vmcnt(32)
    s_barrier
    v_add_u32 v3, 0, v7
    ds_read_b64_tr_b16 a[0:1], v3 offset:0
    ds_read_b64_tr_b16 a[2:3], v3 offset:1536
    ds_read_b64_tr_b16 a[4:5], v3 offset:12288
    ds_read_b64_tr_b16 a[6:7], v3 offset:13824
    ds_read_b64_tr_b16 a[8:9], v3 offset:32
    ds_read_b64_tr_b16 a[10:11], v3 offset:1568
    ds_read_b64_tr_b16 a[12:13], v3 offset:12320
    ds_read_b64_tr_b16 a[14:15], v3 offset:13856
    ds_read_b64_tr_b16 a[16:17], v3 offset:64
    ds_read_b64_tr_b16 a[18:19], v3 offset:1600
    ds_read_b64_tr_b16 a[20:21], v3 offset:12352
    ds_read_b64_tr_b16 a[22:23], v3 offset:13888
    s_waitcnt lgkmcnt(0)
    s_waitcnt vmcnt(22)
    s_barrier
    v_add_u32 v3, 24576, v8
    ds_read_b64_tr_b16 v[96:97], v3 offset:0
    ds_read_b64_tr_b16 v[98:99], v3 offset:5120
    ds_read_b64_tr_b16 a[168:169], v3 offset:32
    ds_read_b64_tr_b16 a[170:171], v3 offset:5152
    ds_read_b64_tr_b16 a[192:193], v3 offset:64
    ds_read_b64_tr_b16 a[194:195], v3 offset:5184
    ds_read_b64_tr_b16 a[216:217], v3 offset:96
    ds_read_b64_tr_b16 a[218:219], v3 offset:5216
    ds_read_b64_tr_b16 a[240:241], v3 offset:128
    ds_read_b64_tr_b16 a[242:243], v3 offset:5248
    ds_read_b64_tr_b16 v[136:137], v3 offset:160
    ds_read_b64_tr_b16 v[138:139], v3 offset:5280
    s_waitcnt lgkmcnt(6)
    ds_read_b64_tr_b16 v[160:161], v3 offset:192
    ds_read_b64_tr_b16 v[162:163], v3 offset:5312
    ds_read_b64_tr_b16 v[184:185], v3 offset:224
    ds_read_b64_tr_b16 v[186:187], v3 offset:5344
    ds_read_b64_tr_b16 v[208:209], v3 offset:256
    ds_read_b64_tr_b16 v[210:211], v3 offset:5376
    ds_read_b64_tr_b16 v[232:233], v3 offset:288
    ds_read_b64_tr_b16 v[234:235], v3 offset:5408
    s_add_u32 m0, s41, 0
    s_add_u32 s37, s40, 2359296
    buffer_load_dwordx4 v4, s[16:19], s37 offen lds
    s_add_u32 m0, s41, 1024
    s_add_u32 s37, s40, 2359296
    buffer_load_dwordx4 v5, s[16:19], s37 offen lds
    s_add_u32 m0, s41, 2048
    s_add_u32 s37, s40, 2359296
    buffer_load_dwordx4 v6, s[16:19], s37 offen lds
    s_add_u32 m0, s41, 3072
    s_add_u32 s37, s40, 2457600
    buffer_load_dwordx4 v4, s[16:19], s37 offen lds
    s_add_u32 m0, s41, 4096
    s_add_u32 s37, s40, 2457600
    buffer_load_dwordx4 v5, s[16:19], s37 offen lds
    s_add_u32 m0, s41, 5120
    s_add_u32 s37, s40, 2457600
    buffer_load_dwordx4 v6, s[16:19], s37 offen lds
    s_waitcnt lgkmcnt(0)
    s_waitcnt vmcnt(22)
    s_barrier
    v_add_u32 v3, 65536, v7
    ds_read_b64_tr_b16 a[24:25], v3 offset:0
    ds_read_b64_tr_b16 a[26:27], v3 offset:1536
    ds_read_b64_tr_b16 a[28:29], v3 offset:12288
    ds_read_b64_tr_b16 a[30:31], v3 offset:13824
    ds_read_b64_tr_b16 a[32:33], v3 offset:32
    ds_read_b64_tr_b16 a[34:35], v3 offset:1568
    ds_read_b64_tr_b16 a[36:37], v3 offset:12320
    ds_read_b64_tr_b16 a[38:39], v3 offset:13856
    ds_read_b64_tr_b16 v[16:17], v3 offset:64
    ds_read_b64_tr_b16 v[18:19], v3 offset:1600
    ds_read_b64_tr_b16 v[20:21], v3 offset:12352
    ds_read_b64_tr_b16 v[22:23], v3 offset:13888
    s_add_u32 m0, s44, 24576
    s_add_u32 s37, s42, 81920
    buffer_load_dwordx4 v9, s[20:23], s37 offen offset:0 lds
    buffer_load_dwordx4 v9, s[20:23], s37 offen offset:1024 lds
    buffer_load_dwordx4 v9, s[20:23], s37 offen offset:2048 lds
    buffer_load_dwordx4 v9, s[20:23], s37 offen offset:3072 lds
    s_add_u32 m0, s44, 28672
    s_add_u32 s37, s42, 86016
    buffer_load_dwordx4 v9, s[20:23], s37 offen offset:0 lds
    buffer_load_dwordx4 v9, s[20:23], s37 offen offset:1024 lds
    buffer_load_dwordx4 v9, s[20:23], s37 offen offset:2048 lds
    buffer_load_dwordx4 v9, s[20:23], s37 offen offset:3072 lds
    s_add_u32 m0, s44, 32768
    s_add_u32 s37, s42, 90112
    buffer_load_dwordx4 v9, s[20:23], s37 offen offset:0 lds
    buffer_load_dwordx4 v9, s[20:23], s37 offen offset:1024 lds
    s_waitcnt lgkmcnt(0)
    s_waitcnt vmcnt(26)
    s_barrier
    v_add_u32 v3, 90112, v7
    ds_read_b64_tr_b16 a[40:41], v3 offset:0
    ds_read_b64_tr_b16 a[42:43], v3 offset:1536
    ds_read_b64_tr_b16 a[44:45], v3 offset:12288
    ds_read_b64_tr_b16 a[46:47], v3 offset:13824
    ds_read_b64_tr_b16 v[24:25], v3 offset:32
    ds_read_b64_tr_b16 v[26:27], v3 offset:1568
    ds_read_b64_tr_b16 v[28:29], v3 offset:12320
    ds_read_b64_tr_b16 v[30:31], v3 offset:13856
    ds_read_b64_tr_b16 a[48:49], v3 offset:64
    ds_read_b64_tr_b16 a[50:51], v3 offset:1600
    ds_read_b64_tr_b16 a[52:53], v3 offset:12352
    ds_read_b64_tr_b16 a[54:55], v3 offset:13888
    s_add_u32 m0, s41, 65536
    s_add_u32 s37, s40, 3145728
    buffer_load_dwordx4 v4, s[16:19], s37 offen lds
    s_add_u32 m0, s41, 66560
    s_add_u32 s37, s40, 3145728
    buffer_load_dwordx4 v5, s[16:19], s37 offen lds
    s_add_u32 m0, s41, 67584
    s_add_u32 s37, s40, 3145728
    buffer_load_dwordx4 v6, s[16:19], s37 offen lds
    s_add_u32 m0, s41, 68608
    s_add_u32 s37, s40, 3244032
    buffer_load_dwordx4 v4, s[16:19], s37 offen lds
    s_add_u32 m0, s41, 69632
    s_add_u32 s37, s40, 3244032
    buffer_load_dwordx4 v5, s[16:19], s37 offen lds
    s_add_u32 m0, s41, 70656
    s_add_u32 s37, s40, 3244032
    buffer_load_dwordx4 v6, s[16:19], s37 offen lds
    s_waitcnt lgkmcnt(0)
    s_waitcnt vmcnt(22)
    s_barrier
    v_add_u32 v3, 114688, v8
    ds_read_b64_tr_b16 v[100:101], v3 offset:0
    ds_read_b64_tr_b16 v[102:103], v3 offset:5120
    ds_read_b64_tr_b16 a[172:173], v3 offset:32
    ds_read_b64_tr_b16 a[174:175], v3 offset:5152
    ds_read_b64_tr_b16 a[196:197], v3 offset:64
    ds_read_b64_tr_b16 a[198:199], v3 offset:5184
    ds_read_b64_tr_b16 a[220:221], v3 offset:96
    ds_read_b64_tr_b16 a[222:223], v3 offset:5216
    ds_read_b64_tr_b16 a[244:245], v3 offset:128
    ds_read_b64_tr_b16 a[246:247], v3 offset:5248
    ds_read_b64_tr_b16 v[140:141], v3 offset:160
    ds_read_b64_tr_b16 v[142:143], v3 offset:5280
    s_waitcnt lgkmcnt(6)
    ds_read_b64_tr_b16 v[164:165], v3 offset:192
    ds_read_b64_tr_b16 v[166:167], v3 offset:5312
    ds_read_b64_tr_b16 v[188:189], v3 offset:224
    ds_read_b64_tr_b16 v[190:191], v3 offset:5344
    ds_read_b64_tr_b16 v[212:213], v3 offset:256
    ds_read_b64_tr_b16 v[214:215], v3 offset:5376
    ds_read_b64_tr_b16 v[236:237], v3 offset:288
    ds_read_b64_tr_b16 v[238:239], v3 offset:5408
    s_add_u32 m0, s41, 90112
    s_add_u32 s37, s40, 3932160
    buffer_load_dwordx4 v4, s[16:19], s37 offen lds
    s_add_u32 m0, s41, 91136
    s_add_u32 s37, s40, 3932160
    buffer_load_dwordx4 v5, s[16:19], s37 offen lds
    s_add_u32 m0, s41, 92160
    s_add_u32 s37, s40, 3932160
    buffer_load_dwordx4 v6, s[16:19], s37 offen lds
    s_add_u32 m0, s41, 93184
    s_add_u32 s37, s40, 4030464
    buffer_load_dwordx4 v4, s[16:19], s37 offen lds
    s_add_u32 m0, s41, 94208
    s_add_u32 s37, s40, 4030464
    buffer_load_dwordx4 v5, s[16:19], s37 offen lds
    s_add_u32 m0, s41, 95232
    s_add_u32 s37, s40, 4030464
    buffer_load_dwordx4 v6, s[16:19], s37 offen lds
    s_waitcnt lgkmcnt(0)
    s_waitcnt vmcnt(22)
    s_barrier
    v_add_u32 v3, 0, v7
    ds_read_b64_tr_b16 a[56:57], v3 offset:0
    ds_read_b64_tr_b16 a[58:59], v3 offset:1536
    ds_read_b64_tr_b16 a[60:61], v3 offset:12288
    ds_read_b64_tr_b16 a[62:63], v3 offset:13824
    ds_read_b64_tr_b16 v[32:33], v3 offset:32
    ds_read_b64_tr_b16 v[34:35], v3 offset:1568
    ds_read_b64_tr_b16 v[36:37], v3 offset:12320
    ds_read_b64_tr_b16 v[38:39], v3 offset:13856
    ds_read_b64_tr_b16 a[64:65], v3 offset:64
    ds_read_b64_tr_b16 a[66:67], v3 offset:1600
    ds_read_b64_tr_b16 a[68:69], v3 offset:12352
    ds_read_b64_tr_b16 a[70:71], v3 offset:13888
    s_add_u32 m0, s44, 114688
    s_add_u32 s37, s42, 122880
    buffer_load_dwordx4 v9, s[20:23], s37 offen offset:0 lds
    buffer_load_dwordx4 v9, s[20:23], s37 offen offset:1024 lds
    buffer_load_dwordx4 v9, s[20:23], s37 offen offset:2048 lds
    buffer_load_dwordx4 v9, s[20:23], s37 offen offset:3072 lds
    s_add_u32 m0, s44, 118784
    s_add_u32 s37, s42, 126976
    buffer_load_dwordx4 v9, s[20:23], s37 offen offset:0 lds
    buffer_load_dwordx4 v9, s[20:23], s37 offen offset:1024 lds
    buffer_load_dwordx4 v9, s[20:23], s37 offen offset:2048 lds
    buffer_load_dwordx4 v9, s[20:23], s37 offen offset:3072 lds
    s_add_u32 m0, s44, 122880
    s_add_u32 s37, s42, 131072
    buffer_load_dwordx4 v9, s[20:23], s37 offen offset:0 lds
    buffer_load_dwordx4 v9, s[20:23], s37 offen offset:1024 lds
    s_waitcnt lgkmcnt(0)
    s_waitcnt vmcnt(22)
    s_barrier
    v_add_u32 v3, 24576, v8
    ds_read_b64_tr_b16 a[160:161], v3 offset:0
    ds_read_b64_tr_b16 a[162:163], v3 offset:5120
    ds_read_b64_tr_b16 a[176:177], v3 offset:32
    ds_read_b64_tr_b16 a[178:179], v3 offset:5152
    ds_read_b64_tr_b16 a[200:201], v3 offset:64
    ds_read_b64_tr_b16 a[202:203], v3 offset:5184
    ds_read_b64_tr_b16 a[224:225], v3 offset:96
    ds_read_b64_tr_b16 a[226:227], v3 offset:5216
    ds_read_b64_tr_b16 a[248:249], v3 offset:128
    ds_read_b64_tr_b16 a[250:251], v3 offset:5248
    ds_read_b64_tr_b16 v[144:145], v3 offset:160
    ds_read_b64_tr_b16 v[146:147], v3 offset:5280
    s_waitcnt lgkmcnt(6)
    ds_read_b64_tr_b16 v[168:169], v3 offset:192
    ds_read_b64_tr_b16 v[170:171], v3 offset:5312
    ds_read_b64_tr_b16 v[192:193], v3 offset:224
    ds_read_b64_tr_b16 v[194:195], v3 offset:5344
    ds_read_b64_tr_b16 v[216:217], v3 offset:256
    ds_read_b64_tr_b16 v[218:219], v3 offset:5376
    ds_read_b64_tr_b16 v[240:241], v3 offset:288
    ds_read_b64_tr_b16 v[242:243], v3 offset:5408
    s_add_u32 m0, s41, 0
    s_add_u32 s37, s40, 4718592
    buffer_load_dwordx4 v4, s[16:19], s37 offen lds
    s_add_u32 m0, s41, 1024
    s_add_u32 s37, s40, 4718592
    buffer_load_dwordx4 v5, s[16:19], s37 offen lds
    s_add_u32 m0, s41, 2048
    s_add_u32 s37, s40, 4718592
    buffer_load_dwordx4 v6, s[16:19], s37 offen lds
    s_add_u32 m0, s41, 3072
    s_add_u32 s37, s40, 4816896
    buffer_load_dwordx4 v4, s[16:19], s37 offen lds
    s_add_u32 m0, s41, 4096
    s_add_u32 s37, s40, 4816896
    buffer_load_dwordx4 v5, s[16:19], s37 offen lds
    s_add_u32 m0, s41, 5120
    s_add_u32 s37, s40, 4816896
    buffer_load_dwordx4 v6, s[16:19], s37 offen lds
    s_waitcnt lgkmcnt(0)
    s_waitcnt vmcnt(22)
    s_barrier
    v_add_u32 v3, 65536, v7
    ds_read_b64_tr_b16 v[40:41], v3 offset:0
    ds_read_b64_tr_b16 v[42:43], v3 offset:1536
    ds_read_b64_tr_b16 v[44:45], v3 offset:12288
    ds_read_b64_tr_b16 v[46:47], v3 offset:13824
    ds_read_b64_tr_b16 a[72:73], v3 offset:32
    ds_read_b64_tr_b16 a[74:75], v3 offset:1568
    ds_read_b64_tr_b16 a[76:77], v3 offset:12320
    ds_read_b64_tr_b16 a[78:79], v3 offset:13856
    ds_read_b64_tr_b16 a[80:81], v3 offset:64
    ds_read_b64_tr_b16 a[82:83], v3 offset:1600
    ds_read_b64_tr_b16 a[84:85], v3 offset:12352
    ds_read_b64_tr_b16 a[86:87], v3 offset:13888
    s_add_u32 m0, s41, 24576
    s_add_u32 s37, s40, 5505024
    buffer_load_dwordx4 v4, s[16:19], s37 offen lds
    s_add_u32 m0, s41, 25600
    s_add_u32 s37, s40, 5505024
    buffer_load_dwordx4 v5, s[16:19], s37 offen lds
    s_add_u32 m0, s41, 26624
    s_add_u32 s37, s40, 5505024
    buffer_load_dwordx4 v6, s[16:19], s37 offen lds
    s_add_u32 m0, s41, 27648
    s_add_u32 s37, s40, 5603328
    buffer_load_dwordx4 v4, s[16:19], s37 offen lds
    s_add_u32 m0, s41, 28672
    s_add_u32 s37, s40, 5603328
    buffer_load_dwordx4 v5, s[16:19], s37 offen lds
    s_add_u32 m0, s41, 29696
    s_add_u32 s37, s40, 5603328
    buffer_load_dwordx4 v6, s[16:19], s37 offen lds
    s_waitcnt lgkmcnt(0)
    s_waitcnt vmcnt(22)
    s_barrier
    v_add_u32 v3, 90112, v7
    ds_read_b64_tr_b16 v[48:49], v3 offset:0
    ds_read_b64_tr_b16 v[50:51], v3 offset:1536
    ds_read_b64_tr_b16 v[52:53], v3 offset:12288
    ds_read_b64_tr_b16 v[54:55], v3 offset:13824
    ds_read_b64_tr_b16 a[88:89], v3 offset:32
    ds_read_b64_tr_b16 a[90:91], v3 offset:1568
    ds_read_b64_tr_b16 a[92:93], v3 offset:12320
    ds_read_b64_tr_b16 a[94:95], v3 offset:13856
    ds_read_b64_tr_b16 v[56:57], v3 offset:64
    ds_read_b64_tr_b16 v[58:59], v3 offset:1600
    ds_read_b64_tr_b16 v[60:61], v3 offset:12352
    ds_read_b64_tr_b16 v[62:63], v3 offset:13888
    s_add_u32 m0, s44, 49152
    s_add_u32 s37, s42, 163840
    buffer_load_dwordx4 v9, s[20:23], s37 offen offset:0 lds
    buffer_load_dwordx4 v9, s[20:23], s37 offen offset:1024 lds
    buffer_load_dwordx4 v9, s[20:23], s37 offen offset:2048 lds
    buffer_load_dwordx4 v9, s[20:23], s37 offen offset:3072 lds
    s_add_u32 m0, s44, 53248
    s_add_u32 s37, s42, 167936
    buffer_load_dwordx4 v9, s[20:23], s37 offen offset:0 lds
    buffer_load_dwordx4 v9, s[20:23], s37 offen offset:1024 lds
    buffer_load_dwordx4 v9, s[20:23], s37 offen offset:2048 lds
    buffer_load_dwordx4 v9, s[20:23], s37 offen offset:3072 lds
    s_add_u32 m0, s44, 57344
    s_add_u32 s37, s42, 172032
    buffer_load_dwordx4 v9, s[20:23], s37 offen offset:0 lds
    buffer_load_dwordx4 v9, s[20:23], s37 offen offset:1024 lds
    s_waitcnt lgkmcnt(0)
    s_waitcnt vmcnt(22)
    s_barrier
    v_add_u32 v3, 114688, v8
    ds_read_b64_tr_b16 a[164:165], v3 offset:0
    ds_read_b64_tr_b16 a[166:167], v3 offset:5120
    ds_read_b64_tr_b16 a[180:181], v3 offset:32
    ds_read_b64_tr_b16 a[182:183], v3 offset:5152
    ds_read_b64_tr_b16 a[204:205], v3 offset:64
    ds_read_b64_tr_b16 a[206:207], v3 offset:5184
    ds_read_b64_tr_b16 a[228:229], v3 offset:96
    ds_read_b64_tr_b16 a[230:231], v3 offset:5216
    ds_read_b64_tr_b16 a[252:253], v3 offset:128
    ds_read_b64_tr_b16 a[254:255], v3 offset:5248
    ds_read_b64_tr_b16 v[148:149], v3 offset:160
    ds_read_b64_tr_b16 v[150:151], v3 offset:5280
    s_waitcnt lgkmcnt(6)
    ds_read_b64_tr_b16 v[172:173], v3 offset:192
    ds_read_b64_tr_b16 v[174:175], v3 offset:5312
    ds_read_b64_tr_b16 v[196:197], v3 offset:224
    ds_read_b64_tr_b16 v[198:199], v3 offset:5344
    ds_read_b64_tr_b16 v[220:221], v3 offset:256
    ds_read_b64_tr_b16 v[222:223], v3 offset:5376
    ds_read_b64_tr_b16 v[244:245], v3 offset:288
    ds_read_b64_tr_b16 v[246:247], v3 offset:5408
    s_add_u32 m0, s41, 90112
    s_add_u32 s37, s40, 6291456
    buffer_load_dwordx4 v4, s[16:19], s37 offen lds
    s_add_u32 m0, s41, 91136
    s_add_u32 s37, s40, 6291456
    buffer_load_dwordx4 v5, s[16:19], s37 offen lds
    s_add_u32 m0, s41, 92160
    s_add_u32 s37, s40, 6291456
    buffer_load_dwordx4 v6, s[16:19], s37 offen lds
    s_add_u32 m0, s41, 93184
    s_add_u32 s37, s40, 6389760
    buffer_load_dwordx4 v4, s[16:19], s37 offen lds
    s_add_u32 m0, s41, 94208
    s_add_u32 s37, s40, 6389760
    buffer_load_dwordx4 v5, s[16:19], s37 offen lds
    s_add_u32 m0, s41, 95232
    s_add_u32 s37, s40, 6389760
    buffer_load_dwordx4 v6, s[16:19], s37 offen lds
    s_waitcnt lgkmcnt(0)
    s_waitcnt vmcnt(22)
    s_barrier
    v_add_u32 v3, 0, v7
    ds_read_b64_tr_b16 a[96:97], v3 offset:0
    ds_read_b64_tr_b16 a[98:99], v3 offset:1536
    ds_read_b64_tr_b16 a[100:101], v3 offset:12288
    ds_read_b64_tr_b16 a[102:103], v3 offset:13824
    ds_read_b64_tr_b16 v[72:73], v3 offset:32
    ds_read_b64_tr_b16 v[74:75], v3 offset:1568
    ds_read_b64_tr_b16 v[76:77], v3 offset:12320
    ds_read_b64_tr_b16 v[78:79], v3 offset:13856
    ds_read_b64_tr_b16 a[136:137], v3 offset:64
    ds_read_b64_tr_b16 a[138:139], v3 offset:1600
    ds_read_b64_tr_b16 a[140:141], v3 offset:12352
    ds_read_b64_tr_b16 a[142:143], v3 offset:13888
    s_add_u32 m0, s44, 114688
    s_add_u32 s37, s42, 204800
    buffer_load_dwordx4 v9, s[20:23], s37 offen offset:0 lds
    buffer_load_dwordx4 v9, s[20:23], s37 offen offset:1024 lds
    buffer_load_dwordx4 v9, s[20:23], s37 offen offset:2048 lds
    buffer_load_dwordx4 v9, s[20:23], s37 offen offset:3072 lds
    s_add_u32 m0, s44, 118784
    s_add_u32 s37, s42, 208896
    buffer_load_dwordx4 v9, s[20:23], s37 offen offset:0 lds
    buffer_load_dwordx4 v9, s[20:23], s37 offen offset:1024 lds
    buffer_load_dwordx4 v9, s[20:23], s37 offen offset:2048 lds
    buffer_load_dwordx4 v9, s[20:23], s37 offen offset:3072 lds
    s_add_u32 m0, s44, 122880
    s_add_u32 s37, s42, 212992
    buffer_load_dwordx4 v9, s[20:23], s37 offen offset:0 lds
    buffer_load_dwordx4 v9, s[20:23], s37 offen offset:1024 lds
    s_waitcnt lgkmcnt(0)
    s_waitcnt vmcnt(26)
    s_barrier
    v_add_u32 v3, 24576, v7
    ds_read_b64_tr_b16 a[104:105], v3 offset:0
    ds_read_b64_tr_b16 a[106:107], v3 offset:1536
    ds_read_b64_tr_b16 a[108:109], v3 offset:12288
    ds_read_b64_tr_b16 a[110:111], v3 offset:13824
    ds_read_b64_tr_b16 a[120:121], v3 offset:32
    ds_read_b64_tr_b16 a[122:123], v3 offset:1568
    ds_read_b64_tr_b16 a[124:125], v3 offset:12320
    ds_read_b64_tr_b16 a[126:127], v3 offset:13856
    ds_read_b64_tr_b16 v[88:89], v3 offset:64
    ds_read_b64_tr_b16 v[90:91], v3 offset:1600
    ds_read_b64_tr_b16 v[92:93], v3 offset:12352
    ds_read_b64_tr_b16 v[94:95], v3 offset:13888
    s_add_u32 m0, s41, 0
    s_add_u32 s37, s40, 7077888
    buffer_load_dwordx4 v4, s[16:19], s37 offen lds
    s_add_u32 m0, s41, 1024
    s_add_u32 s37, s40, 7077888
    buffer_load_dwordx4 v5, s[16:19], s37 offen lds
    s_add_u32 m0, s41, 2048
    s_add_u32 s37, s40, 7077888
    buffer_load_dwordx4 v6, s[16:19], s37 offen lds
    s_add_u32 m0, s41, 3072
    s_add_u32 s37, s40, 7176192
    buffer_load_dwordx4 v4, s[16:19], s37 offen lds
    s_add_u32 m0, s41, 4096
    s_add_u32 s37, s40, 7176192
    buffer_load_dwordx4 v5, s[16:19], s37 offen lds
    s_add_u32 m0, s41, 5120
    s_add_u32 s37, s40, 7176192
    buffer_load_dwordx4 v6, s[16:19], s37 offen lds
    s_waitcnt lgkmcnt(0)
    s_waitcnt vmcnt(22)
    s_barrier
    v_add_u32 v3, 49152, v8
    ds_read_b64_tr_b16 v[104:105], v3 offset:0
    ds_read_b64_tr_b16 v[106:107], v3 offset:5120
    ds_read_b64_tr_b16 a[184:185], v3 offset:32
    ds_read_b64_tr_b16 a[186:187], v3 offset:5152
    ds_read_b64_tr_b16 a[208:209], v3 offset:64
    ds_read_b64_tr_b16 a[210:211], v3 offset:5184
    ds_read_b64_tr_b16 a[232:233], v3 offset:96
    ds_read_b64_tr_b16 a[234:235], v3 offset:5216
    ds_read_b64_tr_b16 v[128:129], v3 offset:128
    ds_read_b64_tr_b16 v[130:131], v3 offset:5248
    ds_read_b64_tr_b16 v[152:153], v3 offset:160
    ds_read_b64_tr_b16 v[154:155], v3 offset:5280
    s_waitcnt lgkmcnt(6)
    ds_read_b64_tr_b16 v[176:177], v3 offset:192
    ds_read_b64_tr_b16 v[178:179], v3 offset:5312
    ds_read_b64_tr_b16 v[200:201], v3 offset:224
    ds_read_b64_tr_b16 v[202:203], v3 offset:5344
    ds_read_b64_tr_b16 v[224:225], v3 offset:256
    ds_read_b64_tr_b16 v[226:227], v3 offset:5376
    ds_read_b64_tr_b16 v[248:249], v3 offset:288
    ds_read_b64_tr_b16 v[250:251], v3 offset:5408
    s_waitcnt lgkmcnt(0)
    s_waitcnt vmcnt(16)
    s_barrier
    v_add_u32 v3, 90112, v7
    ds_read_b64_tr_b16 v[64:65], v3 offset:0
    ds_read_b64_tr_b16 v[66:67], v3 offset:1536
    ds_read_b64_tr_b16 v[68:69], v3 offset:12288
    ds_read_b64_tr_b16 v[70:71], v3 offset:13824
    ds_read_b64_tr_b16 a[128:129], v3 offset:32
    ds_read_b64_tr_b16 a[130:131], v3 offset:1568
    ds_read_b64_tr_b16 a[132:133], v3 offset:12320
    ds_read_b64_tr_b16 a[134:135], v3 offset:13856
    ds_read_b64_tr_b16 a[144:145], v3 offset:64
    ds_read_b64_tr_b16 a[146:147], v3 offset:1600
    ds_read_b64_tr_b16 a[148:149], v3 offset:12352
    ds_read_b64_tr_b16 a[150:151], v3 offset:13888
    s_waitcnt lgkmcnt(0)
    s_waitcnt vmcnt(6)
    s_barrier
    v_add_u32 v3, 114688, v8
    ds_read_b64_tr_b16 v[108:109], v3 offset:0
    ds_read_b64_tr_b16 v[110:111], v3 offset:5120
    ds_read_b64_tr_b16 a[188:189], v3 offset:32
    ds_read_b64_tr_b16 a[190:191], v3 offset:5152
    ds_read_b64_tr_b16 a[212:213], v3 offset:64
    ds_read_b64_tr_b16 a[214:215], v3 offset:5184
    ds_read_b64_tr_b16 a[236:237], v3 offset:96
    ds_read_b64_tr_b16 a[238:239], v3 offset:5216
    ds_read_b64_tr_b16 v[132:133], v3 offset:128
    ds_read_b64_tr_b16 v[134:135], v3 offset:5248
    ds_read_b64_tr_b16 v[156:157], v3 offset:160
    ds_read_b64_tr_b16 v[158:159], v3 offset:5280
    s_waitcnt lgkmcnt(6)
    ds_read_b64_tr_b16 v[180:181], v3 offset:192
    ds_read_b64_tr_b16 v[182:183], v3 offset:5312
    ds_read_b64_tr_b16 v[204:205], v3 offset:224
    ds_read_b64_tr_b16 v[206:207], v3 offset:5344
    ds_read_b64_tr_b16 v[228:229], v3 offset:256
    ds_read_b64_tr_b16 v[230:231], v3 offset:5376
    ds_read_b64_tr_b16 v[252:253], v3 offset:288
    ds_read_b64_tr_b16 v[254:255], v3 offset:5408
    s_waitcnt lgkmcnt(0)
    s_waitcnt vmcnt(0)
    s_barrier
    v_add_u32 v3, 0, v7
    ds_read_b64_tr_b16 a[112:113], v3 offset:0
    ds_read_b64_tr_b16 a[114:115], v3 offset:1536
    ds_read_b64_tr_b16 a[116:117], v3 offset:12288
    ds_read_b64_tr_b16 a[118:119], v3 offset:13824
    ds_read_b64_tr_b16 v[80:81], v3 offset:32
    ds_read_b64_tr_b16 v[82:83], v3 offset:1568
    ds_read_b64_tr_b16 v[84:85], v3 offset:12320
    ds_read_b64_tr_b16 v[86:87], v3 offset:13856
    ds_read_b64_tr_b16 a[152:153], v3 offset:64
    ds_read_b64_tr_b16 a[154:155], v3 offset:1600
    ds_read_b64_tr_b16 a[156:157], v3 offset:12352
    ds_read_b64_tr_b16 a[158:159], v3 offset:13888
    s_waitcnt lgkmcnt(0)
    s_barrier
    s_mul_i32 s32, s12, 24576
    v_add_u32 v120, s32, v9
    ds_write_b128 v120, v[16:19] offset:0
    ds_write_b128 v120, v[20:23] offset:1024
    ds_write_b128 v120, v[24:27] offset:2048
    ds_write_b128 v120, v[28:31] offset:3072
    ds_write_b128 v120, v[32:35] offset:4096
    ds_write_b128 v120, v[36:39] offset:5120
    ds_write_b128 v120, v[40:43] offset:6144
    ds_write_b128 v120, v[44:47] offset:7168
    s_waitcnt lgkmcnt(0)
    ds_write_b128 v120, v[48:51] offset:8192
    ds_write_b128 v120, v[52:55] offset:9216
    ds_write_b128 v120, v[56:59] offset:10240
    ds_write_b128 v120, v[60:63] offset:11264
    ds_write_b128 v120, v[64:67] offset:12288
    ds_write_b128 v120, v[68:71] offset:13312
    ds_write_b128 v120, v[72:75] offset:14336
    ds_write_b128 v120, v[76:79] offset:15360
    s_waitcnt lgkmcnt(0)
    ds_write_b128 v120, v[80:83] offset:16384
    ds_write_b128 v120, v[84:87] offset:17408
    ds_write_b128 v120, v[88:91] offset:18432
    ds_write_b128 v120, v[92:95] offset:19456
    ds_write_b128 v120, v[96:99] offset:20480
    ds_write_b128 v120, v[100:103] offset:21504
    ds_write_b128 v120, v[104:107] offset:22528
    ds_write_b128 v120, v[108:111] offset:23552
    s_waitcnt lgkmcnt(0)
    v_mov_b32 v4, 128
    s_mov_b32 s39, 0
rp_24:
    buffer_load_dwordx2 v[2:3], v4, s[8:11], 0 offen sc1
    s_waitcnt vmcnt(0)
    v_readfirstlane_b32 s32, v2
    v_readfirstlane_b32 s58, v3
    s_cmp_lt_u32 s32, 40
    s_cbranch_scc1 rpa_26
    s_cmp_ge_u32 s58, 1792
    s_cbranch_scc1 rpo_25
rpa_26:
    s_sleep 8
    s_add_u32 s39, s39, 1
    s_cmp_lt_u32 s39, 20000
    s_cbranch_scc1 rp_24
    s_branch L_end2
rpo_25:
    s_and_b32 s58, s58, 0xff
    s_cmp_gt_u32 s58, 3
    s_cselect_b32 s58, 0x2000, 0
    s_mul_i32 s32, s12, 2560
    v_lshlrev_b32 v16, 4, v1
    v_add_u32 v16, s32, v16
    v_add_u32 v17, 1024, v16
    v_add_u32 v18, 2048, v16
    v_lshrrev_b32 v19, 13, v16
    v_lshlrev_b32 v19, 14, v19
    v_and_b32 v4, 0x1fff, v16
    v_or3_b32 v4, v4, v19, s58
    v_lshrrev_b32 v19, 13, v17
    v_lshlrev_b32 v19, 14, v19
    v_and_b32 v5, 0x1fff, v17
    v_or3_b32 v5, v5, v19, s58
    v_lshrrev_b32 v19, 13, v18
    v_lshlrev_b32 v19, 14, v19
    v_and_b32 v6, 0x1fff, v18
    v_or3_b32 v6, v6, v19, s58
    s_mul_i32 s45, s12, 2560
    v_and_b32 v16, 8, v1
    v_mov_b32 v17, 0x4444
    v_mov_b32 v18, 0xeeee
    v_cmp_eq_u32 vcc, 0, v16
    s_nop 1
    v_cndmask_b32 v10, v18, v17, vcc
    s_mul_i32 s32, s12, 768
    s_add_u32 s32, s32, 108544
    v_and_b32 v16, 15, v1
    v_lshlrev_b32 v16, 4, v16
    v_bfe_u32 v17, v1, 4, 1
    v_lshlrev_b32 v17, 3, v17
    v_lshrrev_b32 v18, 5, v1
    v_lshlrev_b32 v18, 2, v18
    v_add3_u32 v16, v16, v17, v18
    v_add_u32 v11, s32, v16
    v_lshrrev_b32 v16, 4, v1
    v_lshlrev_b32 v16, 4, v16
    v_and_b32 v17, 2, v1
    v_bfe_u32 v18, v1, 2, 1
    v_bfe_u32 v19, v1, 3, 1
    v_lshlrev_b32 v19, 2, v19
    v_add3_u32 v16, v16, v17, v18
    v_add_u32 v16, v16, v19
    v_lshlrev_b32 v16, 4, v16
    v_and_b32 v17, 1, v1
    v_lshlrev_b32 v17, 3, v17
    v_add_u32 v16, v16, v17
    v_add_u32 v13, 108544, v16
    v_bfe_u32 v16, v1, 4, 1
    v_lshlrev_b32 v16, 1, v16
    v_lshrrev_b32 v17, 5, v1
    v_add_u32 v16, v16, v17
    s_mul_i32 s32, s12, 10
    v_add_u32 v16, s32, v16
    v_lshlrev_b32 v16, 14, v16
    v_and_b32 v18, 15, v1
    v_lshlrev_b32 v18, 4, v18
    s_lshl_b32 s33, s14, 8
    s_add_u32 s33, s33, s58
    v_add3_u32 v14, v16, v18, s33
    v_add_u32 v16, s32, v17
    v_add_u32 v16, 8, v16
    v_lshlrev_b32 v16, 14, v16
    v_add3_u32 v122, v16, v18, s33
    s_mov_b32 s36, 0
    s_mov_b32 s59, 0
    s_mov_b32 s43, 0
    s_memrealtime s[62:63]
    s_waitcnt lgkmcnt(0)
    s_sub_u32 s61, s62, 100
cv_loop_27:
    ds_read_b128 v[96:99], v120 offset:0
    ds_read_b128 v[100:103], v120 offset:1024
    ds_read_b128 v[104:107], v120 offset:2048
    ds_read_b128 v[108:111], v120 offset:3072
    v_mov_b32 v112, 0
    v_mov_b32 v113, 0
    v_mov_b32 v114, 0
    v_mov_b32 v115, 0
    v_mov_b32 v116, 0
    v_mov_b32 v117, 0
    v_mov_b32 v118, 0
    v_mov_b32 v119, 0
    v_mov_b32 v124, 0
    v_mov_b32 v125, 0
    v_mov_b32 v126, 0
    v_mov_b32 v127, 0
    s_waitcnt lgkmcnt(0)
    v_mov_b32 v56, 0
    v_mov_b32 v57, 0
    v_mov_b32 v58, 0
    v_mov_b32 v59, 0
    v_mov_b32 v60, 0
    v_mov_b32 v61, 0
    v_mov_b32 v62, 0
    v_mov_b32 v63, 0
    v_mov_b32 v64, 0
    v_mov_b32 v65, 0
    v_mov_b32 v66, 0
    v_mov_b32 v67, 0
    v_mov_b32 v68, 0
    v_mov_b32 v69, 0
    v_mov_b32 v70, 0
    v_mov_b32 v71, 0
    v_mov_b32 v72, 0
    v_mov_b32 v73, 0
    v_mov_b32 v74, 0
    v_mov_b32 v75, 0
    v_mov_b32 v76, 0
    v_mov_b32 v77, 0
    v_mov_b32 v78, 0
    v_mov_b32 v79, 0
    v_mov_b32 v80, 0
    v_mov_b32 v81, 0
    v_mov_b32 v82, 0
    v_mov_b32 v83, 0
    v_mov_b32 v84, 0
    v_mov_b32 v85, 0
    v_mov_b32 v86, 0
    v_mov_b32 v87, 0
    v_mov_b32 v88, 0
    v_mov_b32 v89, 0
    v_mov_b32 v90, 0
    v_mov_b32 v91, 0
    v_mov_b32 v92, 0
    v_mov_b32 v93, 0
    v_mov_b32 v94, 0
    v_mov_b32 v95, 0
    s_add_u32 s33, s61, 2
wu_30:
    s_memrealtime s[62:63]
    s_waitcnt lgkmcnt(0)
    s_sub_u32 s32, s62, s33
    s_cmp_ge_u32 s32, 0xfffff000
    s_cbranch_scc1 wu_30
    s_mov_b32 s54, s32
    s_mul_i32 s37, s59, 65536
    s_add_u32 m0, s45, 98304
    s_nop 0
    buffer_load_dwordx4 v4, s[4:7], s37 offen sc1 lds
    s_add_u32 m0, m0, 1024
    s_nop 0
    buffer_load_dwordx4 v5, s[4:7], s37 offen sc1 lds
    s_add_u32 m0, m0, 1024
    s_mov_b32 exec_hi, 0
    buffer_load_dwordx4 v6, s[4:7], s37 offen sc1 lds
    s_mov_b32 exec_hi, -1
    s_mov_b32 s55, 0
    s_waitcnt vmcnt(0)
    v_add_u32 v7, 98304, v9
cv_go_28:
    s_barrier
    ds_read_b128 v[16:19], v7 offset:0
    ds_read_b128 v[20:23], v7 offset:1024
    ds_read_b128 v[24:27], v7 offset:2048
    ds_read_b128 v[28:31], v7 offset:3072
    ds_read_b128 v[32:35], v7 offset:4096
    s_waitcnt lgkmcnt(4)
    v_smfmac_f32_16x16x64_bf16 v[112:115], v[16:19], a[0:7], v10
    ds_read_b128 v[36:39], v7 offset:5120
    v_smfmac_f32_16x16x64_bf16 v[116:119], v[16:19], a[8:15], v10
    ds_read_b128 v[40:43], v7 offset:6144
    v_smfmac_f32_16x16x64_bf16 v[124:127], v[16:19], a[16:23], v10
    ds_read_b128 v[44:47], v7 offset:7168
    s_waitcnt lgkmcnt(6)
    v_smfmac_f32_16x16x64_bf16 v[112:115], v[20:23], a[24:31], v10
    ds_read_b128 v[48:51], v7 offset:8192
    v_smfmac_f32_16x16x64_bf16 v[116:119], v[20:23], a[32:39], v10
    ds_read_b128 v[52:55], v7 offset:9216
    v_smfmac_f32_16x16x64_bf16 v[124:127], v[20:23], v[96:103], v10
    ds_read_b128 v[96:99], v120 offset:4096
    s_waitcnt lgkmcnt(8)
    v_smfmac_f32_16x16x64_bf16 v[112:115], v[24:27], a[40:47], v10
    ds_read_b128 v[100:103], v120 offset:5120
    v_smfmac_f32_16x16x64_bf16 v[116:119], v[24:27], v[104:111], v10
    ds_read_b128 v[104:107], v120 offset:6144
    v_max3_u32 v8, v19, v23, v27
    v_smfmac_f32_16x16x64_bf16 v[124:127], v[24:27], a[48:55], v10
    ds_read_b128 v[108:111], v120 offset:7168
    s_waitcnt lgkmcnt(9)
    v_max3_u32 v8, v8, v31, v35
    v_smfmac_f32_16x16x64_bf16 v[112:115], v[28:31], a[56:63], v10
    s_waitcnt lgkmcnt(7)
    v_max3_u32 v8, v8, v39, v43
    s_waitcnt lgkmcnt(2)
    v_smfmac_f32_16x16x64_bf16 v[116:119], v[28:31], v[96:103], v10
    ds_read_b128 v[96:99], v120 offset:8192
    v_max3_u32 v8, v8, v47, v51
    v_smfmac_f32_16x16x64_bf16 v[124:127], v[28:31], a[64:71], v10
    ds_read_b128 v[100:103], v120 offset:9216
    v_max_u32 v8, v8, v55
    s_waitcnt lgkmcnt(2)
    v_smfmac_f32_16x16x64_bf16 v[112:115], v[32:35], v[104:111], v10
    ds_read_b128 v[104:107], v120 offset:10240
    v_cmp_eq_u32 vcc, -1, v8
    v_smfmac_f32_16x16x64_bf16 v[116:119], v[32:35], a[72:79], v10
    ds_read_b128 v[108:111], v120 offset:11264
    s_cbranch_vccnz cv_retry_29
    v_smfmac_f32_16x16x64_bf16 v[124:127], v[32:35], a[80:87], v10
    s_waitcnt lgkmcnt(2)
    v_smfmac_f32_16x16x64_bf16 v[112:115], v[36:39], v[96:103], v10
    ds_read_b128 v[96:99], v120 offset:12288
    v_smfmac_f32_16x16x64_bf16 v[116:119], v[36:39], a[88:95], v10
    ds_read_b128 v[100:103], v120 offset:13312
    s_waitcnt lgkmcnt(2)
    v_smfmac_f32_16x16x64_bf16 v[124:127], v[36:39], v[104:111], v10
    ds_read_b128 v[104:107], v120 offset:14336
    v_smfmac_f32_16x16x64_bf16 v[112:115], v[40:43], a[96:103], v10
    ds_read_b128 v[108:111], v120 offset:15360
    v_smfmac_f32_16x16x64_bf16 v[112:115], v[44:47], a[104:111], v10
    s_waitcnt lgkmcnt(2)
    v_smfmac_f32_16x16x64_bf16 v[112:115], v[48:51], v[96:103], v10
    ds_read_b128 v[96:99], v120 offset:16384
    v_smfmac_f32_16x16x64_bf16 v[112:115], v[52:55], a[112:119], v10
    ds_read_b128 v[100:103], v120 offset:17408
    s_waitcnt lgkmcnt(2)
    v_smfmac_f32_16x16x64_bf16 v[116:119], v[40:43], v[104:111], v10
    s_nop 1
    ds_read_b128 v[104:107], v120 offset:18432
    v_smfmac_f32_16x16x64_bf16 v[116:119], v[44:47], a[120:127], v10
    s_nop 1
    ds_read_b128 v[108:111], v120 offset:19456
    v_smfmac_f32_16x16x64_bf16 v[116:119], v[48:51], a[128:135], v10
    v_permlane32_swap_b32 v112, v113
    v_permlane32_swap_b32 v114, v115
    s_waitcnt lgkmcnt(2)
    v_smfmac_f32_16x16x64_bf16 v[116:119], v[52:55], v[96:103], v10
    v_add_f32 v112, v112, v113
    v_add_f32 v114, v114, v115
    ds_read_b128 v[96:99], v120 offset:20480
    v_smfmac_f32_16x16x64_bf16 v[124:127], v[40:43], a[136:143], v10
    v_cvt_pk_bf16_f32 v112, v112, v114
    ds_write_b32 v11, v112 offset:0
    s_nop 1
    ds_read_b128 v[100:103], v120 offset:21504
    s_waitcnt lgkmcnt(3)
    v_smfmac_f32_16x16x64_bf16 v[124:127], v[44:47], v[104:111], v10
    s_nop 1
    ds_read_b128 v[104:107], v120 offset:22528
    v_smfmac_f32_16x16x64_bf16 v[124:127], v[48:51], a[144:151], v10
    v_permlane32_swap_b32 v116, v117
    v_permlane32_swap_b32 v118, v119
    ds_read_b128 v[108:111], v120 offset:23552
    v_smfmac_f32_16x16x64_bf16 v[124:127], v[52:55], a[152:159], v10
    v_add_f32 v116, v116, v117
    v_add_f32 v118, v118, v119
    v_cvt_pk_bf16_f32 v116, v116, v118
    ds_write_b32 v11, v116 offset:256
    s_nop 3
    v_permlane32_swap_b32 v124, v125
    v_permlane32_swap_b32 v126, v127
    v_add_f32 v124, v124, v125
    v_add_f32 v126, v126, v127
    v_cvt_pk_bf16_f32 v124, v124, v126
    ds_write_b32 v11, v124 offset:512
    s_waitcnt lgkmcnt(0)
    s_barrier
    ds_read_b64_tr_b16 v[24:25], v13 offset:0
    ds_read_b64_tr_b16 v[26:27], v13 offset:128
    ds_read_b64_tr_b16 v[28:29], v13 offset:1024
    ds_read_b64_tr_b16 v[30:31], v13 offset:1152
    ds_read_b64_tr_b16 v[32:33], v13 offset:2048
    ds_read_b64_tr_b16 v[34:35], v13 offset:2176
    s_mul_i32 s37, s43, 655360
    s_add_u32 s37, s37, 491520
    s_add_u32 s32, s37, 65536
    s_bfe_u32 s47, s36, 0x10001
    s_waitcnt lgkmcnt(4)
    v_smfmac_f32_16x16x64_bf16 v[56:59], v[24:27], v[96:103], v10
    s_waitcnt lgkmcnt(2)
    v_smfmac_f32_16x16x64_bf16 v[56:59], v[28:31], a[160:167], v10
    s_waitcnt lgkmcnt(0)
    v_smfmac_f32_16x16x64_bf16 v[56:59], v[32:35], v[104:111], v10
    v_smfmac_f32_16x16x64_bf16 v[60:63], v[24:27], a[168:175], v10
    v_smfmac_f32_16x16x64_bf16 v[60:63], v[28:31], a[176:183], v10
    v_smfmac_f32_16x16x64_bf16 v[60:63], v[32:35], a[184:191], v10
    s_nop 1
    v_smfmac_f32_16x16x64_bf16 v[64:67], v[24:27], a[192:199], v10
    s_nop 1
    v_smfmac_f32_16x16x64_bf16 v[64:67], v[28:31], a[200:207], v10
    s_nop 1
    v_smfmac_f32_16x16x64_bf16 v[64:67], v[32:35], a[208:215], v10
    v_permlane32_swap_b32 v56, v60
    v_smfmac_f32_16x16x64_bf16 v[68:71], v[24:27], a[216:223], v10
    v_permlane32_swap_b32 v57, v61
    v_smfmac_f32_16x16x64_bf16 v[68:71], v[28:31], a[224:231], v10
    v_permlane32_swap_b32 v58, v62
    v_smfmac_f32_16x16x64_bf16 v[68:71], v[32:35], a[232:239], v10
    v_permlane32_swap_b32 v59, v63
    v_smfmac_f32_16x16x64_bf16 v[72:75], v[24:27], a[240:247], v10
    v_add_f32 v56, v56, v60
    v_add_f32 v57, v57, v61
    v_smfmac_f32_16x16x64_bf16 v[72:75], v[28:31], a[248:255], v10
    v_add_f32 v58, v58, v62
    v_add_f32 v59, v59, v63
    v_smfmac_f32_16x16x64_bf16 v[72:75], v[32:35], v[128:135], v10
    v_cvt_pk_bf16_f32 v36, v56, v57
    v_cvt_pk_bf16_f32 v38, v58, v59
    v_smfmac_f32_16x16x64_bf16 v[76:79], v[24:27], v[136:143], v10
    v_permlane32_swap_b32 v64, v68
    v_permlane32_swap_b32 v65, v69
    v_smfmac_f32_16x16x64_bf16 v[76:79], v[28:31], v[144:151], v10
    v_permlane32_swap_b32 v66, v70
    v_permlane32_swap_b32 v67, v71
    v_smfmac_f32_16x16x64_bf16 v[76:79], v[32:35], v[152:159], v10
    v_add_f32 v64, v64, v68
    v_add_f32 v65, v65, v69
    v_smfmac_f32_16x16x64_bf16 v[80:83], v[24:27], v[160:167], v10
    v_add_f32 v66, v66, v70
    v_add_f32 v67, v67, v71
    v_smfmac_f32_16x16x64_bf16 v[80:83], v[28:31], v[168:175], v10
    v_cvt_pk_bf16_f32 v37, v64, v65
    v_cvt_pk_bf16_f32 v39, v66, v67
    v_smfmac_f32_16x16x64_bf16 v[80:83], v[32:35], v[176:183], v10
    s_nop 1
    v_permlane16_swap_b32 v36, v37
    v_smfmac_f32_16x16x64_bf16 v[84:87], v[24:27], v[184:191], v10
    v_permlane16_swap_b32 v38, v39
    v_and_or_b32 v39, v39, -2, s47
    v_smfmac_f32_16x16x64_bf16 v[84:87], v[28:31], v[192:199], v10
    buffer_store_dwordx4 v[36:39], v14, s[4:7], s37 offen sc1
    v_permlane32_swap_b32 v72, v76
    v_smfmac_f32_16x16x64_bf16 v[84:87], v[32:35], v[200:207], v10
    v_permlane32_swap_b32 v73, v77
    v_permlane32_swap_b32 v74, v78
    v_smfmac_f32_16x16x64_bf16 v[88:91], v[24:27], v[208:215], v10
    v_permlane32_swap_b32 v75, v79
    v_add_f32 v72, v72, v76
    v_add_f32 v73, v73, v77
    v_smfmac_f32_16x16x64_bf16 v[88:91], v[28:31], v[216:223], v10
    v_add_f32 v74, v74, v78
    v_add_f32 v75, v75, v79
    v_cvt_pk_bf16_f32 v40, v72, v73
    v_smfmac_f32_16x16x64_bf16 v[88:91], v[32:35], v[224:231], v10
    v_cvt_pk_bf16_f32 v42, v74, v75
    v_permlane32_swap_b32 v80, v84
    v_permlane32_swap_b32 v81, v85
    v_smfmac_f32_16x16x64_bf16 v[92:95], v[24:27], v[232:239], v10
    v_permlane32_swap_b32 v82, v86
    v_permlane32_swap_b32 v83, v87
    v_add_f32 v80, v80, v84
    v_smfmac_f32_16x16x64_bf16 v[92:95], v[28:31], v[240:247], v10
    v_add_f32 v81, v81, v85
    v_add_f32 v82, v82, v86
    v_add_f32 v83, v83, v87
    v_smfmac_f32_16x16x64_bf16 v[92:95], v[32:35], v[248:255], v10
    v_cvt_pk_bf16_f32 v41, v80, v81
    v_cvt_pk_bf16_f32 v43, v82, v83
    s_nop 1
    v_permlane16_swap_b32 v40, v41
    v_permlane16_swap_b32 v42, v43
    v_and_or_b32 v43, v43, -2, s47
    buffer_store_dwordx4 v[40:43], v14, s[4:7], s32 offen sc1
    v_permlane32_swap_b32 v88, v92
    v_permlane32_swap_b32 v89, v93
    v_permlane32_swap_b32 v90, v94
    v_permlane32_swap_b32 v91, v95
    v_add_f32 v88, v88, v92
    v_add_f32 v89, v89, v93
    v_add_f32 v90, v90, v94
    v_add_f32 v91, v91, v95
    v_cvt_pk_bf16_f32 v44, v88, v89
    v_cvt_pk_bf16_f32 v46, v90, v91
    v_mov_b32 v45, v44
    v_mov_b32 v47, v46
    s_nop 0
    v_permlane16_swap_b32 v44, v45
    v_permlane16_swap_b32 v46, v47
    v_and_or_b32 v47, v47, -2, s47
    s_mov_b32 exec_lo, 0xffff
    s_mov_b32 exec_hi, 0xffff
    buffer_store_dwordx4 v[44:47], v122, s[4:7], s37 offen sc1
    s_mov_b64 exec, -1
    s_cmp_lg_u32 s12, 1
    s_cbranch_scc1 n1_31
    s_memrealtime s[62:63]
    s_waitcnt lgkmcnt(0)
    s_add_u32 s62, s62, -10
    s_and_b32 s32, s36, 1
    s_lshl_b32 s32, s32, 14
    s_lshl_b32 s33, s14, 7
    s_add_u32 s32, s32, s33
    s_add_u32 s32, s32, s58
    s_add_u32 s32, s32, 1871872
    v_mov_b32 v48, s62
    v_mov_b32 v49, s36
    v_mov_b32 v50, 0
    s_mov_b64 exec, 1
    buffer_store_dwordx2 v[48:49], v50, s[4:7], s32 offen sc1
    s_mov_b64 exec, -1
n1_31:
    s_and_b32 s46, s36, 3
    s_lshl_b32 s46, s46, 14
    s_add_u32 s46, s46, s58
    s_add_u32 s46, s46, 1802240
    v_min_u32 v54, 39, v1
    v_lshlrev_b32 v54, 7, v54
    buffer_load_dwordx2 v[52:53], v54, s[4:7], s46 offen sc1
    s_mov_b32 s39, 0
    s_waitcnt vmcnt(0)
hr_32:
    v_cmp_ne_u32 vcc, s36, v53
    s_cbranch_vccz hro_33
    buffer_load_dwordx2 v[52:53], v54, s[4:7], s46 offen sc1
    s_add_u32 s39, s39, 1
    s_cmp_lt_u32 s39, 20000
    s_waitcnt vmcnt(0)
    s_cbranch_scc1 hr_32
    s_branch L_end2
hro_33:
    v_readfirstlane_b32 s34, v52
    s_nop 1
    v_subrev_u32 v52, s34, v52
    s_nop 1
    v_max_i32_dpp v52, v52, v52 quad_perm:[1,0,3,2] row_mask:0xf bank_mask:0xf
    s_nop 1
    v_max_i32_dpp v52, v52, v52 quad_perm:[2,3,0,1] row_mask:0xf bank_mask:0xf
    s_nop 1
    v_max_i32_dpp v52, v52, v52 row_half_mirror row_mask:0xf bank_mask:0xf
    s_nop 1
    v_max_i32_dpp v52, v52, v52 row_mirror row_mask:0xf bank_mask:0xf
    s_nop 0
    v_readlane_b32 s32, v52, 0
    v_readlane_b32 s33, v52, 16
    s_max_i32 s32, s32, s33
    v_readlane_b32 s33, v52, 32
    s_max_i32 s32, s32, s33
    v_readlane_b32 s33, v52, 48
    s_max_i32 s32, s32, s33
    s_add_u32 s32, s32, s34
    s_add_u32 s61, s32, 0
    s_mul_i32 s37, s36, 327680
    s_add_u32 s37, s37, 171966464
    s_add_u32 s32, s37, 32768
    v_lshrrev_b32 v18, 14, v14
    v_lshlrev_b32 v18, 13, v18
    v_and_b32 v19, 0x1fff, v14
    v_or_b32 v18, v18, v19
    v_lshrrev_b32 v20, 14, v122
    v_lshlrev_b32 v20, 13, v20
    v_and_b32 v19, 0x1fff, v122
    v_or_b32 v20, v20, v19
    buffer_store_dwordx4 v[36:39], v18, s[4:7], s37 offen sc1
    buffer_store_dwordx4 v[40:43], v18, s[4:7], s32 offen sc1
    s_mov_b32 exec_lo, 0xffff
    s_mov_b32 exec_hi, 0xffff
    buffer_store_dwordx4 v[44:47], v20, s[4:7], s37 offen sc1
    s_mov_b64 exec, -1
    s_xor_b32 s43, s43, 1
    s_add_u32 s59, s59, 1
    s_cmp_eq_u32 s59, 3
    s_cselect_b32 s59, 0, s59
    s_add_u32 s36, s36, 1
    s_cmp_lt_u32 s36, 64
    s_cbranch_scc1 cv_loop_27
    s_waitcnt vmcnt(0)
    s_barrier
    s_cmp_lg_u32 s12, 0
    s_cbranch_scc1 fs_34
    s_lshl_b32 s32, s14, 7
    s_add_u32 s32, s32, 2191360
    v_mov_b32 v2, 1
    s_mov_b64 exec, 1
    buffer_store_dword v2, off, s[4:7], s32 sc1
    s_mov_b64 exec, -1
fs_34:
    s_endpgm
cv_retry_29:
    s_mul_i32 s37, s59, 65536
    s_add_u32 s37, s37, 32768
    s_waitcnt lgkmcnt(0)
    v_mov_b32 v24, 0
    v_mov_b32 v25, 0
    v_mov_b32 v26, 0
    v_mov_b32 v27, 0
    v_add_u32 v7, 111616, v9
    v_add_u32 v28, s45, v7
fb_35:
    buffer_load_dwordx4 v[16:19], v4, s[4:7], s37 offen sc1
    buffer_load_dwordx4 v[20:23], v5, s[4:7], s37 offen sc1
    s_mov_b32 exec_hi, 0
    buffer_load_dwordx4 v[24:27], v6, s[4:7], s37 offen sc1
    s_mov_b32 exec_hi, -1
    s_add_u32 s55, s55, 1
    s_cmp_gt_u32 s55, 20000
    s_cbranch_scc1 L_end2
    s_cmp_lt_u32 s55, 24
    s_cbranch_scc1 ns_36
    s_sleep 2
ns_36:
    s_waitcnt vmcnt(0)
    v_max3_u32 v29, v16, v17, v18
    v_max3_u32 v29, v29, v19, v20
    v_max3_u32 v29, v29, v21, v22
    v_max3_u32 v29, v29, v23, v24
    v_max3_u32 v29, v29, v25, v26
    v_max_u32 v29, v29, v27
    v_cmp_eq_u32 vcc, -1, v29
    s_cbranch_vccnz fb_35
    ds_write_b128 v28, v[16:19]
    ds_write_b128 v28, v[20:23] offset:1024
    s_mov_b32 exec_hi, 0
    ds_write_b128 v28, v[24:27] offset:2048
    s_mov_b32 exec_hi, -1
    ds_read_b128 v[96:99], v120 offset:0
    ds_read_b128 v[100:103], v120 offset:1024
    ds_read_b128 v[104:107], v120 offset:2048
    ds_read_b128 v[108:111], v120 offset:3072
    v_mov_b32 v112, 0
    v_mov_b32 v113, 0
    v_mov_b32 v114, 0
    v_mov_b32 v115, 0
    v_mov_b32 v116, 0
    v_mov_b32 v117, 0
    v_mov_b32 v118, 0
    v_mov_b32 v119, 0
    v_mov_b32 v124, 0
    v_mov_b32 v125, 0
    v_mov_b32 v126, 0
    v_mov_b32 v127, 0
    s_waitcnt lgkmcnt(0)
    s_branch cv_go_28
L_end2:
    s_endpgm
L_r:
    s_load_dwordx2 s[16:17], s[0:1], 8
    s_mov_b32 s18, 10240
    s_mov_b32 s19, 0x20000
    s_cmp_ge_u32 s14, 7
    s_cbranch_scc1 cal_skip_37
    s_cmp_lg_u32 s12, 0
    s_cbranch_scc1 cal_skip_37
    s_mov_b32 s50, -1
    s_mov_b32 s51, -1
    v_mov_b32 v4, 0
    s_mov_b64 exec, 0xff
    v_and_b32 v5, 1, v1
    v_lshlrev_b32 v5, 13, v5
    v_and_b32 v6, 6, v1
    v_lshlrev_b32 v6, 13, v6
    v_add_u32 v5, v5, v6
    s_lshl_b32 s32, s14, 8
    s_add_u32 s32, s32, 0x1E0000
    v_add_u32 v5, s32, v5
    buffer_load_dword v2, v5, s[4:7], 0 offen sc1
    s_waitcnt vmcnt(0)
    buffer_store_dword v4, v5, s[4:7], 0 offen sc1
    s_waitcnt vmcnt(0)
    s_mov_b64 exec, 1
    s_memtime s[52:53]
    s_waitcnt lgkmcnt(0)
    buffer_load_dword v2, v5, s[4:7], 0 offen sc1
    s_waitcnt vmcnt(0)
    s_memtime s[54:55]
    s_waitcnt lgkmcnt(0)
    s_sub_u32 s32, s54, s52
    s_min_u32 s50, s50, s32
    s_mov_b64 exec, 2
    s_memtime s[52:53]
    s_waitcnt lgkmcnt(0)
    buffer_load_dword v2, v5, s[4:7], 0 offen sc1
    s_waitcnt vmcnt(0)
    s_memtime s[54:55]
    s_waitcnt lgkmcnt(0)
    s_sub_u32 s32, s54, s52
    s_min_u32 s51, s51, s32
    s_mov_b64 exec, 4
    s_memtime s[52:53]
    s_waitcnt lgkmcnt(0)
    buffer_load_dword v2, v5, s[4:7], 0 offen sc1
    s_waitcnt vmcnt(0)
    s_memtime s[54:55]
    s_waitcnt lgkmcnt(0)
    s_sub_u32 s32, s54, s52
    s_min_u32 s50, s50, s32
    s_mov_b64 exec, 8
    s_memtime s[52:53]
    s_waitcnt lgkmcnt(0)
    buffer_load_dword v2, v5, s[4:7], 0 offen sc1
    s_waitcnt vmcnt(0)
    s_memtime s[54:55]
    s_waitcnt lgkmcnt(0)
    s_sub_u32 s32, s54, s52
    s_min_u32 s51, s51, s32
    s_mov_b64 exec, 16
    s_memtime s[52:53]
    s_waitcnt lgkmcnt(0)
    buffer_load_dword v2, v5, s[4:7], 0 offen sc1
    s_waitcnt vmcnt(0)
    s_memtime s[54:55]
    s_waitcnt lgkmcnt(0)
    s_sub_u32 s32, s54, s52
    s_min_u32 s50, s50, s32
    s_mov_b64 exec, 32
    s_memtime s[52:53]
    s_waitcnt lgkmcnt(0)
    buffer_load_dword v2, v5, s[4:7], 0 offen sc1
    s_waitcnt vmcnt(0)
    s_memtime s[54:55]
    s_waitcnt lgkmcnt(0)
    s_sub_u32 s32, s54, s52
    s_min_u32 s51, s51, s32
    s_mov_b64 exec, 64
    s_memtime s[52:53]
    s_waitcnt lgkmcnt(0)
    buffer_load_dword v2, v5, s[4:7], 0 offen sc1
    s_waitcnt vmcnt(0)
    s_memtime s[54:55]
    s_waitcnt lgkmcnt(0)
    s_sub_u32 s32, s54, s52
    s_min_u32 s50, s50, s32
    s_mov_b64 exec, 128
    s_memtime s[52:53]
    s_waitcnt lgkmcnt(0)
    buffer_load_dword v2, v5, s[4:7], 0 offen sc1
    s_waitcnt vmcnt(0)
    s_memtime s[54:55]
    s_waitcnt lgkmcnt(0)
    s_sub_u32 s32, s54, s52
    s_min_u32 s51, s51, s32
    s_mov_b64 exec, 1
    s_cmp_le_u32 s50, s51
    s_cselect_b32 s32, 0, 1
    s_add_u32 s32, s32, 0x100
    v_mov_b32 v2, s32
    v_mov_b32 v3, 132
    buffer_atomic_add v2, v3, s[8:11], 0 offen sc1
    s_mov_b64 exec, -1
cal_skip_37:
    v_mov_b32 v76, -1
    v_mov_b32 v77, -1
    v_mov_b32 v78, -1
    v_mov_b32 v79, -1
    v_lshlrev_b32 v4, 4, v0
    s_mul_i32 s37, s14, 49152
    buffer_store_dwordx4 v[76:79], v4, s[4:7], s37 offen sc1
    s_add_u32 s37, s37, 4096
    buffer_store_dwordx4 v[76:79], v4, s[4:7], s37 offen sc1
    s_add_u32 s37, s37, 4096
    buffer_store_dwordx4 v[76:79], v4, s[4:7], s37 offen sc1
    s_add_u32 s37, s37, 4096
    buffer_store_dwordx4 v[76:79], v4, s[4:7], s37 offen sc1
    s_add_u32 s37, s37, 4096
    buffer_store_dwordx4 v[76:79], v4, s[4:7], s37 offen sc1
    s_add_u32 s37, s37, 4096
    buffer_store_dwordx4 v[76:79], v4, s[4:7], s37 offen sc1
    s_add_u32 s37, s37, 4096
    buffer_store_dwordx4 v[76:79], v4, s[4:7], s37 offen sc1
    s_add_u32 s37, s37, 4096
    buffer_store_dwordx4 v[76:79], v4, s[4:7], s37 offen sc1
    s_add_u32 s37, s37, 4096
    buffer_store_dwordx4 v[76:79], v4, s[4:7], s37 offen sc1
    s_add_u32 s37, s37, 4096
    buffer_store_dwordx4 v[76:79], v4, s[4:7], s37 offen sc1
    s_add_u32 s37, s37, 4096
    buffer_store_dwordx4 v[76:79], v4, s[4:7], s37 offen sc1
    s_add_u32 s37, s37, 4096
    buffer_store_dwordx4 v[76:79], v4, s[4:7], s37 offen sc1
    s_add_u32 s37, s37, 4096
    s_cmp_lg_u32 s14, 1
    s_cbranch_scc1 nz_38
    v_lshlrev_b32 v4, 7, v0
    v_mov_b32 v5, 0
    s_mov_b32 s37, 2162688
    buffer_store_dword v5, v4, s[4:7], s37 offen sc1
    buffer_store_dword v5, v4, s[4:7], s37 offen offset:4 sc1
nz_38:
    s_waitcnt vmcnt(0)
    s_barrier
    s_cmp_lg_u32 s12, 0
    s_cbranch_scc1 ds_39
    v_mov_b32 v3, 128
    v_mov_b32 v2, 1
    s_mov_b64 exec, 1
    buffer_atomic_add v2, v3, s[8:11], 0 offen sc1
    s_mov_b64 exec, -1
ds_39:
    v_mov_b32 v4, 128
    s_mov_b32 s39, 0
rp_40:
    buffer_load_dwordx2 v[2:3], v4, s[8:11], 0 offen sc1
    s_waitcnt vmcnt(0)
    v_readfirstlane_b32 s32, v2
    v_readfirstlane_b32 s58, v3
    s_cmp_lt_u32 s32, 40
    s_cbranch_scc1 rpa_42
    s_cmp_ge_u32 s58, 1792
    s_cbranch_scc1 rpo_41
rpa_42:
    s_sleep 8
    s_add_u32 s39, s39, 1
    s_cmp_lt_u32 s39, 20000
    s_cbranch_scc1 rp_40
    s_branch L_end2
rpo_41:
    s_and_b32 s58, s58, 0xff
    s_cmp_gt_u32 s58, 3
    s_cselect_b32 s58, 0x2000, 0
    v_and_b32 v16, 8, v1
    v_mov_b32 v17, 0x4444
    v_mov_b32 v18, 0xeeee
    v_cmp_eq_u32 vcc, 0, v16
    s_nop 1
    v_cndmask_b32 v11, v18, v17, vcc
    v_lshlrev_b32 v10, 4, v1
    s_lshl_b32 s32, s12, 3
    v_lshrrev_b32 v60, 5, v1
    v_add_u32 v60, s32, v60
    v_mul_u32_u24 v60, 640, v60
    v_and_b32 v61, 31, v1
    v_lshlrev_b32 v61, 4, v61
    v_add_u32 v60, v60, v61
    v_add_u32 v61, 0, v60
    v_lshrrev_b32 v62, 13, v61
    v_lshlrev_b32 v62, 14, v62
    v_and_b32 v4, 0x1fff, v61
    v_or3_b32 v4, v4, v62, s58
    v_add_u32 v61, 1280, v60
    v_lshrrev_b32 v62, 13, v61
    v_lshlrev_b32 v62, 14, v62
    v_and_b32 v5, 0x1fff, v61
    v_or3_b32 v5, v5, v62, s58
    v_add_u32 v61, 2560, v60
    v_lshrrev_b32 v62, 13, v61
    v_lshlrev_b32 v62, 14, v62
    v_and_b32 v6, 0x1fff, v61
    v_or3_b32 v6, v6, v62, s58
    v_add_u32 v61, 3840, v60
    v_lshrrev_b32 v62, 13, v61
    v_lshlrev_b32 v62, 14, v62
    v_and_b32 v7, 0x1fff, v61
    v_or3_b32 v7, v7, v62, s58
    v_lshrrev_b32 v60, 4, v1
    v_lshlrev_b32 v60, 1, v60
    v_add_u32 v60, s32, v60
    v_mul_u32_u24 v60, 640, v60
    v_and_b32 v61, 15, v1
    v_lshlrev_b32 v61, 3, v61
    v_add_u32 v60, v60, v61
    v_add_u32 v60, 512, v60
    v_lshrrev_b32 v62, 13, v60
    v_lshlrev_b32 v62, 14, v62
    v_and_b32 v8, 0x1fff, v60
    v_or3_b32 v8, v8, v62, s58
    v_add_u32 v60, 640, v60
    v_lshrrev_b32 v62, 13, v60
    v_lshlrev_b32 v62, 14, v62
    v_and_b32 v9, 0x1fff, v60
    v_or3_b32 v9, v9, v62, s58
    s_lshl_b32 s32, s14, 14
    s_add_u32 s32, s32, s58
    s_lshl_b32 s33, s12, 11
    s_add_u32 s32, s32, s33
    v_add_u32 v12, s32, v10
    s_lshl_b32 s32, s14, 8
    v_and_b32 v60, 15, v1
    v_lshlrev_b32 v60, 4, v60
    v_add_u32 v60, s32, v60
    v_lshrrev_b32 v62, 13, v60
    v_lshlrev_b32 v62, 14, v62
    v_and_b32 v13, 0x1fff, v60
    v_or3_b32 v13, v13, v62, s58
    v_lshrrev_b32 v60, 4, v1
    v_min_u32 v60, 1, v60
    v_mul_u32_u24 v60, 32768, v60
    v_add_u32 v13, v13, v60
    v_lshrrev_b32 v60, 4, v1
    v_mul_u32_u24 v60, 288, v60
    v_and_b32 v61, 15, v1
    v_lshlrev_b32 v61, 2, v61
    s_mul_i32 s32, s12, 1152
    v_add3_u32 v15, v60, v61, s32
    v_and_b32 v60, 7, v1
    v_mul_u32_u24 v60, 72, v60
    v_lshrrev_b32 v61, 4, v1
    v_lshlrev_b32 v61, 4, v61
    v_and_b32 v62, 8, v1
    v_add3_u32 v16, v60, v61, v62
    v_add_u32 v27, 2304, v16
    v_lshlrev_b32 v60, 7, v1
    v_add_u32 v17, 2170880, v60
    s_lshl_b32 s40, s14, 15
    s_lshl_b32 s32, s12, 13
    s_add_u32 s40, s40, s32
    s_add_u32 s40, s40, 79691776
    v_and_b32 v60, 7, v1
    v_mul_u32_u24 v60, 1280, v60
    v_lshrrev_b32 v61, 4, v1
    v_lshlrev_b32 v61, 3, v61
    v_bfe_u32 v62, v1, 3, 1
    v_lshlrev_b32 v62, 2, v62
    v_add3_u32 v60, v60, v61, v62
    s_lshl_b32 s32, s14, 5
    buffer_load_dword v64, v60, s[16:19], s32 offen
    s_mov_b32 s36, 0
    s_mov_b32 s59, 0
    s_mov_b32 s60, 0
    s_mov_b32 s38, 0
    s_mov_b32 s43, 0
    s_waitcnt vmcnt(0)
    s_memrealtime s[62:63]
    s_waitcnt lgkmcnt(0)
    s_sub_u32 s61, s62, 200
    s_cmp_lg_u32 s12, 0
    s_cbranch_scc1 w0skip_43
    v_mov_b32 v65, v64
    s_nop 1
    v_permlane16_swap_b32 v64, v65
    v_mov_b32 v66, v64
    v_mov_b32 v67, v65
    s_nop 0
    v_permlane32_swap_b32 v64, v66
    v_permlane32_swap_b32 v65, v67
    s_mul_i32 s37, s59, 65536
    s_mov_b32 exec_hi, 0
    buffer_store_dwordx4 v[64:67], v13, s[4:7], s37 offen sc1
    s_mov_b32 exec_hi, -1
    s_and_b32 s32, s36, 3
    s_lshl_b32 s32, s32, 14
    s_lshl_b32 s33, s14, 7
    s_add_u32 s32, s32, s33
    s_add_u32 s32, s32, s58
    s_add_u32 s32, s32, 1802240
    v_mov_b32 v68, s61
    v_mov_b32 v69, s36
    v_mov_b32 v70, s62
    v_mov_b32 v71, s36
    v_mov_b32 v72, 0
    s_mov_b64 exec, 1
    buffer_store_dwordx4 v[68:71], v72, s[4:7], s32 offen sc1
    s_mov_b64 exec, -1
w0skip_43:
    s_mov_b32 s16, 160
    s_mov_b32 s17, 90
    s_mov_b32 s18, 216
    s_mov_b32 s19, 142
    s_add_u32 s20, s61, 90
    s_sub_u32 s21, s61, 1000
    s_mov_b32 s22, s61
    s_mov_b32 s23, 1
    s_mov_b32 s28, 0
    s_mov_b32 s29, 0
    v_mov_b32 v136, 0
    s_add_u32 s41, s36, 1
    s_cmp_ge_u32 s38, s41
    s_cbranch_scc1 ux_ok_44
    s_mov_b32 s39, 0
ux_45:
    buffer_load_dword v2, v17, s[4:7], 0 offen sc1
    s_waitcnt vmcnt(0)
    s_nop 1
    v_min_u32_dpp v2, v2, v2 quad_perm:[1,0,3,2] row_mask:0xf bank_mask:0xf
    s_nop 1
    v_min_u32_dpp v2, v2, v2 quad_perm:[2,3,0,1] row_mask:0xf bank_mask:0xf
    s_nop 1
    v_min_u32_dpp v2, v2, v2 row_half_mirror row_mask:0xf bank_mask:0xf
    s_nop 1
    v_min_u32_dpp v2, v2, v2 row_mirror row_mask:0xf bank_mask:0xf
    s_nop 0
    v_readlane_b32 s32, v2, 0
    v_readlane_b32 s33, v2, 16
    s_min_u32 s32, s32, s33
    v_readlane_b32 s33, v2, 32
    s_min_u32 s32, s32, s33
    v_readlane_b32 s33, v2, 48
    s_min_u32 s38, s32, s33
    s_cmp_ge_u32 s38, s41
    s_cbranch_scc1 ux_ok_44
    s_sleep 2
    s_add_u32 s39, s39, 1
    s_cmp_lt_u32 s39, 20000
    s_cbranch_scc1 ux_45
    s_branch L_end2
ux_ok_44:
    s_mul_i32 s45, s36, 1310720
    s_add_u32 s45, s45, s40
    buffer_load_dwordx4 v[160:163], v10, s[4:7], s45 offen offset:0 sc1
    buffer_load_dwordx4 v[164:167], v10, s[4:7], s45 offen offset:1024 sc1
    buffer_load_dwordx4 v[168:171], v10, s[4:7], s45 offen offset:2048 sc1
    buffer_load_dwordx4 v[172:175], v10, s[4:7], s45 offen offset:3072 sc1
    s_add_u32 s45, s45, 4096
    buffer_load_dwordx4 v[176:179], v10, s[4:7], s45 offen offset:0 sc1
    buffer_load_dwordx4 v[180:183], v10, s[4:7], s45 offen offset:1024 sc1
    buffer_load_dwordx4 v[184:187], v10, s[4:7], s45 offen offset:2048 sc1
    buffer_load_dwordx4 v[188:191], v10, s[4:7], s45 offen offset:3072 sc1
r_top_47:
    v_mov_b32 v28, 0
    v_mov_b32 v29, 0
    v_mov_b32 v30, 0
    v_mov_b32 v31, 0
    s_bfe_u32 s47, s36, 0x10001
wu_54:
    s_memrealtime s[62:63]
    s_waitcnt lgkmcnt(0)
    s_sub_u32 s32, s62, s61
    s_cmp_ge_u32 s32, 0xfffff000
    s_cbranch_scc1 wu_54
    s_mul_i32 s34, s59, 98304
    s_add_u32 s34, s34, 196608
    buffer_load_dwordx4 v[32:35], v4, s[4:7], s34 offen sc1
    buffer_load_dwordx4 v[36:39], v5, s[4:7], s34 offen sc1
    buffer_load_dwordx4 v[40:43], v6, s[4:7], s34 offen sc1
    buffer_load_dwordx4 v[44:47], v7, s[4:7], s34 offen sc1
    buffer_load_dwordx2 v[48:49], v8, s[4:7], s34 offen sc1
    buffer_load_dwordx2 v[50:51], v9, s[4:7], s34 offen sc1
    s_add_u32 s33, s61, 16
wu_55:
    s_memrealtime s[62:63]
    s_waitcnt lgkmcnt(0)
    s_sub_u32 s32, s62, s33
    s_cmp_ge_u32 s32, 0xfffff000
    s_cbranch_scc1 wu_55
    s_mul_i32 s35, s60, 655360
    s_add_u32 s35, s35, 491520
    buffer_load_dwordx4 v[192:195], v12, s[4:7], s35 offen sc1
    buffer_load_dwordx4 v[196:199], v12, s[4:7], s35 offen offset:1024 sc1
    s_mov_b32 s55, 0
    s_waitcnt vmcnt(2)
    v_smfmac_f32_16x16x64_bf16 v[28:31], v[32:35], v[160:167], v11
    v_max3_u32 v14, v35, v39, v43
    v_smfmac_f32_16x16x64_bf16 v[28:31], v[36:39], v[168:175], v11
    v_max3_u32 v14, v14, v47, v49
    v_smfmac_f32_16x16x64_bf16 v[28:31], v[40:43], v[176:183], v11
    v_max_u32 v14, v14, v51
    v_smfmac_f32_16x16x64_bf16 v[28:31], v[44:47], v[184:191], v11
    v_cmp_eq_u32 s[64:65], -1, v14
    s_waitcnt vmcnt(0)
    v_smfmac_f32_16x16x64_bf16 v[28:31], v[48:51], v[192:199], v11
    v_xor_b32 v14, s47, v195
    v_bitop3_b32 v14, v199, s47, v14 bitop3:0xbe
    v_and_b32 v14, 1, v14
    v_cmp_eq_u32 vcc, 1, v14
    s_or_b64 vcc, vcc, s[64:65]
    s_cbranch_vccnz r_try1_52
r_got_51:
    s_add_u32 s59, s59, 1
    s_cmp_eq_u32 s59, 3
    s_cselect_b32 s59, 0, s59
    ds_write_b32 v15, v28 offset:0
    ds_write_b32 v15, v29 offset:72
    ds_write_b32 v15, v30 offset:144
    ds_write_b32 v15, v31 offset:216
    s_waitcnt lgkmcnt(0)
    s_barrier
    s_cmp_lg_u32 s12, 0
    s_cbranch_scc1 w0skip_56
    ds_read2_b64 v[104:107], v16 offset0:0 offset1:72
    ds_read2_b64 v[108:111], v16 offset0:144 offset1:216
    ds_read2_b64 v[112:115], v27 offset0:0 offset1:72
    ds_read2_b64 v[116:119], v27 offset0:144 offset1:216
    s_mul_i32 s37, s59, 65536
    s_waitcnt lgkmcnt(2)
    v_pk_add_f32 v[104:105], v[104:105], v[106:107]
    v_pk_add_f32 v[108:109], v[108:109], v[110:111]
    s_waitcnt lgkmcnt(0)
    v_pk_add_f32 v[112:113], v[112:113], v[114:115]
    v_pk_add_f32 v[116:117], v[116:117], v[118:119]
    v_pk_add_f32 v[104:105], v[104:105], v[108:109]
    v_pk_add_f32 v[112:113], v[112:113], v[116:117]
    v_pk_add_f32 v[104:105], v[104:105], v[112:113]
    v_cvt_pk_bf16_f32 v104, v104, v105
    v_mov_b32 v105, v104
    s_nop 1
    v_permlane16_swap_b32 v104, v105
    v_mov_b32 v106, v104
    v_mov_b32 v107, v105
    s_nop 0
    v_permlane32_swap_b32 v104, v106
    v_permlane32_swap_b32 v105, v107
    s_mov_b32 exec_hi, 0
    buffer_store_dwordx4 v[104:107], v13, s[4:7], s37 offen sc1
    s_mov_b32 exec_hi, -1
w0skip_56:
    s_barrier
    s_memrealtime s[62:63]
    s_mov_b32 s46, s20
    s_waitcnt lgkmcnt(0)
    s_mov_b32 s27, s62
    s_nop 1
    v_min_u32_dpp v136, v136, v136 quad_perm:[1,0,3,2] row_mask:0xf bank_mask:0xf
    s_nop 1
    v_min_u32_dpp v136, v136, v136 quad_perm:[2,3,0,1] row_mask:0xf bank_mask:0xf
    s_nop 1
    v_min_u32_dpp v136, v136, v136 row_half_mirror row_mask:0xf bank_mask:0xf
    s_nop 1
    v_min_u32_dpp v136, v136, v136 row_mirror row_mask:0xf bank_mask:0xf
    s_nop 0
    v_readlane_b32 s32, v136, 0
    v_readlane_b32 s33, v136, 16
    s_min_u32 s32, s32, s33
    v_readlane_b32 s33, v136, 32
    s_min_u32 s32, s32, s33
    v_readlane_b32 s33, v136, 48
    s_min_u32 s32, s32, s33
    s_max_u32 s38, s38, s32
    s_sub_u32 s33, s46, 4
wu_58:
    s_memrealtime s[62:63]
    s_waitcnt lgkmcnt(0)
    s_sub_u32 s32, s62, s33
    s_cmp_ge_u32 s32, 0xfffff000
    s_cbranch_scc1 wu_58
    s_cmp_lg_u32 s12, 0
    s_cbranch_scc1 w1skip_57
    s_add_u32 s34, s59, 2
    s_cmp_ge_u32 s34, 3
    s_cselect_b32 s32, 3, 0
    s_sub_u32 s34, s34, s32
    s_mul_i32 s37, s34, 65536
    s_mov_b32 exec_hi, 0
    buffer_store_dwordx4 v[76:79], v13, s[4:7], s37 offen sc1
    s_mov_b32 exec_hi, -1
w1skip_57:
r_nopub_49:
    s_and_b32 s44, s36, 1
    s_lshl_b32 s44, s44, 14
    s_add_u32 s44, s44, s58
    s_add_u32 s44, s44, 1867776
    v_min_u32 v130, 63, v1
    v_lshlrev_b32 v130, 7, v130
    buffer_load_dwordx2 v[128:129], v130, s[4:7], s44 offen sc1
    s_and_b32 s24, s36, 3
    s_lshl_b32 s24, s24, 14
    s_add_u32 s24, s24, s58
    s_add_u32 s24, s24, 1802248
    v_min_u32 v134, 39, v1
    v_lshlrev_b32 v134, 7, v134
    buffer_load_dwordx2 v[132:133], v134, s[4:7], s24 offen sc1
    s_add_u32 s35, s36, 1
    s_cmp_le_u32 s38, s35
    s_cbranch_scc1 uxn_59
    s_add_u32 s41, s35, 1
    s_cmp_ge_u32 s38, s41
    s_cbranch_scc1 ux_ok_61
    s_mov_b32 s39, 0
ux_62:
    buffer_load_dword v2, v17, s[4:7], 0 offen sc1
    s_waitcnt vmcnt(0)
    s_nop 1
    v_min_u32_dpp v2, v2, v2 quad_perm:[1,0,3,2] row_mask:0xf bank_mask:0xf
    s_nop 1
    v_min_u32_dpp v2, v2, v2 quad_perm:[2,3,0,1] row_mask:0xf bank_mask:0xf
    s_nop 1
    v_min_u32_dpp v2, v2, v2 row_half_mirror row_mask:0xf bank_mask:0xf
    s_nop 1
    v_min_u32_dpp v2, v2, v2 row_mirror row_mask:0xf bank_mask:0xf
    s_nop 0
    v_readlane_b32 s32, v2, 0
    v_readlane_b32 s33, v2, 16
    s_min_u32 s32, s32, s33
    v_readlane_b32 s33, v2, 32
    s_min_u32 s32, s32, s33
    v_readlane_b32 s33, v2, 48
    s_min_u32 s38, s32, s33
    s_cmp_ge_u32 s38, s41
    s_cbranch_scc1 ux_ok_61
    s_sleep 2
    s_add_u32 s39, s39, 1
    s_cmp_lt_u32 s39, 20000
    s_cbranch_scc1 ux_62
    s_branch L_end2
ux_ok_61:
    s_mul_i32 s45, s35, 1310720
    s_add_u32 s45, s45, s40
    buffer_load_dwordx4 v[200:203], v10, s[4:7], s45 offen offset:0 sc1
    buffer_load_dwordx4 v[204:207], v10, s[4:7], s45 offen offset:1024 sc1
    buffer_load_dwordx4 v[208:211], v10, s[4:7], s45 offen offset:2048 sc1
    buffer_load_dwordx4 v[212:215], v10, s[4:7], s45 offen offset:3072 sc1
    s_add_u32 s45, s45, 4096
    buffer_load_dwordx4 v[216:219], v10, s[4:7], s45 offen offset:0 sc1
    buffer_load_dwordx4 v[220:223], v10, s[4:7], s45 offen offset:1024 sc1
    buffer_load_dwordx4 v[224:227], v10, s[4:7], s45 offen offset:2048 sc1
    buffer_load_dwordx4 v[228:231], v10, s[4:7], s45 offen offset:3072 sc1
    s_mov_b32 s39, 0
    s_waitcnt vmcnt(9)
hr_63:
    v_cmp_ne_u32 vcc, s36, v129
    s_cbranch_vccz hro_64
    buffer_load_dwordx2 v[128:129], v130, s[4:7], s44 offen sc1
    s_add_u32 s39, s39, 1
    s_cmp_lt_u32 s39, 20000
    s_waitcnt vmcnt(0)
    s_cbranch_scc1 hr_63
    s_branch L_end2
hro_64:
    v_readfirstlane_b32 s34, v128
    s_nop 1
    v_subrev_u32 v128, s34, v128
    s_nop 1
    v_max_i32_dpp v128, v128, v128 quad_perm:[1,0,3,2] row_mask:0xf bank_mask:0xf
    s_nop 1
    v_max_i32_dpp v128, v128, v128 quad_perm:[2,3,0,1] row_mask:0xf bank_mask:0xf
    s_nop 1
    v_max_i32_dpp v128, v128, v128 row_half_mirror row_mask:0xf bank_mask:0xf
    s_nop 1
    v_max_i32_dpp v128, v128, v128 row_mirror row_mask:0xf bank_mask:0xf
    s_nop 0
    v_readlane_b32 s32, v128, 0
    v_readlane_b32 s33, v128, 16
    s_max_i32 s32, s32, s33
    v_readlane_b32 s33, v128, 32
    s_max_i32 s32, s32, s33
    v_readlane_b32 s33, v128, 48
    s_max_i32 s32, s32, s33
    s_add_u32 s32, s32, s34
    s_mov_b32 s25, s32
    s_mov_b32 s39, 0
    s_waitcnt vmcnt(8)
hr_65:
    v_cmp_ne_u32 vcc, s36, v133
    s_cbranch_vccz hro_66
    buffer_load_dwordx2 v[132:133], v134, s[4:7], s24 offen sc1
    s_add_u32 s39, s39, 1
    s_cmp_lt_u32 s39, 20000
    s_waitcnt vmcnt(0)
    s_cbranch_scc1 hr_65
    s_branch L_end2
hro_66:
    v_readfirstlane_b32 s34, v132
    s_nop 1
    v_subrev_u32 v132, s34, v132
    s_nop 1
    v_max_i32_dpp v132, v132, v132 quad_perm:[1,0,3,2] row_mask:0xf bank_mask:0xf
    s_nop 1
    v_max_i32_dpp v132, v132, v132 quad_perm:[2,3,0,1] row_mask:0xf bank_mask:0xf
    s_nop 1
    v_max_i32_dpp v132, v132, v132 row_half_mirror row_mask:0xf bank_mask:0xf
    s_nop 1
    v_max_i32_dpp v132, v132, v132 row_mirror row_mask:0xf bank_mask:0xf
    s_nop 0
    v_readlane_b32 s32, v132, 0
    v_readlane_b32 s33, v132, 16
    s_max_i32 s32, s32, s33
    v_readlane_b32 s33, v132, 32
    s_max_i32 s32, s32, s33
    v_readlane_b32 s33, v132, 48
    s_max_i32 s32, s32, s33
    s_add_u32 s32, s32, s34
    s_mov_b32 s26, s32
    s_sub_u32 s35, s25, s21
    s_sub_u32 s33, s26, s21
    s_cmp_le_i32 s33, 0
    s_cbranch_scc0 ad_67
    s_lshl_b32 s35, s35, 1
    s_cmp_gt_i32 s35, s18
    s_cselect_b32 s33, 1, -1
    s_add_u32 s18, s18, s33
    s_sub_u32 s35, s35, s18
    s_cmp_gt_i32 s35, 32
    s_cselect_b32 s33, 4, 0
    s_add_u32 s29, s29, s33
    s_min_u32 s29, s29, 12
ad_67:
    s_cmp_lt_u32 s36, 34
    s_cselect_b32 s33, 32, 30
    s_lshr_b32 s16, s18, 1
    s_add_u32 s16, s16, s33
    s_sub_u32 s35, s26, s22
    s_cmp_eq_u32 s23, 0
    s_cbranch_scc0 ad_68
    s_lshl_b32 s35, s35, 1
    s_cmp_gt_i32 s35, s19
    s_cselect_b32 s33, 1, -1
    s_add_u32 s19, s19, s33
    s_sub_u32 s35, s35, s19
    s_cmp_gt_i32 s35, 32
    s_cselect_b32 s33, 4, 0
    s_add_u32 s28, s28, s33
    s_min_u32 s28, s28, 12
ad_68:
    s_cmp_lt_u32 s36, 34
    s_cselect_b32 s33, 9, 7
    s_lshr_b32 s17, s19, 1
    s_add_u32 s17, s17, s33
    s_and_b32 s33, s36, 3
    s_cmp_eq_u32 s33, 0
    s_cselect_b32 s33, 1, 0
    s_sub_i32 s28, s28, s33
    s_max_i32 s28, s28, 0
    s_sub_i32 s29, s29, s33
    s_max_i32 s29, s29, 0
    s_add_u32 s16, s16, s28
    s_add_u32 s17, s17, s29
    s_sub_u32 s32, s25, s61
    s_add_u32 s32, s32, 22
    s_add_u32 s33, s32, 90
    s_cmp_le_i32 s32, 0
    s_cselect_b32 s33, 50, s33
    s_cmp_le_i32 s32, 0
    s_cselect_b32 s33, 0, s33
    s_mov_b32 s23, s33
    s_mov_b32 s22, s61
    s_mov_b32 s21, s20
    s_add_u32 s61, s20, s16
    s_add_u32 s61, s61, s33
    s_add_u32 s20, s61, s17
    s_add_u32 s35, s36, 1
    s_and_b32 s32, s35, 3
    s_lshl_b32 s32, s32, 14
    s_lshl_b32 s33, s14, 7
    s_add_u32 s32, s32, s33
    s_add_u32 s32, s32, s58
    s_add_u32 s32, s32, 1802240
    v_mov_b32 v104, s20
    v_mov_b32 v105, s35
    v_mov_b32 v106, s27
    v_mov_b32 v107, s35
    v_mov_b32 v108, 0
    s_mov_b64 exec, 1
    buffer_store_dwordx4 v[104:107], v108, s[4:7], s32 offen sc1
    s_mov_b64 exec, -1
uxj_60:
    s_add_u32 s32, s36, 5
    s_min_u32 s32, s32, 64
    s_cmp_ge_u32 s38, s32
    s_cbranch_scc1 npg_69
    v_mov_b32 v3, 2179204
    buffer_load_dword v136, v3, s[4:7], 0 offen sc1
npg_69:
    s_lshl_b32 s32, s14, 2
    s_add_u32 s32, s32, s12
    s_cmp_lg_u32 s32, 3
    s_cbranch_scc1 pw_70
    v_mov_b32 v2, s36
    v_mov_b32 v3, 2179072
    s_mov_b64 exec, 1
    buffer_store_dword v2, v3, s[4:7], 0 offen sc1
    s_mov_b64 exec, -1
pw_70:
    s_add_u32 s36, s36, 1
    s_xor_b32 s60, s60, 1
    s_cmp_eq_u32 s36, 63
    s_cbranch_scc1 r_done_46
    v_mov_b32 v28, 0
    v_mov_b32 v29, 0
    v_mov_b32 v30, 0
    v_mov_b32 v31, 0
    s_bfe_u32 s47, s36, 0x10001
wu_77:
    s_memrealtime s[62:63]
    s_waitcnt lgkmcnt(0)
    s_sub_u32 s32, s62, s61
    s_cmp_ge_u32 s32, 0xfffff000
    s_cbranch_scc1 wu_77
    s_mul_i32 s34, s59, 98304
    s_add_u32 s34, s34, 196608
    buffer_load_dwordx4 v[32:35], v4, s[4:7], s34 offen sc1
    buffer_load_dwordx4 v[36:39], v5, s[4:7], s34 offen sc1
    buffer_load_dwordx4 v[40:43], v6, s[4:7], s34 offen sc1
    buffer_load_dwordx4 v[44:47], v7, s[4:7], s34 offen sc1
    buffer_load_dwordx2 v[48:49], v8, s[4:7], s34 offen sc1
    buffer_load_dwordx2 v[50:51], v9, s[4:7], s34 offen sc1
    s_add_u32 s33, s61, 16
wu_78:
    s_memrealtime s[62:63]
    s_waitcnt lgkmcnt(0)
    s_sub_u32 s32, s62, s33
    s_cmp_ge_u32 s32, 0xfffff000
    s_cbranch_scc1 wu_78
    s_mul_i32 s35, s60, 655360
    s_add_u32 s35, s35, 491520
    buffer_load_dwordx4 v[232:235], v12, s[4:7], s35 offen sc1
    buffer_load_dwordx4 v[236:239], v12, s[4:7], s35 offen offset:1024 sc1
    s_mov_b32 s55, 0
    s_waitcnt vmcnt(2)
    v_smfmac_f32_16x16x64_bf16 v[28:31], v[32:35], v[200:207], v11
    v_max3_u32 v14, v35, v39, v43
    v_smfmac_f32_16x16x64_bf16 v[28:31], v[36:39], v[208:215], v11
    v_max3_u32 v14, v14, v47, v49
    v_smfmac_f32_16x16x64_bf16 v[28:31], v[40:43], v[216:223], v11
    v_max_u32 v14, v14, v51
    v_smfmac_f32_16x16x64_bf16 v[28:31], v[44:47], v[224:231], v11
    v_cmp_eq_u32 s[64:65], -1, v14
    s_waitcnt vmcnt(0)
    v_smfmac_f32_16x16x64_bf16 v[28:31], v[48:51], v[232:239], v11
    v_xor_b32 v14, s47, v235
    v_bitop3_b32 v14, v239, s47, v14 bitop3:0xbe
    v_and_b32 v14, 1, v14
    v_cmp_eq_u32 vcc, 1, v14
    s_or_b64 vcc, vcc, s[64:65]
    s_cbranch_vccnz r_try1_75
r_got_74:
    s_add_u32 s59, s59, 1
    s_cmp_eq_u32 s59, 3
    s_cselect_b32 s59, 0, s59
    ds_write_b32 v15, v28 offset:0
    ds_write_b32 v15, v29 offset:72
    ds_write_b32 v15, v30 offset:144
    ds_write_b32 v15, v31 offset:216
    s_waitcnt lgkmcnt(0)
    s_barrier
    s_cmp_lg_u32 s12, 0
    s_cbranch_scc1 w0skip_79
    ds_read2_b64 v[104:107], v16 offset0:0 offset1:72
    ds_read2_b64 v[108:111], v16 offset0:144 offset1:216
    ds_read2_b64 v[112:115], v27 offset0:0 offset1:72
    ds_read2_b64 v[116:119], v27 offset0:144 offset1:216
    s_mul_i32 s37, s59, 65536
    s_waitcnt lgkmcnt(2)
    v_pk_add_f32 v[104:105], v[104:105], v[106:107]
    v_pk_add_f32 v[108:109], v[108:109], v[110:111]
    s_waitcnt lgkmcnt(0)
    v_pk_add_f32 v[112:113], v[112:113], v[114:115]
    v_pk_add_f32 v[116:117], v[116:117], v[118:119]
    v_pk_add_f32 v[104:105], v[104:105], v[108:109]
    v_pk_add_f32 v[112:113], v[112:113], v[116:117]
    v_pk_add_f32 v[104:105], v[104:105], v[112:113]
    v_cvt_pk_bf16_f32 v104, v104, v105
    v_mov_b32 v105, v104
    s_nop 1
    v_permlane16_swap_b32 v104, v105
    v_mov_b32 v106, v104
    v_mov_b32 v107, v105
    s_nop 0
    v_permlane32_swap_b32 v104, v106
    v_permlane32_swap_b32 v105, v107
    s_mov_b32 exec_hi, 0
    buffer_store_dwordx4 v[104:107], v13, s[4:7], s37 offen sc1
    s_mov_b32 exec_hi, -1
w0skip_79:
    s_barrier
    s_memrealtime s[62:63]
    s_mov_b32 s46, s20
    s_waitcnt lgkmcnt(0)
    s_mov_b32 s27, s62
    s_nop 1
    v_min_u32_dpp v136, v136, v136 quad_perm:[1,0,3,2] row_mask:0xf bank_mask:0xf
    s_nop 1
    v_min_u32_dpp v136, v136, v136 quad_perm:[2,3,0,1] row_mask:0xf bank_mask:0xf
    s_nop 1
    v_min_u32_dpp v136, v136, v136 row_half_mirror row_mask:0xf bank_mask:0xf
    s_nop 1
    v_min_u32_dpp v136, v136, v136 row_mirror row_mask:0xf bank_mask:0xf
    s_nop 0
    v_readlane_b32 s32, v136, 0
    v_readlane_b32 s33, v136, 16
    s_min_u32 s32, s32, s33
    v_readlane_b32 s33, v136, 32
    s_min_u32 s32, s32, s33
    v_readlane_b32 s33, v136, 48
    s_min_u32 s32, s32, s33
    s_max_u32 s38, s38, s32
    s_sub_u32 s33, s46, 4
wu_81:
    s_memrealtime s[62:63]
    s_waitcnt lgkmcnt(0)
    s_sub_u32 s32, s62, s33
    s_cmp_ge_u32 s32, 0xfffff000
    s_cbranch_scc1 wu_81
    s_cmp_lg_u32 s12, 0
    s_cbranch_scc1 w1skip_80
    s_add_u32 s34, s59, 2
    s_cmp_ge_u32 s34, 3
    s_cselect_b32 s32, 3, 0
    s_sub_u32 s34, s34, s32
    s_mul_i32 s37, s34, 65536
    s_mov_b32 exec_hi, 0
    buffer_store_dwordx4 v[76:79], v13, s[4:7], s37 offen sc1
    s_mov_b32 exec_hi, -1
w1skip_80:
r_nopub_72:
    s_and_b32 s44, s36, 1
    s_lshl_b32 s44, s44, 14
    s_add_u32 s44, s44, s58
    s_add_u32 s44, s44, 1867776
    v_min_u32 v130, 63, v1
    v_lshlrev_b32 v130, 7, v130
    buffer_load_dwordx2 v[128:129], v130, s[4:7], s44 offen sc1
    s_and_b32 s24, s36, 3
    s_lshl_b32 s24, s24, 14
    s_add_u32 s24, s24, s58
    s_add_u32 s24, s24, 1802248
    v_min_u32 v134, 39, v1
    v_lshlrev_b32 v134, 7, v134
    buffer_load_dwordx2 v[132:133], v134, s[4:7], s24 offen sc1
    s_add_u32 s35, s36, 1
    s_cmp_le_u32 s38, s35
    s_cbranch_scc1 uxn_82
    s_add_u32 s41, s35, 1
    s_cmp_ge_u32 s38, s41
    s_cbranch_scc1 ux_ok_84
    s_mov_b32 s39, 0
ux_85:
    buffer_load_dword v2, v17, s[4:7], 0 offen sc1
    s_waitcnt vmcnt(0)
    s_nop 1
    v_min_u32_dpp v2, v2, v2 quad_perm:[1,0,3,2] row_mask:0xf bank_mask:0xf
    s_nop 1
    v_min_u32_dpp v2, v2, v2 quad_perm:[2,3,0,1] row_mask:0xf bank_mask:0xf
    s_nop 1
    v_min_u32_dpp v2, v2, v2 row_half_mirror row_mask:0xf bank_mask:0xf
    s_nop 1
    v_min_u32_dpp v2, v2, v2 row_mirror row_mask:0xf bank_mask:0xf
    s_nop 0
    v_readlane_b32 s32, v2, 0
    v_readlane_b32 s33, v2, 16
    s_min_u32 s32, s32, s33
    v_readlane_b32 s33, v2, 32
    s_min_u32 s32, s32, s33
    v_readlane_b32 s33, v2, 48
    s_min_u32 s38, s32, s33
    s_cmp_ge_u32 s38, s41
    s_cbranch_scc1 ux_ok_84
    s_sleep 2
    s_add_u32 s39, s39, 1
    s_cmp_lt_u32 s39, 20000
    s_cbranch_scc1 ux_85
    s_branch L_end2
ux_ok_84:
    s_mul_i32 s45, s35, 1310720
    s_add_u32 s45, s45, s40
    buffer_load_dwordx4 v[160:163], v10, s[4:7], s45 offen offset:0 sc1
    buffer_load_dwordx4 v[164:167], v10, s[4:7], s45 offen offset:1024 sc1
    buffer_load_dwordx4 v[168:171], v10, s[4:7], s45 offen offset:2048 sc1
    buffer_load_dwordx4 v[172:175], v10, s[4:7], s45 offen offset:3072 sc1
    s_add_u32 s45, s45, 4096
    buffer_load_dwordx4 v[176:179], v10, s[4:7], s45 offen offset:0 sc1
    buffer_load_dwordx4 v[180:183], v10, s[4:7], s45 offen offset:1024 sc1
    buffer_load_dwordx4 v[184:187], v10, s[4:7], s45 offen offset:2048 sc1
    buffer_load_dwordx4 v[188:191], v10, s[4:7], s45 offen offset:3072 sc1
    s_mov_b32 s39, 0
    s_waitcnt vmcnt(9)
hr_86:
    v_cmp_ne_u32 vcc, s36, v129
    s_cbranch_vccz hro_87
    buffer_load_dwordx2 v[128:129], v130, s[4:7], s44 offen sc1
    s_add_u32 s39, s39, 1
    s_cmp_lt_u32 s39, 20000
    s_waitcnt vmcnt(0)
    s_cbranch_scc1 hr_86
    s_branch L_end2
hro_87:
    v_readfirstlane_b32 s34, v128
    s_nop 1
    v_subrev_u32 v128, s34, v128
    s_nop 1
    v_max_i32_dpp v128, v128, v128 quad_perm:[1,0,3,2] row_mask:0xf bank_mask:0xf
    s_nop 1
    v_max_i32_dpp v128, v128, v128 quad_perm:[2,3,0,1] row_mask:0xf bank_mask:0xf
    s_nop 1
    v_max_i32_dpp v128, v128, v128 row_half_mirror row_mask:0xf bank_mask:0xf
    s_nop 1
    v_max_i32_dpp v128, v128, v128 row_mirror row_mask:0xf bank_mask:0xf
    s_nop 0
    v_readlane_b32 s32, v128, 0
    v_readlane_b32 s33, v128, 16
    s_max_i32 s32, s32, s33
    v_readlane_b32 s33, v128, 32
    s_max_i32 s32, s32, s33
    v_readlane_b32 s33, v128, 48
    s_max_i32 s32, s32, s33
    s_add_u32 s32, s32, s34
    s_mov_b32 s25, s32
    s_mov_b32 s39, 0
    s_waitcnt vmcnt(8)
hr_88:
    v_cmp_ne_u32 vcc, s36, v133
    s_cbranch_vccz hro_89
    buffer_load_dwordx2 v[132:133], v134, s[4:7], s24 offen sc1
    s_add_u32 s39, s39, 1
    s_cmp_lt_u32 s39, 20000
    s_waitcnt vmcnt(0)
    s_cbranch_scc1 hr_88
    s_branch L_end2
hro_89:
    v_readfirstlane_b32 s34, v132
    s_nop 1
    v_subrev_u32 v132, s34, v132
    s_nop 1
    v_max_i32_dpp v132, v132, v132 quad_perm:[1,0,3,2] row_mask:0xf bank_mask:0xf
    s_nop 1
    v_max_i32_dpp v132, v132, v132 quad_perm:[2,3,0,1] row_mask:0xf bank_mask:0xf
    s_nop 1
    v_max_i32_dpp v132, v132, v132 row_half_mirror row_mask:0xf bank_mask:0xf
    s_nop 1
    v_max_i32_dpp v132, v132, v132 row_mirror row_mask:0xf bank_mask:0xf
    s_nop 0
    v_readlane_b32 s32, v132, 0
    v_readlane_b32 s33, v132, 16
    s_max_i32 s32, s32, s33
    v_readlane_b32 s33, v132, 32
    s_max_i32 s32, s32, s33
    v_readlane_b32 s33, v132, 48
    s_max_i32 s32, s32, s33
    s_add_u32 s32, s32, s34
    s_mov_b32 s26, s32
    s_sub_u32 s35, s25, s21
    s_sub_u32 s33, s26, s21
    s_cmp_le_i32 s33, 0
    s_cbranch_scc0 ad_90
    s_lshl_b32 s35, s35, 1
    s_cmp_gt_i32 s35, s18
    s_cselect_b32 s33, 1, -1
    s_add_u32 s18, s18, s33
    s_sub_u32 s35, s35, s18
    s_cmp_gt_i32 s35, 32
    s_cselect_b32 s33, 4, 0
    s_add_u32 s29, s29, s33
    s_min_u32 s29, s29, 12
ad_90:
    s_cmp_lt_u32 s36, 34
    s_cselect_b32 s33, 32, 30
    s_lshr_b32 s16, s18, 1
    s_add_u32 s16, s16, s33
    s_sub_u32 s35, s26, s22
    s_cmp_eq_u32 s23, 0
    s_cbranch_scc0 ad_91
    s_lshl_b32 s35, s35, 1
    s_cmp_gt_i32 s35, s19
    s_cselect_b32 s33, 1, -1
    s_add_u32 s19, s19, s33
    s_sub_u32 s35, s35, s19
    s_cmp_gt_i32 s35, 32
    s_cselect_b32 s33, 4, 0
    s_add_u32 s28, s28, s33
    s_min_u32 s28, s28, 12
ad_91:
    s_cmp_lt_u32 s36, 34
    s_cselect_b32 s33, 9, 7
    s_lshr_b32 s17, s19, 1
    s_add_u32 s17, s17, s33
    s_and_b32 s33, s36, 3
    s_cmp_eq_u32 s33, 0
    s_cselect_b32 s33, 1, 0
    s_sub_i32 s28, s28, s33
    s_max_i32 s28, s28, 0
    s_sub_i32 s29, s29, s33
    s_max_i32 s29, s29, 0
    s_add_u32 s16, s16, s28
    s_add_u32 s17, s17, s29
    s_sub_u32 s32, s25, s61
    s_add_u32 s32, s32, 22
    s_add_u32 s33, s32, 90
    s_cmp_le_i32 s32, 0
    s_cselect_b32 s33, 50, s33
    s_cmp_le_i32 s32, 0
    s_cselect_b32 s33, 0, s33
    s_mov_b32 s23, s33
    s_mov_b32 s22, s61
    s_mov_b32 s21, s20
    s_add_u32 s61, s20, s16
    s_add_u32 s61, s61, s33
    s_add_u32 s20, s61, s17
    s_add_u32 s35, s36, 1
    s_and_b32 s32, s35, 3
    s_lshl_b32 s32, s32, 14
    s_lshl_b32 s33, s14, 7
    s_add_u32 s32, s32, s33
    s_add_u32 s32, s32, s58
    s_add_u32 s32, s32, 1802240
    v_mov_b32 v104, s20
    v_mov_b32 v105, s35
    v_mov_b32 v106, s27
    v_mov_b32 v107, s35
    v_mov_b32 v108, 0
    s_mov_b64 exec, 1
    buffer_store_dwordx4 v[104:107], v108, s[4:7], s32 offen sc1
    s_mov_b64 exec, -1
uxj_83:
    s_add_u32 s32, s36, 5
    s_min_u32 s32, s32, 64
    s_cmp_ge_u32 s38, s32
    s_cbranch_scc1 npg_92
    v_mov_b32 v3, 2179204
    buffer_load_dword v136, v3, s[4:7], 0 offen sc1
npg_92:
    s_lshl_b32 s32, s14, 2
    s_add_u32 s32, s32, s12
    s_cmp_lg_u32 s32, 3
    s_cbranch_scc1 pw_93
    v_mov_b32 v2, s36
    v_mov_b32 v3, 2179072
    s_mov_b64 exec, 1
    buffer_store_dword v2, v3, s[4:7], 0 offen sc1
    s_mov_b64 exec, -1
pw_93:
    s_add_u32 s36, s36, 1
    s_xor_b32 s60, s60, 1
    s_cmp_eq_u32 s36, 63
    s_cbranch_scc1 r_done_46
    s_branch r_top_47
r_done_46:
    s_endpgm
r_try1_52:
r_poll_53:
    s_add_u32 s55, s55, 1
    s_cmp_gt_u32 s55, 20000
    s_cbranch_scc1 L_end2
    s_cmp_lt_u32 s55, 12
    s_cbranch_scc1 ns_94
    s_sleep 2
ns_94:
    s_mul_i32 s34, s59, 98304
    s_add_u32 s34, s34, 245760
    buffer_load_dwordx4 v[32:35], v4, s[4:7], s34 offen sc1
    buffer_load_dwordx4 v[36:39], v5, s[4:7], s34 offen sc1
    buffer_load_dwordx4 v[40:43], v6, s[4:7], s34 offen sc1
    buffer_load_dwordx4 v[44:47], v7, s[4:7], s34 offen sc1
    buffer_load_dwordx2 v[48:49], v8, s[4:7], s34 offen sc1
    buffer_load_dwordx2 v[50:51], v9, s[4:7], s34 offen sc1
    s_mul_i32 s35, s60, 655360
    s_add_u32 s35, s35, 491520
    buffer_load_dwordx4 v[192:195], v12, s[4:7], s35 offen sc1
    buffer_load_dwordx4 v[196:199], v12, s[4:7], s35 offen offset:1024 sc1
    v_mov_b32 v28, 0
    v_mov_b32 v29, 0
    v_mov_b32 v30, 0
    v_mov_b32 v31, 0
    s_waitcnt vmcnt(0)
    s_nop 0
    v_smfmac_f32_16x16x64_bf16 v[28:31], v[32:35], v[160:167], v11
    v_max3_u32 v14, v35, v39, v43
    v_smfmac_f32_16x16x64_bf16 v[28:31], v[36:39], v[168:175], v11
    v_max3_u32 v14, v14, v47, v49
    v_smfmac_f32_16x16x64_bf16 v[28:31], v[40:43], v[176:183], v11
    v_max_u32 v14, v14, v51
    v_smfmac_f32_16x16x64_bf16 v[28:31], v[44:47], v[184:191], v11
    v_cmp_eq_u32 s[64:65], -1, v14
    v_smfmac_f32_16x16x64_bf16 v[28:31], v[48:51], v[192:199], v11
    v_xor_b32 v14, s47, v195
    v_bitop3_b32 v14, v199, s47, v14 bitop3:0xbe
    v_and_b32 v14, 1, v14
    v_cmp_eq_u32 vcc, 1, v14
    s_or_b64 vcc, vcc, s[64:65]
    s_cbranch_vccz r_got_51
    s_branch r_poll_53
uxn_59:
    s_mov_b32 s39, 0
    s_waitcnt vmcnt(1)
hr_95:
    v_cmp_ne_u32 vcc, s36, v129
    s_cbranch_vccz hro_96
    buffer_load_dwordx2 v[128:129], v130, s[4:7], s44 offen sc1
    s_add_u32 s39, s39, 1
    s_cmp_lt_u32 s39, 20000
    s_waitcnt vmcnt(0)
    s_cbranch_scc1 hr_95
    s_branch L_end2
hro_96:
    v_readfirstlane_b32 s34, v128
    s_nop 1
    v_subrev_u32 v128, s34, v128
    s_nop 1
    v_max_i32_dpp v128, v128, v128 quad_perm:[1,0,3,2] row_mask:0xf bank_mask:0xf
    s_nop 1
    v_max_i32_dpp v128, v128, v128 quad_perm:[2,3,0,1] row_mask:0xf bank_mask:0xf
    s_nop 1
    v_max_i32_dpp v128, v128, v128 row_half_mirror row_mask:0xf bank_mask:0xf
    s_nop 1
    v_max_i32_dpp v128, v128, v128 row_mirror row_mask:0xf bank_mask:0xf
    s_nop 0
    v_readlane_b32 s32, v128, 0
    v_readlane_b32 s33, v128, 16
    s_max_i32 s32, s32, s33
    v_readlane_b32 s33, v128, 32
    s_max_i32 s32, s32, s33
    v_readlane_b32 s33, v128, 48
    s_max_i32 s32, s32, s33
    s_add_u32 s32, s32, s34
    s_mov_b32 s25, s32
    s_mov_b32 s39, 0
    s_waitcnt vmcnt(0)
hr_97:
    v_cmp_ne_u32 vcc, s36, v133
    s_cbranch_vccz hro_98
    buffer_load_dwordx2 v[132:133], v134, s[4:7], s24 offen sc1
    s_add_u32 s39, s39, 1
    s_cmp_lt_u32 s39, 20000
    s_waitcnt vmcnt(0)
    s_cbranch_scc1 hr_97
    s_branch L_end2
hro_98:
    v_readfirstlane_b32 s34, v132
    s_nop 1
    v_subrev_u32 v132, s34, v132
    s_nop 1
    v_max_i32_dpp v132, v132, v132 quad_perm:[1,0,3,2] row_mask:0xf bank_mask:0xf
    s_nop 1
    v_max_i32_dpp v132, v132, v132 quad_perm:[2,3,0,1] row_mask:0xf bank_mask:0xf
    s_nop 1
    v_max_i32_dpp v132, v132, v132 row_half_mirror row_mask:0xf bank_mask:0xf
    s_nop 1
    v_max_i32_dpp v132, v132, v132 row_mirror row_mask:0xf bank_mask:0xf
    s_nop 0
    v_readlane_b32 s32, v132, 0
    v_readlane_b32 s33, v132, 16
    s_max_i32 s32, s32, s33
    v_readlane_b32 s33, v132, 32
    s_max_i32 s32, s32, s33
    v_readlane_b32 s33, v132, 48
    s_max_i32 s32, s32, s33
    s_add_u32 s32, s32, s34
    s_mov_b32 s26, s32
    s_sub_u32 s35, s25, s21
    s_sub_u32 s33, s26, s21
    s_cmp_le_i32 s33, 0
    s_cbranch_scc0 ad_99
    s_lshl_b32 s35, s35, 1
    s_cmp_gt_i32 s35, s18
    s_cselect_b32 s33, 1, -1
    s_add_u32 s18, s18, s33
    s_sub_u32 s35, s35, s18
    s_cmp_gt_i32 s35, 32
    s_cselect_b32 s33, 4, 0
    s_add_u32 s29, s29, s33
    s_min_u32 s29, s29, 12
ad_99:
    s_cmp_lt_u32 s36, 34
    s_cselect_b32 s33, 32, 30
    s_lshr_b32 s16, s18, 1
    s_add_u32 s16, s16, s33
    s_sub_u32 s35, s26, s22
    s_cmp_eq_u32 s23, 0
    s_cbranch_scc0 ad_100
    s_lshl_b32 s35, s35, 1
    s_cmp_gt_i32 s35, s19
    s_cselect_b32 s33, 1, -1
    s_add_u32 s19, s19, s33
    s_sub_u32 s35, s35, s19
    s_cmp_gt_i32 s35, 32
    s_cselect_b32 s33, 4, 0
    s_add_u32 s28, s28, s33
    s_min_u32 s28, s28, 12
ad_100:
    s_cmp_lt_u32 s36, 34
    s_cselect_b32 s33, 9, 7
    s_lshr_b32 s17, s19, 1
    s_add_u32 s17, s17, s33
    s_and_b32 s33, s36, 3
    s_cmp_eq_u32 s33, 0
    s_cselect_b32 s33, 1, 0
    s_sub_i32 s28, s28, s33
    s_max_i32 s28, s28, 0
    s_sub_i32 s29, s29, s33
    s_max_i32 s29, s29, 0
    s_add_u32 s16, s16, s28
    s_add_u32 s17, s17, s29
    s_sub_u32 s32, s25, s61
    s_add_u32 s32, s32, 22
    s_add_u32 s33, s32, 90
    s_cmp_le_i32 s32, 0
    s_cselect_b32 s33, 50, s33
    s_cmp_le_i32 s32, 0
    s_cselect_b32 s33, 0, s33
    s_mov_b32 s23, s33
    s_mov_b32 s22, s61
    s_mov_b32 s21, s20
    s_add_u32 s61, s20, s16
    s_add_u32 s61, s61, s33
    s_add_u32 s20, s61, s17
    s_add_u32 s35, s36, 1
    s_and_b32 s32, s35, 3
    s_lshl_b32 s32, s32, 14
    s_lshl_b32 s33, s14, 7
    s_add_u32 s32, s32, s33
    s_add_u32 s32, s32, s58
    s_add_u32 s32, s32, 1802240
    v_mov_b32 v104, s20
    v_mov_b32 v105, s35
    v_mov_b32 v106, s27
    v_mov_b32 v107, s35
    v_mov_b32 v108, 0
    s_mov_b64 exec, 1
    buffer_store_dwordx4 v[104:107], v108, s[4:7], s32 offen sc1
    s_mov_b64 exec, -1
    s_add_u32 s35, s36, 1
    s_add_u32 s41, s35, 1
    s_cmp_ge_u32 s38, s41
    s_cbranch_scc1 ux_ok_101
    s_mov_b32 s39, 0
ux_102:
    buffer_load_dword v2, v17, s[4:7], 0 offen sc1
    s_waitcnt vmcnt(0)
    s_nop 1
    v_min_u32_dpp v2, v2, v2 quad_perm:[1,0,3,2] row_mask:0xf bank_mask:0xf
    s_nop 1
    v_min_u32_dpp v2, v2, v2 quad_perm:[2,3,0,1] row_mask:0xf bank_mask:0xf
    s_nop 1
    v_min_u32_dpp v2, v2, v2 row_half_mirror row_mask:0xf bank_mask:0xf
    s_nop 1
    v_min_u32_dpp v2, v2, v2 row_mirror row_mask:0xf bank_mask:0xf
    s_nop 0
    v_readlane_b32 s32, v2, 0
    v_readlane_b32 s33, v2, 16
    s_min_u32 s32, s32, s33
    v_readlane_b32 s33, v2, 32
    s_min_u32 s32, s32, s33
    v_readlane_b32 s33, v2, 48
    s_min_u32 s38, s32, s33
    s_cmp_ge_u32 s38, s41
    s_cbranch_scc1 ux_ok_101
    s_sleep 2
    s_add_u32 s39, s39, 1
    s_cmp_lt_u32 s39, 20000
    s_cbranch_scc1 ux_102
    s_branch L_end2
ux_ok_101:
    s_mul_i32 s45, s35, 1310720
    s_add_u32 s45, s45, s40
    buffer_load_dwordx4 v[200:203], v10, s[4:7], s45 offen offset:0 sc1
    buffer_load_dwordx4 v[204:207], v10, s[4:7], s45 offen offset:1024 sc1
    buffer_load_dwordx4 v[208:211], v10, s[4:7], s45 offen offset:2048 sc1
    buffer_load_dwordx4 v[212:215], v10, s[4:7], s45 offen offset:3072 sc1
    s_add_u32 s45, s45, 4096
    buffer_load_dwordx4 v[216:219], v10, s[4:7], s45 offen offset:0 sc1
    buffer_load_dwordx4 v[220:223], v10, s[4:7], s45 offen offset:1024 sc1
    buffer_load_dwordx4 v[224:227], v10, s[4:7], s45 offen offset:2048 sc1
    buffer_load_dwordx4 v[228:231], v10, s[4:7], s45 offen offset:3072 sc1
    s_branch uxj_60
r_try1_75:
r_poll_76:
    s_add_u32 s55, s55, 1
    s_cmp_gt_u32 s55, 20000
    s_cbranch_scc1 L_end2
    s_cmp_lt_u32 s55, 12
    s_cbranch_scc1 ns_103
    s_sleep 2
ns_103:
    s_mul_i32 s34, s59, 98304
    s_add_u32 s34, s34, 245760
    buffer_load_dwordx4 v[32:35], v4, s[4:7], s34 offen sc1
    buffer_load_dwordx4 v[36:39], v5, s[4:7], s34 offen sc1
    buffer_load_dwordx4 v[40:43], v6, s[4:7], s34 offen sc1
    buffer_load_dwordx4 v[44:47], v7, s[4:7], s34 offen sc1
    buffer_load_dwordx2 v[48:49], v8, s[4:7], s34 offen sc1
    buffer_load_dwordx2 v[50:51], v9, s[4:7], s34 offen sc1
    s_mul_i32 s35, s60, 655360
    s_add_u32 s35, s35, 491520
    buffer_load_dwordx4 v[232:235], v12, s[4:7], s35 offen sc1
    buffer_load_dwordx4 v[236:239], v12, s[4:7], s35 offen offset:1024 sc1
    v_mov_b32 v28, 0
    v_mov_b32 v29, 0
    v_mov_b32 v30, 0
    v_mov_b32 v31, 0
    s_waitcnt vmcnt(0)
    s_nop 0
    v_smfmac_f32_16x16x64_bf16 v[28:31], v[32:35], v[200:207], v11
    v_max3_u32 v14, v35, v39, v43
    v_smfmac_f32_16x16x64_bf16 v[28:31], v[36:39], v[208:215], v11
    v_max3_u32 v14, v14, v47, v49
    v_smfmac_f32_16x16x64_bf16 v[28:31], v[40:43], v[216:223], v11
    v_max_u32 v14, v14, v51
    v_smfmac_f32_16x16x64_bf16 v[28:31], v[44:47], v[224:231], v11
    v_cmp_eq_u32 s[64:65], -1, v14
    v_smfmac_f32_16x16x64_bf16 v[28:31], v[48:51], v[232:239], v11
    v_xor_b32 v14, s47, v235
    v_bitop3_b32 v14, v239, s47, v14 bitop3:0xbe
    v_and_b32 v14, 1, v14
    v_cmp_eq_u32 vcc, 1, v14
    s_or_b64 vcc, vcc, s[64:65]
    s_cbranch_vccz r_got_74
    s_branch r_poll_76
uxn_82:
    s_mov_b32 s39, 0
    s_waitcnt vmcnt(1)
hr_104:
    v_cmp_ne_u32 vcc, s36, v129
    s_cbranch_vccz hro_105
    buffer_load_dwordx2 v[128:129], v130, s[4:7], s44 offen sc1
    s_add_u32 s39, s39, 1
    s_cmp_lt_u32 s39, 20000
    s_waitcnt vmcnt(0)
    s_cbranch_scc1 hr_104
    s_branch L_end2
hro_105:
    v_readfirstlane_b32 s34, v128
    s_nop 1
    v_subrev_u32 v128, s34, v128
    s_nop 1
    v_max_i32_dpp v128, v128, v128 quad_perm:[1,0,3,2] row_mask:0xf bank_mask:0xf
    s_nop 1
    v_max_i32_dpp v128, v128, v128 quad_perm:[2,3,0,1] row_mask:0xf bank_mask:0xf
    s_nop 1
    v_max_i32_dpp v128, v128, v128 row_half_mirror row_mask:0xf bank_mask:0xf
    s_nop 1
    v_max_i32_dpp v128, v128, v128 row_mirror row_mask:0xf bank_mask:0xf
    s_nop 0
    v_readlane_b32 s32, v128, 0
    v_readlane_b32 s33, v128, 16
    s_max_i32 s32, s32, s33
    v_readlane_b32 s33, v128, 32
    s_max_i32 s32, s32, s33
    v_readlane_b32 s33, v128, 48
    s_max_i32 s32, s32, s33
    s_add_u32 s32, s32, s34
    s_mov_b32 s25, s32
    s_mov_b32 s39, 0
    s_waitcnt vmcnt(0)
hr_106:
    v_cmp_ne_u32 vcc, s36, v133
    s_cbranch_vccz hro_107
    buffer_load_dwordx2 v[132:133], v134, s[4:7], s24 offen sc1
    s_add_u32 s39, s39, 1
    s_cmp_lt_u32 s39, 20000
    s_waitcnt vmcnt(0)
    s_cbranch_scc1 hr_106
    s_branch L_end2
hro_107:
    v_readfirstlane_b32 s34, v132
    s_nop 1
    v_subrev_u32 v132, s34, v132
    s_nop 1
    v_max_i32_dpp v132, v132, v132 quad_perm:[1,0,3,2] row_mask:0xf bank_mask:0xf
    s_nop 1
    v_max_i32_dpp v132, v132, v132 quad_perm:[2,3,0,1] row_mask:0xf bank_mask:0xf
    s_nop 1
    v_max_i32_dpp v132, v132, v132 row_half_mirror row_mask:0xf bank_mask:0xf
    s_nop 1
    v_max_i32_dpp v132, v132, v132 row_mirror row_mask:0xf bank_mask:0xf
    s_nop 0
    v_readlane_b32 s32, v132, 0
    v_readlane_b32 s33, v132, 16
    s_max_i32 s32, s32, s33
    v_readlane_b32 s33, v132, 32
    s_max_i32 s32, s32, s33
    v_readlane_b32 s33, v132, 48
    s_max_i32 s32, s32, s33
    s_add_u32 s32, s32, s34
    s_mov_b32 s26, s32
    s_sub_u32 s35, s25, s21
    s_sub_u32 s33, s26, s21
    s_cmp_le_i32 s33, 0
    s_cbranch_scc0 ad_108
    s_lshl_b32 s35, s35, 1
    s_cmp_gt_i32 s35, s18
    s_cselect_b32 s33, 1, -1
    s_add_u32 s18, s18, s33
    s_sub_u32 s35, s35, s18
    s_cmp_gt_i32 s35, 32
    s_cselect_b32 s33, 4, 0
    s_add_u32 s29, s29, s33
    s_min_u32 s29, s29, 12
ad_108:
    s_cmp_lt_u32 s36, 34
    s_cselect_b32 s33, 32, 30
    s_lshr_b32 s16, s18, 1
    s_add_u32 s16, s16, s33
    s_sub_u32 s35, s26, s22
    s_cmp_eq_u32 s23, 0
    s_cbranch_scc0 ad_109
    s_lshl_b32 s35, s35, 1
    s_cmp_gt_i32 s35, s19
    s_cselect_b32 s33, 1, -1
    s_add_u32 s19, s19, s33
    s_sub_u32 s35, s35, s19
    s_cmp_gt_i32 s35, 32
    s_cselect_b32 s33, 4, 0
    s_add_u32 s28, s28, s33
    s_min_u32 s28, s28, 12
ad_109:
    s_cmp_lt_u32 s36, 34
    s_cselect_b32 s33, 9, 7
    s_lshr_b32 s17, s19, 1
    s_add_u32 s17, s17, s33
    s_and_b32 s33, s36, 3
    s_cmp_eq_u32 s33, 0
    s_cselect_b32 s33, 1, 0
    s_sub_i32 s28, s28, s33
    s_max_i32 s28, s28, 0
    s_sub_i32 s29, s29, s33
    s_max_i32 s29, s29, 0
    s_add_u32 s16, s16, s28
    s_add_u32 s17, s17, s29
    s_sub_u32 s32, s25, s61
    s_add_u32 s32, s32, 22
    s_add_u32 s33, s32, 90
    s_cmp_le_i32 s32, 0
    s_cselect_b32 s33, 50, s33
    s_cmp_le_i32 s32, 0
    s_cselect_b32 s33, 0, s33
    s_mov_b32 s23, s33
    s_mov_b32 s22, s61
    s_mov_b32 s21, s20
    s_add_u32 s61, s20, s16
    s_add_u32 s61, s61, s33
    s_add_u32 s20, s61, s17
    s_add_u32 s35, s36, 1
    s_and_b32 s32, s35, 3
    s_lshl_b32 s32, s32, 14
    s_lshl_b32 s33, s14, 7
    s_add_u32 s32, s32, s33
    s_add_u32 s32, s32, s58
    s_add_u32 s32, s32, 1802240
    v_mov_b32 v104, s20
    v_mov_b32 v105, s35
    v_mov_b32 v106, s27
    v_mov_b32 v107, s35
    v_mov_b32 v108, 0
    s_mov_b64 exec, 1
    buffer_store_dwordx4 v[104:107], v108, s[4:7], s32 offen sc1
    s_mov_b64 exec, -1
    s_add_u32 s35, s36, 1
    s_add_u32 s41, s35, 1
    s_cmp_ge_u32 s38, s41
    s_cbranch_scc1 ux_ok_110
    s_mov_b32 s39, 0
ux_111:
    buffer_load_dword v2, v17, s[4:7], 0 offen sc1
    s_waitcnt vmcnt(0)
    s_nop 1
    v_min_u32_dpp v2, v2, v2 quad_perm:[1,0,3,2] row_mask:0xf bank_mask:0xf
    s_nop 1
    v_min_u32_dpp v2, v2, v2 quad_perm:[2,3,0,1] row_mask:0xf bank_mask:0xf
    s_nop 1
    v_min_u32_dpp v2, v2, v2 row_half_mirror row_mask:0xf bank_mask:0xf
    s_nop 1
    v_min_u32_dpp v2, v2, v2 row_mirror row_mask:0xf bank_mask:0xf
    s_nop 0
    v_readlane_b32 s32, v2, 0
    v_readlane_b32 s33, v2, 16
    s_min_u32 s32, s32, s33
    v_readlane_b32 s33, v2, 32
    s_min_u32 s32, s32, s33
    v_readlane_b32 s33, v2, 48
    s_min_u32 s38, s32, s33
    s_cmp_ge_u32 s38, s41
    s_cbranch_scc1 ux_ok_110
    s_sleep 2
    s_add_u32 s39, s39, 1
    s_cmp_lt_u32 s39, 20000
    s_cbranch_scc1 ux_111
    s_branch L_end2
ux_ok_110:
    s_mul_i32 s45, s35, 1310720
    s_add_u32 s45, s45, s40
    buffer_load_dwordx4 v[160:163], v10, s[4:7], s45 offen offset:0 sc1
    buffer_load_dwordx4 v[164:167], v10, s[4:7], s45 offen offset:1024 sc1
    buffer_load_dwordx4 v[168:171], v10, s[4:7], s45 offen offset:2048 sc1
    buffer_load_dwordx4 v[172:175], v10, s[4:7], s45 offen offset:3072 sc1
    s_add_u32 s45, s45, 4096
    buffer_load_dwordx4 v[176:179], v10, s[4:7], s45 offen offset:0 sc1
    buffer_load_dwordx4 v[180:183], v10, s[4:7], s45 offen offset:1024 sc1
    buffer_load_dwordx4 v[184:187], v10, s[4:7], s45 offen offset:2048 sc1
    buffer_load_dwordx4 v[188:191], v10, s[4:7], s45 offen offset:3072 sc1
    s_branch uxj_83
L_x:
    s_load_dwordx2 s[16:17], s[0:1], 0
    s_mov_b32 s18, 2621440
    s_mov_b32 s19, 0x20000
    s_load_dwordx2 s[20:21], s[0:1], 72
    s_mov_b32 s22, 1966080
    s_mov_b32 s23, 0x20000
    s_load_dwordx2 s[24:25], s[0:1], 80
    s_mov_b32 s26, 1966080
    s_mov_b32 s27, 0x20000
    s_load_dwordx2 s[28:29], s[0:1], 88
    s_mov_b32 s30, 1966080
    s_mov_b32 s31, 0x20000
    s_load_dwordx2 s[64:65], s[0:1], 64
    s_mov_b32 s66, 1280
    s_mov_b32 s67, 0x20000
    s_load_dwordx2 s[68:69], s[0:1], 96
    s_mov_b32 s70, 1280
    s_mov_b32 s71, 0x20000
    s_mov_b32 s40, 0xbfb8aa3b
    v_lshrrev_b32 v4, 3, v1
    v_mul_u32_u24 v4, 3072, v4
    v_and_b32 v5, 7, v1
    v_lshlrev_b32 v5, 4, v5
    v_add_u32 v4, v4, v5
    s_lshl_b32 s41, s14, 7
    s_mul_i32 s32, s12, 98304
    s_add_u32 s41, s41, s32
    s_lshl_b32 s42, s12, 12
    s_waitcnt lgkmcnt(0)
    s_cmp_lt_u32 s14, 16
    s_cbranch_scc1 dox1_113
    s_add_u32 m0, s42, 0
    s_add_u32 s37, s41, 0
    buffer_load_dwordx4 v4, s[20:23], s37 offen lds
    s_add_u32 m0, s42, 1024
    s_add_u32 s37, s41, 24576
    buffer_load_dwordx4 v4, s[20:23], s37 offen lds
    s_add_u32 m0, s42, 2048
    s_add_u32 s37, s41, 49152
    buffer_load_dwordx4 v4, s[20:23], s37 offen lds
    s_add_u32 m0, s42, 3072
    s_add_u32 s37, s41, 73728
    buffer_load_dwordx4 v4, s[20:23], s37 offen lds
    s_add_u32 m0, s42, 16384
    s_add_u32 s37, s41, 393216
    buffer_load_dwordx4 v4, s[20:23], s37 offen lds
    s_add_u32 m0, s42, 17408
    s_add_u32 s37, s41, 417792
    buffer_load_dwordx4 v4, s[20:23], s37 offen lds
    s_add_u32 m0, s42, 18432
    s_add_u32 s37, s41, 442368
    buffer_load_dwordx4 v4, s[20:23], s37 offen lds
    s_add_u32 m0, s42, 19456
    s_add_u32 s37, s41, 466944
    buffer_load_dwordx4 v4, s[20:23], s37 offen lds
    s_add_u32 m0, s42, 32768
    s_add_u32 s37, s41, 786432
    buffer_load_dwordx4 v4, s[20:23], s37 offen lds
    s_add_u32 m0, s42, 33792
    s_add_u32 s37, s41, 811008
    buffer_load_dwordx4 v4, s[20:23], s37 offen lds
    s_add_u32 m0, s42, 34816
    s_add_u32 s37, s41, 835584
    buffer_load_dwordx4 v4, s[20:23], s37 offen lds
    s_add_u32 m0, s42, 35840
    s_add_u32 s37, s41, 860160
    buffer_load_dwordx4 v4, s[20:23], s37 offen lds
    s_add_u32 m0, s42, 49152
    s_add_u32 s37, s41, 1179648
    buffer_load_dwordx4 v4, s[20:23], s37 offen lds
    s_add_u32 m0, s42, 50176
    s_add_u32 s37, s41, 1204224
    buffer_load_dwordx4 v4, s[20:23], s37 offen lds
    s_add_u32 m0, s42, 51200
    s_add_u32 s37, s41, 1228800
    buffer_load_dwordx4 v4, s[20:23], s37 offen lds
    s_add_u32 m0, s42, 52224
    s_add_u32 s37, s41, 1253376
    buffer_load_dwordx4 v4, s[20:23], s37 offen lds
    s_add_u32 m0, s42, 65536
    s_add_u32 s37, s41, 1572864
    buffer_load_dwordx4 v4, s[20:23], s37 offen lds
    s_add_u32 m0, s42, 66560
    s_add_u32 s37, s41, 1597440
    buffer_load_dwordx4 v4, s[20:23], s37 offen lds
    s_add_u32 m0, s42, 67584
    s_add_u32 s37, s41, 1622016
    buffer_load_dwordx4 v4, s[20:23], s37 offen lds
    s_add_u32 m0, s42, 68608
    s_add_u32 s37, s41, 1646592
    buffer_load_dwordx4 v4, s[20:23], s37 offen lds
    s_add_u32 m0, s42, 81920
    s_add_u32 s37, s41, 0
    buffer_load_dwordx4 v4, s[24:27], s37 offen lds
    s_add_u32 m0, s42, 82944
    s_add_u32 s37, s41, 24576
    buffer_load_dwordx4 v4, s[24:27], s37 offen lds
    s_add_u32 m0, s42, 83968
    s_add_u32 s37, s41, 49152
    buffer_load_dwordx4 v4, s[24:27], s37 offen lds
    s_add_u32 m0, s42, 84992
    s_add_u32 s37, s41, 73728
    buffer_load_dwordx4 v4, s[24:27], s37 offen lds
    s_add_u32 m0, s42, 98304
    s_add_u32 s37, s41, 393216
    buffer_load_dwordx4 v4, s[24:27], s37 offen lds
    s_add_u32 m0, s42, 99328
    s_add_u32 s37, s41, 417792
    buffer_load_dwordx4 v4, s[24:27], s37 offen lds
    s_add_u32 m0, s42, 100352
    s_add_u32 s37, s41, 442368
    buffer_load_dwordx4 v4, s[24:27], s37 offen lds
    s_add_u32 m0, s42, 101376
    s_add_u32 s37, s41, 466944
    buffer_load_dwordx4 v4, s[24:27], s37 offen lds
    s_add_u32 m0, s42, 114688
    s_add_u32 s37, s41, 786432
    buffer_load_dwordx4 v4, s[24:27], s37 offen lds
    s_add_u32 m0, s42, 115712
    s_add_u32 s37, s41, 811008
    buffer_load_dwordx4 v4, s[24:27], s37 offen lds
    s_add_u32 m0, s42, 116736
    s_add_u32 s37, s41, 835584
    buffer_load_dwordx4 v4, s[24:27], s37 offen lds
    s_add_u32 m0, s42, 117760
    s_add_u32 s37, s41, 860160
    buffer_load_dwordx4 v4, s[24:27], s37 offen lds
    s_add_u32 m0, s42, 131072
    s_add_u32 s37, s41, 1179648
    buffer_load_dwordx4 v4, s[24:27], s37 offen lds
    s_add_u32 m0, s42, 132096
    s_add_u32 s37, s41, 1204224
    buffer_load_dwordx4 v4, s[24:27], s37 offen lds
    s_add_u32 m0, s42, 133120
    s_add_u32 s37, s41, 1228800
    buffer_load_dwordx4 v4, s[24:27], s37 offen lds
    s_add_u32 m0, s42, 134144
    s_add_u32 s37, s41, 1253376
    buffer_load_dwordx4 v4, s[24:27], s37 offen lds
    s_add_u32 m0, s42, 147456
    s_add_u32 s37, s41, 1572864
    buffer_load_dwordx4 v4, s[24:27], s37 offen lds
    s_add_u32 m0, s42, 148480
    s_add_u32 s37, s41, 1597440
    buffer_load_dwordx4 v4, s[24:27], s37 offen lds
    s_add_u32 m0, s42, 149504
    s_add_u32 s37, s41, 1622016
    buffer_load_dwordx4 v4, s[24:27], s37 offen lds
    s_add_u32 m0, s42, 150528
    s_add_u32 s37, s41, 1646592
    buffer_load_dwordx4 v4, s[24:27], s37 offen lds
    s_branch nox1_112
dox1_113:
    v_mov_b32 v16, 0
    v_mov_b32 v17, 0
    v_mov_b32 v18, 0
    v_mov_b32 v19, 0
    v_mov_b32 v20, 0
    v_mov_b32 v21, 0
    v_mov_b32 v22, 0
    v_mov_b32 v23, 0
    v_mov_b32 v24, 0
    v_mov_b32 v25, 0
    v_mov_b32 v26, 0
    v_mov_b32 v27, 0
    v_mov_b32 v28, 0
    v_mov_b32 v29, 0
    v_mov_b32 v30, 0
    v_mov_b32 v31, 0
    v_mov_b32 v32, 0
    v_mov_b32 v33, 0
    v_mov_b32 v34, 0
    v_mov_b32 v35, 0
    v_mov_b32 v36, 0
    v_mov_b32 v37, 0
    v_mov_b32 v38, 0
    v_mov_b32 v39, 0
    v_mov_b32 v40, 0
    v_mov_b32 v41, 0
    v_mov_b32 v42, 0
    v_mov_b32 v43, 0
    v_mov_b32 v44, 0
    v_mov_b32 v45, 0
    v_mov_b32 v46, 0
    v_mov_b32 v47, 0
    v_mov_b32 v48, 0
    v_mov_b32 v49, 0
    v_mov_b32 v50, 0
    v_mov_b32 v51, 0
    v_mov_b32 v52, 0
    v_mov_b32 v53, 0
    v_mov_b32 v54, 0
    v_mov_b32 v55, 0
    v_mov_b32 v56, 0
    v_mov_b32 v57, 0
    v_mov_b32 v58, 0
    v_mov_b32 v59, 0
    v_mov_b32 v60, 0
    v_mov_b32 v61, 0
    v_mov_b32 v62, 0
    v_mov_b32 v63, 0
    v_mov_b32 v64, 0
    v_mov_b32 v65, 0
    v_mov_b32 v66, 0
    v_mov_b32 v67, 0
    v_mov_b32 v68, 0
    v_mov_b32 v69, 0
    v_mov_b32 v70, 0
    v_mov_b32 v71, 0
    v_mov_b32 v72, 0
    v_mov_b32 v73, 0
    v_mov_b32 v74, 0
    v_mov_b32 v75, 0
    v_mov_b32 v76, 0
    v_mov_b32 v77, 0
    v_mov_b32 v78, 0
    v_mov_b32 v79, 0
    v_mov_b32 v80, 0
    v_mov_b32 v81, 0
    v_mov_b32 v82, 0
    v_mov_b32 v83, 0
    v_mov_b32 v84, 0
    v_mov_b32 v85, 0
    v_mov_b32 v86, 0
    v_mov_b32 v87, 0
    v_mov_b32 v88, 0
    v_mov_b32 v89, 0
    v_mov_b32 v90, 0
    v_mov_b32 v91, 0
    v_mov_b32 v92, 0
    v_mov_b32 v93, 0
    v_mov_b32 v94, 0
    v_mov_b32 v95, 0
    v_lshrrev_b32 v5, 4, v1
    v_lshlrev_b32 v5, 4, v5
    v_and_b32 v6, 15, v1
    v_mul_u32_u24 v7, 1280, v6
    v_add_u32 v7, v7, v5
    s_lshl_b32 s34, s14, 2
    s_add_u32 s34, s34, s12
    s_mul_i32 s35, s34, 40960
    s_add_u32 s32, s35, 0
    buffer_load_dwordx4 v[96:99], v7, s[16:19], s32 offen offset:0
    buffer_load_dwordx4 v[100:103], v7, s[16:19], s32 offen offset:64
    buffer_load_dwordx4 v[104:107], v7, s[16:19], s32 offen offset:128
    buffer_load_dwordx4 v[108:111], v7, s[16:19], s32 offen offset:192
    buffer_load_dwordx4 v[112:115], v7, s[16:19], s32 offen offset:256
    buffer_load_dwordx4 v[116:119], v7, s[16:19], s32 offen offset:320
    buffer_load_dwordx4 v[120:123], v7, s[16:19], s32 offen offset:384
    buffer_load_dwordx4 v[124:127], v7, s[16:19], s32 offen offset:448
    buffer_load_dwordx4 v[128:131], v7, s[16:19], s32 offen offset:512
    buffer_load_dwordx4 v[132:135], v7, s[16:19], s32 offen offset:576
    buffer_load_dwordx4 v[136:139], v7, s[16:19], s32 offen offset:640
    buffer_load_dwordx4 v[140:143], v7, s[16:19], s32 offen offset:704
    buffer_load_dwordx4 v[144:147], v7, s[16:19], s32 offen offset:768
    buffer_load_dwordx4 v[148:151], v7, s[16:19], s32 offen offset:832
    buffer_load_dwordx4 v[152:155], v7, s[16:19], s32 offen offset:896
    buffer_load_dwordx4 v[156:159], v7, s[16:19], s32 offen offset:960
    buffer_load_dwordx4 v[160:163], v7, s[16:19], s32 offen offset:1024
    buffer_load_dwordx4 v[164:167], v7, s[16:19], s32 offen offset:1088
    buffer_load_dwordx4 v[168:171], v7, s[16:19], s32 offen offset:1152
    buffer_load_dwordx4 v[172:175], v7, s[16:19], s32 offen offset:1216
    s_add_u32 s32, s35, 20480
    buffer_load_dwordx4 v[176:179], v7, s[16:19], s32 offen offset:0
    buffer_load_dwordx4 v[180:183], v7, s[16:19], s32 offen offset:64
    buffer_load_dwordx4 v[184:187], v7, s[16:19], s32 offen offset:128
    buffer_load_dwordx4 v[188:191], v7, s[16:19], s32 offen offset:192
    buffer_load_dwordx4 v[192:195], v7, s[16:19], s32 offen offset:256
    buffer_load_dwordx4 v[196:199], v7, s[16:19], s32 offen offset:320
    buffer_load_dwordx4 v[200:203], v7, s[16:19], s32 offen offset:384
    buffer_load_dwordx4 v[204:207], v7, s[16:19], s32 offen offset:448
    buffer_load_dwordx4 v[208:211], v7, s[16:19], s32 offen offset:512
    buffer_load_dwordx4 v[212:215], v7, s[16:19], s32 offen offset:576
    buffer_load_dwordx4 v[216:219], v7, s[16:19], s32 offen offset:640
    buffer_load_dwordx4 v[220:223], v7, s[16:19], s32 offen offset:704
    buffer_load_dwordx4 v[224:227], v7, s[16:19], s32 offen offset:768
    buffer_load_dwordx4 v[228:231], v7, s[16:19], s32 offen offset:832
    buffer_load_dwordx4 v[232:235], v7, s[16:19], s32 offen offset:896
    buffer_load_dwordx4 v[236:239], v7, s[16:19], s32 offen offset:960
    buffer_load_dwordx4 v[240:243], v7, s[16:19], s32 offen offset:1024
    buffer_load_dwordx4 v[244:247], v7, s[16:19], s32 offen offset:1088
    buffer_load_dwordx4 v[248:251], v7, s[16:19], s32 offen offset:1152
    buffer_load_dwordx4 v[252:255], v7, s[16:19], s32 offen offset:1216
    s_mov_b32 exec_lo, 0x11111111
    s_mov_b32 exec_hi, 0x11111111
    buffer_load_dwordx4 v[16:19], v5, s[64:67], 0 offen offset:0
    buffer_load_dwordx4 v[20:23], v5, s[64:67], 0 offen offset:64
    buffer_load_dwordx4 v[24:27], v5, s[64:67], 0 offen offset:128
    buffer_load_dwordx4 v[28:31], v5, s[64:67], 0 offen offset:192
    buffer_load_dwordx4 v[32:35], v5, s[64:67], 0 offen offset:256
    buffer_load_dwordx4 v[36:39], v5, s[64:67], 0 offen offset:320
    buffer_load_dwordx4 v[40:43], v5, s[64:67], 0 offen offset:384
    buffer_load_dwordx4 v[44:47], v5, s[64:67], 0 offen offset:448
    buffer_load_dwordx4 v[48:51], v5, s[64:67], 0 offen offset:512
    buffer_load_dwordx4 v[52:55], v5, s[64:67], 0 offen offset:576
    buffer_load_dwordx4 v[56:59], v5, s[64:67], 0 offen offset:640
    buffer_load_dwordx4 v[60:63], v5, s[64:67], 0 offen offset:704
    buffer_load_dwordx4 v[64:67], v5, s[64:67], 0 offen offset:768
    buffer_load_dwordx4 v[68:71], v5, s[64:67], 0 offen offset:832
    buffer_load_dwordx4 v[72:75], v5, s[64:67], 0 offen offset:896
    buffer_load_dwordx4 v[76:79], v5, s[64:67], 0 offen offset:960
    buffer_load_dwordx4 v[80:83], v5, s[64:67], 0 offen offset:1024
    buffer_load_dwordx4 v[84:87], v5, s[64:67], 0 offen offset:1088
    buffer_load_dwordx4 v[88:91], v5, s[64:67], 0 offen offset:1152
    buffer_load_dwordx4 v[92:95], v5, s[64:67], 0 offen offset:1216
    s_mov_b32 exec_lo, 0x22222222
    s_mov_b32 exec_hi, 0x22222222
    buffer_load_dwordx4 v[16:19], v5, s[68:71], 0 offen offset:0
    buffer_load_dwordx4 v[20:23], v5, s[68:71], 0 offen offset:64
    buffer_load_dwordx4 v[24:27], v5, s[68:71], 0 offen offset:128
    buffer_load_dwordx4 v[28:31], v5, s[68:71], 0 offen offset:192
    buffer_load_dwordx4 v[32:35], v5, s[68:71], 0 offen offset:256
    buffer_load_dwordx4 v[36:39], v5, s[68:71], 0 offen offset:320
    buffer_load_dwordx4 v[40:43], v5, s[68:71], 0 offen offset:384
    buffer_load_dwordx4 v[44:47], v5, s[68:71], 0 offen offset:448
    buffer_load_dwordx4 v[48:51], v5, s[68:71], 0 offen offset:512
    buffer_load_dwordx4 v[52:55], v5, s[68:71], 0 offen offset:576
    buffer_load_dwordx4 v[56:59], v5, s[68:71], 0 offen offset:640
    buffer_load_dwordx4 v[60:63], v5, s[68:71], 0 offen offset:704
    buffer_load_dwordx4 v[64:67], v5, s[68:71], 0 offen offset:768
    buffer_load_dwordx4 v[68:71], v5, s[68:71], 0 offen offset:832
    buffer_load_dwordx4 v[72:75], v5, s[68:71], 0 offen offset:896
    buffer_load_dwordx4 v[76:79], v5, s[68:71], 0 offen offset:960
    buffer_load_dwordx4 v[80:83], v5, s[68:71], 0 offen offset:1024
    buffer_load_dwordx4 v[84:87], v5, s[68:71], 0 offen offset:1088
    buffer_load_dwordx4 v[88:91], v5, s[68:71], 0 offen offset:1152
    buffer_load_dwordx4 v[92:95], v5, s[68:71], 0 offen offset:1216
    s_mov_b64 exec, -1
    s_add_u32 m0, s42, 0
    s_add_u32 s37, s41, 0
    buffer_load_dwordx4 v4, s[20:23], s37 offen lds
    s_add_u32 m0, s42, 1024
    s_add_u32 s37, s41, 24576
    buffer_load_dwordx4 v4, s[20:23], s37 offen lds
    s_add_u32 m0, s42, 2048
    s_add_u32 s37, s41, 49152
    buffer_load_dwordx4 v4, s[20:23], s37 offen lds
    s_add_u32 m0, s42, 3072
    s_add_u32 s37, s41, 73728
    buffer_load_dwordx4 v4, s[20:23], s37 offen lds
    s_add_u32 m0, s42, 16384
    s_add_u32 s37, s41, 393216
    buffer_load_dwordx4 v4, s[20:23], s37 offen lds
    s_add_u32 m0, s42, 17408
    s_add_u32 s37, s41, 417792
    buffer_load_dwordx4 v4, s[20:23], s37 offen lds
    s_add_u32 m0, s42, 18432
    s_add_u32 s37, s41, 442368
    buffer_load_dwordx4 v4, s[20:23], s37 offen lds
    s_add_u32 m0, s42, 19456
    s_add_u32 s37, s41, 466944
    buffer_load_dwordx4 v4, s[20:23], s37 offen lds
    s_add_u32 m0, s42, 32768
    s_add_u32 s37, s41, 786432
    buffer_load_dwordx4 v4, s[20:23], s37 offen lds
    s_add_u32 m0, s42, 33792
    s_add_u32 s37, s41, 811008
    buffer_load_dwordx4 v4, s[20:23], s37 offen lds
    s_add_u32 m0, s42, 34816
    s_add_u32 s37, s41, 835584
    buffer_load_dwordx4 v4, s[20:23], s37 offen lds
    s_add_u32 m0, s42, 35840
    s_add_u32 s37, s41, 860160
    buffer_load_dwordx4 v4, s[20:23], s37 offen lds
    s_add_u32 m0, s42, 49152
    s_add_u32 s37, s41, 1179648
    buffer_load_dwordx4 v4, s[20:23], s37 offen lds
    s_add_u32 m0, s42, 50176
    s_add_u32 s37, s41, 1204224
    buffer_load_dwordx4 v4, s[20:23], s37 offen lds
    s_add_u32 m0, s42, 51200
    s_add_u32 s37, s41, 1228800
    buffer_load_dwordx4 v4, s[20:23], s37 offen lds
    s_add_u32 m0, s42, 52224
    s_add_u32 s37, s41, 1253376
    buffer_load_dwordx4 v4, s[20:23], s37 offen lds
    s_add_u32 m0, s42, 65536
    s_add_u32 s37, s41, 1572864
    buffer_load_dwordx4 v4, s[20:23], s37 offen lds
    s_add_u32 m0, s42, 66560
    s_add_u32 s37, s41, 1597440
    buffer_load_dwordx4 v4, s[20:23], s37 offen lds
    s_add_u32 m0, s42, 67584
    s_add_u32 s37, s41, 1622016
    buffer_load_dwordx4 v4, s[20:23], s37 offen lds
    s_add_u32 m0, s42, 68608
    s_add_u32 s37, s41, 1646592
    buffer_load_dwordx4 v4, s[20:23], s37 offen lds
    s_add_u32 m0, s42, 81920
    s_add_u32 s37, s41, 0
    buffer_load_dwordx4 v4, s[24:27], s37 offen lds
    s_add_u32 m0, s42, 82944
    s_add_u32 s37, s41, 24576
    buffer_load_dwordx4 v4, s[24:27], s37 offen lds
    s_add_u32 m0, s42, 83968
    s_add_u32 s37, s41, 49152
    buffer_load_dwordx4 v4, s[24:27], s37 offen lds
    s_add_u32 m0, s42, 84992
    s_add_u32 s37, s41, 73728
    buffer_load_dwordx4 v4, s[24:27], s37 offen lds
    s_add_u32 m0, s42, 98304
    s_add_u32 s37, s41, 393216
    buffer_load_dwordx4 v4, s[24:27], s37 offen lds
    s_add_u32 m0, s42, 99328
    s_add_u32 s37, s41, 417792
    buffer_load_dwordx4 v4, s[24:27], s37 offen lds
    s_add_u32 m0, s42, 100352
    s_add_u32 s37, s41, 442368
    buffer_load_dwordx4 v4, s[24:27], s37 offen lds
    s_add_u32 m0, s42, 101376
    s_add_u32 s37, s41, 466944
    buffer_load_dwordx4 v4, s[24:27], s37 offen lds
    s_add_u32 m0, s42, 114688
    s_add_u32 s37, s41, 786432
    buffer_load_dwordx4 v4, s[24:27], s37 offen lds
    s_add_u32 m0, s42, 115712
    s_add_u32 s37, s41, 811008
    buffer_load_dwordx4 v4, s[24:27], s37 offen lds
    s_add_u32 m0, s42, 116736
    s_add_u32 s37, s41, 835584
    buffer_load_dwordx4 v4, s[24:27], s37 offen lds
    s_add_u32 m0, s42, 117760
    s_add_u32 s37, s41, 860160
    buffer_load_dwordx4 v4, s[24:27], s37 offen lds
    s_add_u32 m0, s42, 131072
    s_add_u32 s37, s41, 1179648
    buffer_load_dwordx4 v4, s[24:27], s37 offen lds
    s_add_u32 m0, s42, 132096
    s_add_u32 s37, s41, 1204224
    buffer_load_dwordx4 v4, s[24:27], s37 offen lds
    s_add_u32 m0, s42, 133120
    s_add_u32 s37, s41, 1228800
    buffer_load_dwordx4 v4, s[24:27], s37 offen lds
    s_add_u32 m0, s42, 134144
    s_add_u32 s37, s41, 1253376
    buffer_load_dwordx4 v4, s[24:27], s37 offen lds
    s_add_u32 m0, s42, 147456
    s_add_u32 s37, s41, 1572864
    buffer_load_dwordx4 v4, s[24:27], s37 offen lds
    s_add_u32 m0, s42, 148480
    s_add_u32 s37, s41, 1597440
    buffer_load_dwordx4 v4, s[24:27], s37 offen lds
    s_add_u32 m0, s42, 149504
    s_add_u32 s37, s41, 1622016
    buffer_load_dwordx4 v4, s[24:27], s37 offen lds
    s_add_u32 m0, s42, 150528
    s_add_u32 s37, s41, 1646592
    buffer_load_dwordx4 v4, s[24:27], s37 offen lds
    s_waitcnt vmcnt(40)
    v_mfma_f32_16x16x32_bf16 v[8:11], v[16:19], v[96:99], 0
    v_mfma_f32_16x16x32_bf16 v[12:15], v[16:19], v[176:179], 0
    v_mfma_f32_16x16x32_bf16 v[8:11], v[20:23], v[100:103], v[8:11]
    v_mfma_f32_16x16x32_bf16 v[12:15], v[20:23], v[180:183], v[12:15]
    v_mfma_f32_16x16x32_bf16 v[8:11], v[24:27], v[104:107], v[8:11]
    v_mfma_f32_16x16x32_bf16 v[12:15], v[24:27], v[184:187], v[12:15]
    v_mfma_f32_16x16x32_bf16 v[8:11], v[28:31], v[108:111], v[8:11]
    v_mfma_f32_16x16x32_bf16 v[12:15], v[28:31], v[188:191], v[12:15]
    v_mfma_f32_16x16x32_bf16 v[8:11], v[32:35], v[112:115], v[8:11]
    v_mfma_f32_16x16x32_bf16 v[12:15], v[32:35], v[192:195], v[12:15]
    v_mfma_f32_16x16x32_bf16 v[8:11], v[36:39], v[116:119], v[8:11]
    v_mfma_f32_16x16x32_bf16 v[12:15], v[36:39], v[196:199], v[12:15]
    v_mfma_f32_16x16x32_bf16 v[8:11], v[40:43], v[120:123], v[8:11]
    v_mfma_f32_16x16x32_bf16 v[12:15], v[40:43], v[200:203], v[12:15]
    v_mfma_f32_16x16x32_bf16 v[8:11], v[44:47], v[124:127], v[8:11]
    v_mfma_f32_16x16x32_bf16 v[12:15], v[44:47], v[204:207], v[12:15]
    v_mfma_f32_16x16x32_bf16 v[8:11], v[48:51], v[128:131], v[8:11]
    v_mfma_f32_16x16x32_bf16 v[12:15], v[48:51], v[208:211], v[12:15]
    v_mfma_f32_16x16x32_bf16 v[8:11], v[52:55], v[132:135], v[8:11]
    v_mfma_f32_16x16x32_bf16 v[12:15], v[52:55], v[212:215], v[12:15]
    v_mfma_f32_16x16x32_bf16 v[8:11], v[56:59], v[136:139], v[8:11]
    v_mfma_f32_16x16x32_bf16 v[12:15], v[56:59], v[216:219], v[12:15]
    v_mfma_f32_16x16x32_bf16 v[8:11], v[60:63], v[140:143], v[8:11]
    v_mfma_f32_16x16x32_bf16 v[12:15], v[60:63], v[220:223], v[12:15]
    v_mfma_f32_16x16x32_bf16 v[8:11], v[64:67], v[144:147], v[8:11]
    v_mfma_f32_16x16x32_bf16 v[12:15], v[64:67], v[224:227], v[12:15]
    v_mfma_f32_16x16x32_bf16 v[8:11], v[68:71], v[148:151], v[8:11]
    v_mfma_f32_16x16x32_bf16 v[12:15], v[68:71], v[228:231], v[12:15]
    v_mfma_f32_16x16x32_bf16 v[8:11], v[72:75], v[152:155], v[8:11]
    v_mfma_f32_16x16x32_bf16 v[12:15], v[72:75], v[232:235], v[12:15]
    v_mfma_f32_16x16x32_bf16 v[8:11], v[76:79], v[156:159], v[8:11]
    v_mfma_f32_16x16x32_bf16 v[12:15], v[76:79], v[236:239], v[12:15]
    v_mfma_f32_16x16x32_bf16 v[8:11], v[80:83], v[160:163], v[8:11]
    v_mfma_f32_16x16x32_bf16 v[12:15], v[80:83], v[240:243], v[12:15]
    v_mfma_f32_16x16x32_bf16 v[8:11], v[84:87], v[164:167], v[8:11]
    v_mfma_f32_16x16x32_bf16 v[12:15], v[84:87], v[244:247], v[12:15]
    v_mfma_f32_16x16x32_bf16 v[8:11], v[88:91], v[168:171], v[8:11]
    v_mfma_f32_16x16x32_bf16 v[12:15], v[88:91], v[248:251], v[12:15]
    v_mfma_f32_16x16x32_bf16 v[8:11], v[92:95], v[172:175], v[8:11]
    v_mfma_f32_16x16x32_bf16 v[12:15], v[92:95], v[252:255], v[12:15]
    s_nop 7
    v_lshrrev_b32 v16, 5, v1
    v_lshlrev_b32 v16, 10, v16
    v_lshlrev_b32 v17, 5, v6
    v_bfe_u32 v18, v1, 4, 1
    v_lshlrev_b32 v18, 4, v18
    v_add3_u32 v16, v16, v17, v18
    v_lshlrev_b32 v17, 2, v6
    v_cvt_pk_bf16_f32 v20, v8, v8
    v_and_b32 v20, 0xffff0000, v20
    v_ashrrev_i32 v21, 31, v20
    v_or_b32 v21, 0x80000000, v21
    v_xor_b32 v20, v20, v21
    v_and_b32 v20, 0xffff0000, v20
    s_lshl_b32 s32, s34, 5
    s_add_u32 s32, s32, 0
    s_sub_u32 s33, 2047, s32
    v_sub_u32 v21, s33, v6
    v_or_b32 v20, v20, v21
    v_cvt_pk_bf16_f32 v21, v9, v9
    v_and_b32 v21, 0xffff0000, v21
    v_mul_f32 v22, s40, v21
    v_exp_f32 v22, v22
    s_nop 0
    v_add_f32 v22, 1.0, v22
    v_rcp_f32 v22, v22
    s_nop 0
    v_cvt_pk_bf16_f32 v22, v22, v22
    v_and_b32 v22, 0xffff0000, v22
    v_sub_f32 v23, 1.0, v22
    v_cvt_pk_bf16_f32 v23, v23, v23
    v_and_b32 v23, 0xffff0000, v23
    s_lshl_b32 s32, s32, 2
    s_add_u32 s33, s32, 2113536
    s_add_u32 s32, s32, 2101248
    s_mov_b64 exec, 0xffff
    buffer_store_dword v20, v17, s[4:7], s33 offen sc1
    buffer_store_dword v22, v17, s[4:7], s32 offen sc1
    s_mov_b64 exec, -1
    s_add_u32 s37, s35, 168820736
    v_lshlrev_b32 v24, 16, v96
    v_and_b32 v25, 0xffff0000, v96
    v_mul_f32 v24, v24, v23
    v_mul_f32 v25, v25, v23
    v_cvt_pk_bf16_f32 v96, v24, v25
    v_lshlrev_b32 v24, 16, v97
    v_and_b32 v25, 0xffff0000, v97
    v_mul_f32 v24, v24, v23
    v_mul_f32 v25, v25, v23
    v_cvt_pk_bf16_f32 v97, v24, v25
    v_lshlrev_b32 v24, 16, v98
    v_and_b32 v25, 0xffff0000, v98
    v_mul_f32 v24, v24, v23
    v_mul_f32 v25, v25, v23
    v_cvt_pk_bf16_f32 v98, v24, v25
    v_lshlrev_b32 v24, 16, v99
    v_and_b32 v25, 0xffff0000, v99
    v_mul_f32 v24, v24, v23
    v_mul_f32 v25, v25, v23
    v_cvt_pk_bf16_f32 v99, v24, v25
    buffer_store_dwordx4 v[96:99], v16, s[4:7], s37 offen offset:0 sc1
    v_lshlrev_b32 v24, 16, v100
    v_and_b32 v25, 0xffff0000, v100
    v_mul_f32 v24, v24, v23
    v_mul_f32 v25, v25, v23
    v_cvt_pk_bf16_f32 v100, v24, v25
    v_lshlrev_b32 v24, 16, v101
    v_and_b32 v25, 0xffff0000, v101
    v_mul_f32 v24, v24, v23
    v_mul_f32 v25, v25, v23
    v_cvt_pk_bf16_f32 v101, v24, v25
    v_lshlrev_b32 v24, 16, v102
    v_and_b32 v25, 0xffff0000, v102
    v_mul_f32 v24, v24, v23
    v_mul_f32 v25, v25, v23
    v_cvt_pk_bf16_f32 v102, v24, v25
    v_lshlrev_b32 v24, 16, v103
    v_and_b32 v25, 0xffff0000, v103
    v_mul_f32 v24, v24, v23
    v_mul_f32 v25, v25, v23
    v_cvt_pk_bf16_f32 v103, v24, v25
    buffer_store_dwordx4 v[100:103], v16, s[4:7], s37 offen offset:2048 sc1
    s_add_u32 s37, s37, 4096
    v_lshlrev_b32 v24, 16, v104
    v_and_b32 v25, 0xffff0000, v104
    v_mul_f32 v24, v24, v23
    v_mul_f32 v25, v25, v23
    v_cvt_pk_bf16_f32 v104, v24, v25
    v_lshlrev_b32 v24, 16, v105
    v_and_b32 v25, 0xffff0000, v105
    v_mul_f32 v24, v24, v23
    v_mul_f32 v25, v25, v23
    v_cvt_pk_bf16_f32 v105, v24, v25
    v_lshlrev_b32 v24, 16, v106
    v_and_b32 v25, 0xffff0000, v106
    v_mul_f32 v24, v24, v23
    v_mul_f32 v25, v25, v23
    v_cvt_pk_bf16_f32 v106, v24, v25
    v_lshlrev_b32 v24, 16, v107
    v_and_b32 v25, 0xffff0000, v107
    v_mul_f32 v24, v24, v23
    v_mul_f32 v25, v25, v23
    v_cvt_pk_bf16_f32 v107, v24, v25
    buffer_store_dwordx4 v[104:107], v16, s[4:7], s37 offen offset:0 sc1
    v_lshlrev_b32 v24, 16, v108
    v_and_b32 v25, 0xffff0000, v108
    v_mul_f32 v24, v24, v23
    v_mul_f32 v25, v25, v23
    v_cvt_pk_bf16_f32 v108, v24, v25
    v_lshlrev_b32 v24, 16, v109
    v_and_b32 v25, 0xffff0000, v109
    v_mul_f32 v24, v24, v23
    v_mul_f32 v25, v25, v23
    v_cvt_pk_bf16_f32 v109, v24, v25
    v_lshlrev_b32 v24, 16, v110
    v_and_b32 v25, 0xffff0000, v110
    v_mul_f32 v24, v24, v23
    v_mul_f32 v25, v25, v23
    v_cvt_pk_bf16_f32 v110, v24, v25
    v_lshlrev_b32 v24, 16, v111
    v_and_b32 v25, 0xffff0000, v111
    v_mul_f32 v24, v24, v23
    v_mul_f32 v25, v25, v23
    v_cvt_pk_bf16_f32 v111, v24, v25
    buffer_store_dwordx4 v[108:111], v16, s[4:7], s37 offen offset:2048 sc1
    s_add_u32 s37, s37, 4096
    v_lshlrev_b32 v24, 16, v112
    v_and_b32 v25, 0xffff0000, v112
    v_mul_f32 v24, v24, v23
    v_mul_f32 v25, v25, v23
    v_cvt_pk_bf16_f32 v112, v24, v25
    v_lshlrev_b32 v24, 16, v113
    v_and_b32 v25, 0xffff0000, v113
    v_mul_f32 v24, v24, v23
    v_mul_f32 v25, v25, v23
    v_cvt_pk_bf16_f32 v113, v24, v25
    v_lshlrev_b32 v24, 16, v114
    v_and_b32 v25, 0xffff0000, v114
    v_mul_f32 v24, v24, v23
    v_mul_f32 v25, v25, v23
    v_cvt_pk_bf16_f32 v114, v24, v25
    v_lshlrev_b32 v24, 16, v115
    v_and_b32 v25, 0xffff0000, v115
    v_mul_f32 v24, v24, v23
    v_mul_f32 v25, v25, v23
    v_cvt_pk_bf16_f32 v115, v24, v25
    buffer_store_dwordx4 v[112:115], v16, s[4:7], s37 offen offset:0 sc1
    v_lshlrev_b32 v24, 16, v116
    v_and_b32 v25, 0xffff0000, v116
    v_mul_f32 v24, v24, v23
    v_mul_f32 v25, v25, v23
    v_cvt_pk_bf16_f32 v116, v24, v25
    v_lshlrev_b32 v24, 16, v117
    v_and_b32 v25, 0xffff0000, v117
    v_mul_f32 v24, v24, v23
    v_mul_f32 v25, v25, v23
    v_cvt_pk_bf16_f32 v117, v24, v25
    v_lshlrev_b32 v24, 16, v118
    v_and_b32 v25, 0xffff0000, v118
    v_mul_f32 v24, v24, v23
    v_mul_f32 v25, v25, v23
    v_cvt_pk_bf16_f32 v118, v24, v25
    v_lshlrev_b32 v24, 16, v119
    v_and_b32 v25, 0xffff0000, v119
    v_mul_f32 v24, v24, v23
    v_mul_f32 v25, v25, v23
    v_cvt_pk_bf16_f32 v119, v24, v25
    buffer_store_dwordx4 v[116:119], v16, s[4:7], s37 offen offset:2048 sc1
    s_add_u32 s37, s37, 4096
    v_lshlrev_b32 v24, 16, v120
    v_and_b32 v25, 0xffff0000, v120
    v_mul_f32 v24, v24, v23
    v_mul_f32 v25, v25, v23
    v_cvt_pk_bf16_f32 v120, v24, v25
    v_lshlrev_b32 v24, 16, v121
    v_and_b32 v25, 0xffff0000, v121
    v_mul_f32 v24, v24, v23
    v_mul_f32 v25, v25, v23
    v_cvt_pk_bf16_f32 v121, v24, v25
    v_lshlrev_b32 v24, 16, v122
    v_and_b32 v25, 0xffff0000, v122
    v_mul_f32 v24, v24, v23
    v_mul_f32 v25, v25, v23
    v_cvt_pk_bf16_f32 v122, v24, v25
    v_lshlrev_b32 v24, 16, v123
    v_and_b32 v25, 0xffff0000, v123
    v_mul_f32 v24, v24, v23
    v_mul_f32 v25, v25, v23
    v_cvt_pk_bf16_f32 v123, v24, v25
    buffer_store_dwordx4 v[120:123], v16, s[4:7], s37 offen offset:0 sc1
    v_lshlrev_b32 v24, 16, v124
    v_and_b32 v25, 0xffff0000, v124
    v_mul_f32 v24, v24, v23
    v_mul_f32 v25, v25, v23
    v_cvt_pk_bf16_f32 v124, v24, v25
    v_lshlrev_b32 v24, 16, v125
    v_and_b32 v25, 0xffff0000, v125
    v_mul_f32 v24, v24, v23
    v_mul_f32 v25, v25, v23
    v_cvt_pk_bf16_f32 v125, v24, v25
    v_lshlrev_b32 v24, 16, v126
    v_and_b32 v25, 0xffff0000, v126
    v_mul_f32 v24, v24, v23
    v_mul_f32 v25, v25, v23
    v_cvt_pk_bf16_f32 v126, v24, v25
    v_lshlrev_b32 v24, 16, v127
    v_and_b32 v25, 0xffff0000, v127
    v_mul_f32 v24, v24, v23
    v_mul_f32 v25, v25, v23
    v_cvt_pk_bf16_f32 v127, v24, v25
    buffer_store_dwordx4 v[124:127], v16, s[4:7], s37 offen offset:2048 sc1
    s_add_u32 s37, s37, 4096
    v_lshlrev_b32 v24, 16, v128
    v_and_b32 v25, 0xffff0000, v128
    v_mul_f32 v24, v24, v23
    v_mul_f32 v25, v25, v23
    v_cvt_pk_bf16_f32 v128, v24, v25
    v_lshlrev_b32 v24, 16, v129
    v_and_b32 v25, 0xffff0000, v129
    v_mul_f32 v24, v24, v23
    v_mul_f32 v25, v25, v23
    v_cvt_pk_bf16_f32 v129, v24, v25
    v_lshlrev_b32 v24, 16, v130
    v_and_b32 v25, 0xffff0000, v130
    v_mul_f32 v24, v24, v23
    v_mul_f32 v25, v25, v23
    v_cvt_pk_bf16_f32 v130, v24, v25
    v_lshlrev_b32 v24, 16, v131
    v_and_b32 v25, 0xffff0000, v131
    v_mul_f32 v24, v24, v23
    v_mul_f32 v25, v25, v23
    v_cvt_pk_bf16_f32 v131, v24, v25
    buffer_store_dwordx4 v[128:131], v16, s[4:7], s37 offen offset:0 sc1
    v_lshlrev_b32 v24, 16, v132
    v_and_b32 v25, 0xffff0000, v132
    v_mul_f32 v24, v24, v23
    v_mul_f32 v25, v25, v23
    v_cvt_pk_bf16_f32 v132, v24, v25
    v_lshlrev_b32 v24, 16, v133
    v_and_b32 v25, 0xffff0000, v133
    v_mul_f32 v24, v24, v23
    v_mul_f32 v25, v25, v23
    v_cvt_pk_bf16_f32 v133, v24, v25
    v_lshlrev_b32 v24, 16, v134
    v_and_b32 v25, 0xffff0000, v134
    v_mul_f32 v24, v24, v23
    v_mul_f32 v25, v25, v23
    v_cvt_pk_bf16_f32 v134, v24, v25
    v_lshlrev_b32 v24, 16, v135
    v_and_b32 v25, 0xffff0000, v135
    v_mul_f32 v24, v24, v23
    v_mul_f32 v25, v25, v23
    v_cvt_pk_bf16_f32 v135, v24, v25
    buffer_store_dwordx4 v[132:135], v16, s[4:7], s37 offen offset:2048 sc1
    s_add_u32 s37, s37, 4096
    v_lshlrev_b32 v24, 16, v136
    v_and_b32 v25, 0xffff0000, v136
    v_mul_f32 v24, v24, v23
    v_mul_f32 v25, v25, v23
    v_cvt_pk_bf16_f32 v136, v24, v25
    v_lshlrev_b32 v24, 16, v137
    v_and_b32 v25, 0xffff0000, v137
    v_mul_f32 v24, v24, v23
    v_mul_f32 v25, v25, v23
    v_cvt_pk_bf16_f32 v137, v24, v25
    v_lshlrev_b32 v24, 16, v138
    v_and_b32 v25, 0xffff0000, v138
    v_mul_f32 v24, v24, v23
    v_mul_f32 v25, v25, v23
    v_cvt_pk_bf16_f32 v138, v24, v25
    v_lshlrev_b32 v24, 16, v139
    v_and_b32 v25, 0xffff0000, v139
    v_mul_f32 v24, v24, v23
    v_mul_f32 v25, v25, v23
    v_cvt_pk_bf16_f32 v139, v24, v25
    buffer_store_dwordx4 v[136:139], v16, s[4:7], s37 offen offset:0 sc1
    v_lshlrev_b32 v24, 16, v140
    v_and_b32 v25, 0xffff0000, v140
    v_mul_f32 v24, v24, v23
    v_mul_f32 v25, v25, v23
    v_cvt_pk_bf16_f32 v140, v24, v25
    v_lshlrev_b32 v24, 16, v141
    v_and_b32 v25, 0xffff0000, v141
    v_mul_f32 v24, v24, v23
    v_mul_f32 v25, v25, v23
    v_cvt_pk_bf16_f32 v141, v24, v25
    v_lshlrev_b32 v24, 16, v142
    v_and_b32 v25, 0xffff0000, v142
    v_mul_f32 v24, v24, v23
    v_mul_f32 v25, v25, v23
    v_cvt_pk_bf16_f32 v142, v24, v25
    v_lshlrev_b32 v24, 16, v143
    v_and_b32 v25, 0xffff0000, v143
    v_mul_f32 v24, v24, v23
    v_mul_f32 v25, v25, v23
    v_cvt_pk_bf16_f32 v143, v24, v25
    buffer_store_dwordx4 v[140:143], v16, s[4:7], s37 offen offset:2048 sc1
    s_add_u32 s37, s37, 4096
    v_lshlrev_b32 v24, 16, v144
    v_and_b32 v25, 0xffff0000, v144
    v_mul_f32 v24, v24, v23
    v_mul_f32 v25, v25, v23
    v_cvt_pk_bf16_f32 v144, v24, v25
    v_lshlrev_b32 v24, 16, v145
    v_and_b32 v25, 0xffff0000, v145
    v_mul_f32 v24, v24, v23
    v_mul_f32 v25, v25, v23
    v_cvt_pk_bf16_f32 v145, v24, v25
    v_lshlrev_b32 v24, 16, v146
    v_and_b32 v25, 0xffff0000, v146
    v_mul_f32 v24, v24, v23
    v_mul_f32 v25, v25, v23
    v_cvt_pk_bf16_f32 v146, v24, v25
    v_lshlrev_b32 v24, 16, v147
    v_and_b32 v25, 0xffff0000, v147
    v_mul_f32 v24, v24, v23
    v_mul_f32 v25, v25, v23
    v_cvt_pk_bf16_f32 v147, v24, v25
    buffer_store_dwordx4 v[144:147], v16, s[4:7], s37 offen offset:0 sc1
    v_lshlrev_b32 v24, 16, v148
    v_and_b32 v25, 0xffff0000, v148
    v_mul_f32 v24, v24, v23
    v_mul_f32 v25, v25, v23
    v_cvt_pk_bf16_f32 v148, v24, v25
    v_lshlrev_b32 v24, 16, v149
    v_and_b32 v25, 0xffff0000, v149
    v_mul_f32 v24, v24, v23
    v_mul_f32 v25, v25, v23
    v_cvt_pk_bf16_f32 v149, v24, v25
    v_lshlrev_b32 v24, 16, v150
    v_and_b32 v25, 0xffff0000, v150
    v_mul_f32 v24, v24, v23
    v_mul_f32 v25, v25, v23
    v_cvt_pk_bf16_f32 v150, v24, v25
    v_lshlrev_b32 v24, 16, v151
    v_and_b32 v25, 0xffff0000, v151
    v_mul_f32 v24, v24, v23
    v_mul_f32 v25, v25, v23
    v_cvt_pk_bf16_f32 v151, v24, v25
    buffer_store_dwordx4 v[148:151], v16, s[4:7], s37 offen offset:2048 sc1
    s_add_u32 s37, s37, 4096
    v_lshlrev_b32 v24, 16, v152
    v_and_b32 v25, 0xffff0000, v152
    v_mul_f32 v24, v24, v23
    v_mul_f32 v25, v25, v23
    v_cvt_pk_bf16_f32 v152, v24, v25
    v_lshlrev_b32 v24, 16, v153
    v_and_b32 v25, 0xffff0000, v153
    v_mul_f32 v24, v24, v23
    v_mul_f32 v25, v25, v23
    v_cvt_pk_bf16_f32 v153, v24, v25
    v_lshlrev_b32 v24, 16, v154
    v_and_b32 v25, 0xffff0000, v154
    v_mul_f32 v24, v24, v23
    v_mul_f32 v25, v25, v23
    v_cvt_pk_bf16_f32 v154, v24, v25
    v_lshlrev_b32 v24, 16, v155
    v_and_b32 v25, 0xffff0000, v155
    v_mul_f32 v24, v24, v23
    v_mul_f32 v25, v25, v23
    v_cvt_pk_bf16_f32 v155, v24, v25
    buffer_store_dwordx4 v[152:155], v16, s[4:7], s37 offen offset:0 sc1
    v_lshlrev_b32 v24, 16, v156
    v_and_b32 v25, 0xffff0000, v156
    v_mul_f32 v24, v24, v23
    v_mul_f32 v25, v25, v23
    v_cvt_pk_bf16_f32 v156, v24, v25
    v_lshlrev_b32 v24, 16, v157
    v_and_b32 v25, 0xffff0000, v157
    v_mul_f32 v24, v24, v23
    v_mul_f32 v25, v25, v23
    v_cvt_pk_bf16_f32 v157, v24, v25
    v_lshlrev_b32 v24, 16, v158
    v_and_b32 v25, 0xffff0000, v158
    v_mul_f32 v24, v24, v23
    v_mul_f32 v25, v25, v23
    v_cvt_pk_bf16_f32 v158, v24, v25
    v_lshlrev_b32 v24, 16, v159
    v_and_b32 v25, 0xffff0000, v159
    v_mul_f32 v24, v24, v23
    v_mul_f32 v25, v25, v23
    v_cvt_pk_bf16_f32 v159, v24, v25
    buffer_store_dwordx4 v[156:159], v16, s[4:7], s37 offen offset:2048 sc1
    s_add_u32 s37, s37, 4096
    v_lshlrev_b32 v24, 16, v160
    v_and_b32 v25, 0xffff0000, v160
    v_mul_f32 v24, v24, v23
    v_mul_f32 v25, v25, v23
    v_cvt_pk_bf16_f32 v160, v24, v25
    v_lshlrev_b32 v24, 16, v161
    v_and_b32 v25, 0xffff0000, v161
    v_mul_f32 v24, v24, v23
    v_mul_f32 v25, v25, v23
    v_cvt_pk_bf16_f32 v161, v24, v25
    v_lshlrev_b32 v24, 16, v162
    v_and_b32 v25, 0xffff0000, v162
    v_mul_f32 v24, v24, v23
    v_mul_f32 v25, v25, v23
    v_cvt_pk_bf16_f32 v162, v24, v25
    v_lshlrev_b32 v24, 16, v163
    v_and_b32 v25, 0xffff0000, v163
    v_mul_f32 v24, v24, v23
    v_mul_f32 v25, v25, v23
    v_cvt_pk_bf16_f32 v163, v24, v25
    buffer_store_dwordx4 v[160:163], v16, s[4:7], s37 offen offset:0 sc1
    v_lshlrev_b32 v24, 16, v164
    v_and_b32 v25, 0xffff0000, v164
    v_mul_f32 v24, v24, v23
    v_mul_f32 v25, v25, v23
    v_cvt_pk_bf16_f32 v164, v24, v25
    v_lshlrev_b32 v24, 16, v165
    v_and_b32 v25, 0xffff0000, v165
    v_mul_f32 v24, v24, v23
    v_mul_f32 v25, v25, v23
    v_cvt_pk_bf16_f32 v165, v24, v25
    v_lshlrev_b32 v24, 16, v166
    v_and_b32 v25, 0xffff0000, v166
    v_mul_f32 v24, v24, v23
    v_mul_f32 v25, v25, v23
    v_cvt_pk_bf16_f32 v166, v24, v25
    v_lshlrev_b32 v24, 16, v167
    v_and_b32 v25, 0xffff0000, v167
    v_mul_f32 v24, v24, v23
    v_mul_f32 v25, v25, v23
    v_cvt_pk_bf16_f32 v167, v24, v25
    buffer_store_dwordx4 v[164:167], v16, s[4:7], s37 offen offset:2048 sc1
    s_add_u32 s37, s37, 4096
    v_lshlrev_b32 v24, 16, v168
    v_and_b32 v25, 0xffff0000, v168
    v_mul_f32 v24, v24, v23
    v_mul_f32 v25, v25, v23
    v_cvt_pk_bf16_f32 v168, v24, v25
    v_lshlrev_b32 v24, 16, v169
    v_and_b32 v25, 0xffff0000, v169
    v_mul_f32 v24, v24, v23
    v_mul_f32 v25, v25, v23
    v_cvt_pk_bf16_f32 v169, v24, v25
    v_lshlrev_b32 v24, 16, v170
    v_and_b32 v25, 0xffff0000, v170
    v_mul_f32 v24, v24, v23
    v_mul_f32 v25, v25, v23
    v_cvt_pk_bf16_f32 v170, v24, v25
    v_lshlrev_b32 v24, 16, v171
    v_and_b32 v25, 0xffff0000, v171
    v_mul_f32 v24, v24, v23
    v_mul_f32 v25, v25, v23
    v_cvt_pk_bf16_f32 v171, v24, v25
    buffer_store_dwordx4 v[168:171], v16, s[4:7], s37 offen offset:0 sc1
    v_lshlrev_b32 v24, 16, v172
    v_and_b32 v25, 0xffff0000, v172
    v_mul_f32 v24, v24, v23
    v_mul_f32 v25, v25, v23
    v_cvt_pk_bf16_f32 v172, v24, v25
    v_lshlrev_b32 v24, 16, v173
    v_and_b32 v25, 0xffff0000, v173
    v_mul_f32 v24, v24, v23
    v_mul_f32 v25, v25, v23
    v_cvt_pk_bf16_f32 v173, v24, v25
    v_lshlrev_b32 v24, 16, v174
    v_and_b32 v25, 0xffff0000, v174
    v_mul_f32 v24, v24, v23
    v_mul_f32 v25, v25, v23
    v_cvt_pk_bf16_f32 v174, v24, v25
    v_lshlrev_b32 v24, 16, v175
    v_and_b32 v25, 0xffff0000, v175
    v_mul_f32 v24, v24, v23
    v_mul_f32 v25, v25, v23
    v_cvt_pk_bf16_f32 v175, v24, v25
    buffer_store_dwordx4 v[172:175], v16, s[4:7], s37 offen offset:2048 sc1
    s_add_u32 s37, s37, 4096
    v_cvt_pk_bf16_f32 v20, v12, v12
    v_and_b32 v20, 0xffff0000, v20
    v_ashrrev_i32 v21, 31, v20
    v_or_b32 v21, 0x80000000, v21
    v_xor_b32 v20, v20, v21
    v_and_b32 v20, 0xffff0000, v20
    s_lshl_b32 s32, s34, 5
    s_add_u32 s32, s32, 16
    s_sub_u32 s33, 2047, s32
    v_sub_u32 v21, s33, v6
    v_or_b32 v20, v20, v21
    v_cvt_pk_bf16_f32 v21, v13, v13
    v_and_b32 v21, 0xffff0000, v21
    v_mul_f32 v22, s40, v21
    v_exp_f32 v22, v22
    s_nop 0
    v_add_f32 v22, 1.0, v22
    v_rcp_f32 v22, v22
    s_nop 0
    v_cvt_pk_bf16_f32 v22, v22, v22
    v_and_b32 v22, 0xffff0000, v22
    v_sub_f32 v23, 1.0, v22
    v_cvt_pk_bf16_f32 v23, v23, v23
    v_and_b32 v23, 0xffff0000, v23
    s_lshl_b32 s32, s32, 2
    s_add_u32 s33, s32, 2113536
    s_add_u32 s32, s32, 2101248
    s_mov_b64 exec, 0xffff
    buffer_store_dword v20, v17, s[4:7], s33 offen sc1
    buffer_store_dword v22, v17, s[4:7], s32 offen sc1
    s_mov_b64 exec, -1
    s_add_u32 s37, s35, 168821248
    v_lshlrev_b32 v24, 16, v176
    v_and_b32 v25, 0xffff0000, v176
    v_mul_f32 v24, v24, v23
    v_mul_f32 v25, v25, v23
    v_cvt_pk_bf16_f32 v176, v24, v25
    v_lshlrev_b32 v24, 16, v177
    v_and_b32 v25, 0xffff0000, v177
    v_mul_f32 v24, v24, v23
    v_mul_f32 v25, v25, v23
    v_cvt_pk_bf16_f32 v177, v24, v25
    v_lshlrev_b32 v24, 16, v178
    v_and_b32 v25, 0xffff0000, v178
    v_mul_f32 v24, v24, v23
    v_mul_f32 v25, v25, v23
    v_cvt_pk_bf16_f32 v178, v24, v25
    v_lshlrev_b32 v24, 16, v179
    v_and_b32 v25, 0xffff0000, v179
    v_mul_f32 v24, v24, v23
    v_mul_f32 v25, v25, v23
    v_cvt_pk_bf16_f32 v179, v24, v25
    buffer_store_dwordx4 v[176:179], v16, s[4:7], s37 offen offset:0 sc1
    v_lshlrev_b32 v24, 16, v180
    v_and_b32 v25, 0xffff0000, v180
    v_mul_f32 v24, v24, v23
    v_mul_f32 v25, v25, v23
    v_cvt_pk_bf16_f32 v180, v24, v25
    v_lshlrev_b32 v24, 16, v181
    v_and_b32 v25, 0xffff0000, v181
    v_mul_f32 v24, v24, v23
    v_mul_f32 v25, v25, v23
    v_cvt_pk_bf16_f32 v181, v24, v25
    v_lshlrev_b32 v24, 16, v182
    v_and_b32 v25, 0xffff0000, v182
    v_mul_f32 v24, v24, v23
    v_mul_f32 v25, v25, v23
    v_cvt_pk_bf16_f32 v182, v24, v25
    v_lshlrev_b32 v24, 16, v183
    v_and_b32 v25, 0xffff0000, v183
    v_mul_f32 v24, v24, v23
    v_mul_f32 v25, v25, v23
    v_cvt_pk_bf16_f32 v183, v24, v25
    buffer_store_dwordx4 v[180:183], v16, s[4:7], s37 offen offset:2048 sc1
    s_add_u32 s37, s37, 4096
    v_lshlrev_b32 v24, 16, v184
    v_and_b32 v25, 0xffff0000, v184
    v_mul_f32 v24, v24, v23
    v_mul_f32 v25, v25, v23
    v_cvt_pk_bf16_f32 v184, v24, v25
    v_lshlrev_b32 v24, 16, v185
    v_and_b32 v25, 0xffff0000, v185
    v_mul_f32 v24, v24, v23
    v_mul_f32 v25, v25, v23
    v_cvt_pk_bf16_f32 v185, v24, v25
    v_lshlrev_b32 v24, 16, v186
    v_and_b32 v25, 0xffff0000, v186
    v_mul_f32 v24, v24, v23
    v_mul_f32 v25, v25, v23
    v_cvt_pk_bf16_f32 v186, v24, v25
    v_lshlrev_b32 v24, 16, v187
    v_and_b32 v25, 0xffff0000, v187
    v_mul_f32 v24, v24, v23
    v_mul_f32 v25, v25, v23
    v_cvt_pk_bf16_f32 v187, v24, v25
    buffer_store_dwordx4 v[184:187], v16, s[4:7], s37 offen offset:0 sc1
    v_lshlrev_b32 v24, 16, v188
    v_and_b32 v25, 0xffff0000, v188
    v_mul_f32 v24, v24, v23
    v_mul_f32 v25, v25, v23
    v_cvt_pk_bf16_f32 v188, v24, v25
    v_lshlrev_b32 v24, 16, v189
    v_and_b32 v25, 0xffff0000, v189
    v_mul_f32 v24, v24, v23
    v_mul_f32 v25, v25, v23
    v_cvt_pk_bf16_f32 v189, v24, v25
    v_lshlrev_b32 v24, 16, v190
    v_and_b32 v25, 0xffff0000, v190
    v_mul_f32 v24, v24, v23
    v_mul_f32 v25, v25, v23
    v_cvt_pk_bf16_f32 v190, v24, v25
    v_lshlrev_b32 v24, 16, v191
    v_and_b32 v25, 0xffff0000, v191
    v_mul_f32 v24, v24, v23
    v_mul_f32 v25, v25, v23
    v_cvt_pk_bf16_f32 v191, v24, v25
    buffer_store_dwordx4 v[188:191], v16, s[4:7], s37 offen offset:2048 sc1
    s_add_u32 s37, s37, 4096
    v_lshlrev_b32 v24, 16, v192
    v_and_b32 v25, 0xffff0000, v192
    v_mul_f32 v24, v24, v23
    v_mul_f32 v25, v25, v23
    v_cvt_pk_bf16_f32 v192, v24, v25
    v_lshlrev_b32 v24, 16, v193
    v_and_b32 v25, 0xffff0000, v193
    v_mul_f32 v24, v24, v23
    v_mul_f32 v25, v25, v23
    v_cvt_pk_bf16_f32 v193, v24, v25
    v_lshlrev_b32 v24, 16, v194
    v_and_b32 v25, 0xffff0000, v194
    v_mul_f32 v24, v24, v23
    v_mul_f32 v25, v25, v23
    v_cvt_pk_bf16_f32 v194, v24, v25
    v_lshlrev_b32 v24, 16, v195
    v_and_b32 v25, 0xffff0000, v195
    v_mul_f32 v24, v24, v23
    v_mul_f32 v25, v25, v23
    v_cvt_pk_bf16_f32 v195, v24, v25
    buffer_store_dwordx4 v[192:195], v16, s[4:7], s37 offen offset:0 sc1
    v_lshlrev_b32 v24, 16, v196
    v_and_b32 v25, 0xffff0000, v196
    v_mul_f32 v24, v24, v23
    v_mul_f32 v25, v25, v23
    v_cvt_pk_bf16_f32 v196, v24, v25
    v_lshlrev_b32 v24, 16, v197
    v_and_b32 v25, 0xffff0000, v197
    v_mul_f32 v24, v24, v23
    v_mul_f32 v25, v25, v23
    v_cvt_pk_bf16_f32 v197, v24, v25
    v_lshlrev_b32 v24, 16, v198
    v_and_b32 v25, 0xffff0000, v198
    v_mul_f32 v24, v24, v23
    v_mul_f32 v25, v25, v23
    v_cvt_pk_bf16_f32 v198, v24, v25
    v_lshlrev_b32 v24, 16, v199
    v_and_b32 v25, 0xffff0000, v199
    v_mul_f32 v24, v24, v23
    v_mul_f32 v25, v25, v23
    v_cvt_pk_bf16_f32 v199, v24, v25
    buffer_store_dwordx4 v[196:199], v16, s[4:7], s37 offen offset:2048 sc1
    s_add_u32 s37, s37, 4096
    v_lshlrev_b32 v24, 16, v200
    v_and_b32 v25, 0xffff0000, v200
    v_mul_f32 v24, v24, v23
    v_mul_f32 v25, v25, v23
    v_cvt_pk_bf16_f32 v200, v24, v25
    v_lshlrev_b32 v24, 16, v201
    v_and_b32 v25, 0xffff0000, v201
    v_mul_f32 v24, v24, v23
    v_mul_f32 v25, v25, v23
    v_cvt_pk_bf16_f32 v201, v24, v25
    v_lshlrev_b32 v24, 16, v202
    v_and_b32 v25, 0xffff0000, v202
    v_mul_f32 v24, v24, v23
    v_mul_f32 v25, v25, v23
    v_cvt_pk_bf16_f32 v202, v24, v25
    v_lshlrev_b32 v24, 16, v203
    v_and_b32 v25, 0xffff0000, v203
    v_mul_f32 v24, v24, v23
    v_mul_f32 v25, v25, v23
    v_cvt_pk_bf16_f32 v203, v24, v25
    buffer_store_dwordx4 v[200:203], v16, s[4:7], s37 offen offset:0 sc1
    v_lshlrev_b32 v24, 16, v204
    v_and_b32 v25, 0xffff0000, v204
    v_mul_f32 v24, v24, v23
    v_mul_f32 v25, v25, v23
    v_cvt_pk_bf16_f32 v204, v24, v25
    v_lshlrev_b32 v24, 16, v205
    v_and_b32 v25, 0xffff0000, v205
    v_mul_f32 v24, v24, v23
    v_mul_f32 v25, v25, v23
    v_cvt_pk_bf16_f32 v205, v24, v25
    v_lshlrev_b32 v24, 16, v206
    v_and_b32 v25, 0xffff0000, v206
    v_mul_f32 v24, v24, v23
    v_mul_f32 v25, v25, v23
    v_cvt_pk_bf16_f32 v206, v24, v25
    v_lshlrev_b32 v24, 16, v207
    v_and_b32 v25, 0xffff0000, v207
    v_mul_f32 v24, v24, v23
    v_mul_f32 v25, v25, v23
    v_cvt_pk_bf16_f32 v207, v24, v25
    buffer_store_dwordx4 v[204:207], v16, s[4:7], s37 offen offset:2048 sc1
    s_add_u32 s37, s37, 4096
    v_lshlrev_b32 v24, 16, v208
    v_and_b32 v25, 0xffff0000, v208
    v_mul_f32 v24, v24, v23
    v_mul_f32 v25, v25, v23
    v_cvt_pk_bf16_f32 v208, v24, v25
    v_lshlrev_b32 v24, 16, v209
    v_and_b32 v25, 0xffff0000, v209
    v_mul_f32 v24, v24, v23
    v_mul_f32 v25, v25, v23
    v_cvt_pk_bf16_f32 v209, v24, v25
    v_lshlrev_b32 v24, 16, v210
    v_and_b32 v25, 0xffff0000, v210
    v_mul_f32 v24, v24, v23
    v_mul_f32 v25, v25, v23
    v_cvt_pk_bf16_f32 v210, v24, v25
    v_lshlrev_b32 v24, 16, v211
    v_and_b32 v25, 0xffff0000, v211
    v_mul_f32 v24, v24, v23
    v_mul_f32 v25, v25, v23
    v_cvt_pk_bf16_f32 v211, v24, v25
    buffer_store_dwordx4 v[208:211], v16, s[4:7], s37 offen offset:0 sc1
    v_lshlrev_b32 v24, 16, v212
    v_and_b32 v25, 0xffff0000, v212
    v_mul_f32 v24, v24, v23
    v_mul_f32 v25, v25, v23
    v_cvt_pk_bf16_f32 v212, v24, v25
    v_lshlrev_b32 v24, 16, v213
    v_and_b32 v25, 0xffff0000, v213
    v_mul_f32 v24, v24, v23
    v_mul_f32 v25, v25, v23
    v_cvt_pk_bf16_f32 v213, v24, v25
    v_lshlrev_b32 v24, 16, v214
    v_and_b32 v25, 0xffff0000, v214
    v_mul_f32 v24, v24, v23
    v_mul_f32 v25, v25, v23
    v_cvt_pk_bf16_f32 v214, v24, v25
    v_lshlrev_b32 v24, 16, v215
    v_and_b32 v25, 0xffff0000, v215
    v_mul_f32 v24, v24, v23
    v_mul_f32 v25, v25, v23
    v_cvt_pk_bf16_f32 v215, v24, v25
    buffer_store_dwordx4 v[212:215], v16, s[4:7], s37 offen offset:2048 sc1
    s_add_u32 s37, s37, 4096
    v_lshlrev_b32 v24, 16, v216
    v_and_b32 v25, 0xffff0000, v216
    v_mul_f32 v24, v24, v23
    v_mul_f32 v25, v25, v23
    v_cvt_pk_bf16_f32 v216, v24, v25
    v_lshlrev_b32 v24, 16, v217
    v_and_b32 v25, 0xffff0000, v217
    v_mul_f32 v24, v24, v23
    v_mul_f32 v25, v25, v23
    v_cvt_pk_bf16_f32 v217, v24, v25
    v_lshlrev_b32 v24, 16, v218
    v_and_b32 v25, 0xffff0000, v218
    v_mul_f32 v24, v24, v23
    v_mul_f32 v25, v25, v23
    v_cvt_pk_bf16_f32 v218, v24, v25
    v_lshlrev_b32 v24, 16, v219
    v_and_b32 v25, 0xffff0000, v219
    v_mul_f32 v24, v24, v23
    v_mul_f32 v25, v25, v23
    v_cvt_pk_bf16_f32 v219, v24, v25
    buffer_store_dwordx4 v[216:219], v16, s[4:7], s37 offen offset:0 sc1
    v_lshlrev_b32 v24, 16, v220
    v_and_b32 v25, 0xffff0000, v220
    v_mul_f32 v24, v24, v23
    v_mul_f32 v25, v25, v23
    v_cvt_pk_bf16_f32 v220, v24, v25
    v_lshlrev_b32 v24, 16, v221
    v_and_b32 v25, 0xffff0000, v221
    v_mul_f32 v24, v24, v23
    v_mul_f32 v25, v25, v23
    v_cvt_pk_bf16_f32 v221, v24, v25
    v_lshlrev_b32 v24, 16, v222
    v_and_b32 v25, 0xffff0000, v222
    v_mul_f32 v24, v24, v23
    v_mul_f32 v25, v25, v23
    v_cvt_pk_bf16_f32 v222, v24, v25
    v_lshlrev_b32 v24, 16, v223
    v_and_b32 v25, 0xffff0000, v223
    v_mul_f32 v24, v24, v23
    v_mul_f32 v25, v25, v23
    v_cvt_pk_bf16_f32 v223, v24, v25
    buffer_store_dwordx4 v[220:223], v16, s[4:7], s37 offen offset:2048 sc1
    s_add_u32 s37, s37, 4096
    v_lshlrev_b32 v24, 16, v224
    v_and_b32 v25, 0xffff0000, v224
    v_mul_f32 v24, v24, v23
    v_mul_f32 v25, v25, v23
    v_cvt_pk_bf16_f32 v224, v24, v25
    v_lshlrev_b32 v24, 16, v225
    v_and_b32 v25, 0xffff0000, v225
    v_mul_f32 v24, v24, v23
    v_mul_f32 v25, v25, v23
    v_cvt_pk_bf16_f32 v225, v24, v25
    v_lshlrev_b32 v24, 16, v226
    v_and_b32 v25, 0xffff0000, v226
    v_mul_f32 v24, v24, v23
    v_mul_f32 v25, v25, v23
    v_cvt_pk_bf16_f32 v226, v24, v25
    v_lshlrev_b32 v24, 16, v227
    v_and_b32 v25, 0xffff0000, v227
    v_mul_f32 v24, v24, v23
    v_mul_f32 v25, v25, v23
    v_cvt_pk_bf16_f32 v227, v24, v25
    buffer_store_dwordx4 v[224:227], v16, s[4:7], s37 offen offset:0 sc1
    v_lshlrev_b32 v24, 16, v228
    v_and_b32 v25, 0xffff0000, v228
    v_mul_f32 v24, v24, v23
    v_mul_f32 v25, v25, v23
    v_cvt_pk_bf16_f32 v228, v24, v25
    v_lshlrev_b32 v24, 16, v229
    v_and_b32 v25, 0xffff0000, v229
    v_mul_f32 v24, v24, v23
    v_mul_f32 v25, v25, v23
    v_cvt_pk_bf16_f32 v229, v24, v25
    v_lshlrev_b32 v24, 16, v230
    v_and_b32 v25, 0xffff0000, v230
    v_mul_f32 v24, v24, v23
    v_mul_f32 v25, v25, v23
    v_cvt_pk_bf16_f32 v230, v24, v25
    v_lshlrev_b32 v24, 16, v231
    v_and_b32 v25, 0xffff0000, v231
    v_mul_f32 v24, v24, v23
    v_mul_f32 v25, v25, v23
    v_cvt_pk_bf16_f32 v231, v24, v25
    buffer_store_dwordx4 v[228:231], v16, s[4:7], s37 offen offset:2048 sc1
    s_add_u32 s37, s37, 4096
    v_lshlrev_b32 v24, 16, v232
    v_and_b32 v25, 0xffff0000, v232
    v_mul_f32 v24, v24, v23
    v_mul_f32 v25, v25, v23
    v_cvt_pk_bf16_f32 v232, v24, v25
    v_lshlrev_b32 v24, 16, v233
    v_and_b32 v25, 0xffff0000, v233
    v_mul_f32 v24, v24, v23
    v_mul_f32 v25, v25, v23
    v_cvt_pk_bf16_f32 v233, v24, v25
    v_lshlrev_b32 v24, 16, v234
    v_and_b32 v25, 0xffff0000, v234
    v_mul_f32 v24, v24, v23
    v_mul_f32 v25, v25, v23
    v_cvt_pk_bf16_f32 v234, v24, v25
    v_lshlrev_b32 v24, 16, v235
    v_and_b32 v25, 0xffff0000, v235
    v_mul_f32 v24, v24, v23
    v_mul_f32 v25, v25, v23
    v_cvt_pk_bf16_f32 v235, v24, v25
    buffer_store_dwordx4 v[232:235], v16, s[4:7], s37 offen offset:0 sc1
    v_lshlrev_b32 v24, 16, v236
    v_and_b32 v25, 0xffff0000, v236
    v_mul_f32 v24, v24, v23
    v_mul_f32 v25, v25, v23
    v_cvt_pk_bf16_f32 v236, v24, v25
    v_lshlrev_b32 v24, 16, v237
    v_and_b32 v25, 0xffff0000, v237
    v_mul_f32 v24, v24, v23
    v_mul_f32 v25, v25, v23
    v_cvt_pk_bf16_f32 v237, v24, v25
    v_lshlrev_b32 v24, 16, v238
    v_and_b32 v25, 0xffff0000, v238
    v_mul_f32 v24, v24, v23
    v_mul_f32 v25, v25, v23
    v_cvt_pk_bf16_f32 v238, v24, v25
    v_lshlrev_b32 v24, 16, v239
    v_and_b32 v25, 0xffff0000, v239
    v_mul_f32 v24, v24, v23
    v_mul_f32 v25, v25, v23
    v_cvt_pk_bf16_f32 v239, v24, v25
    buffer_store_dwordx4 v[236:239], v16, s[4:7], s37 offen offset:2048 sc1
    s_add_u32 s37, s37, 4096
    v_lshlrev_b32 v24, 16, v240
    v_and_b32 v25, 0xffff0000, v240
    v_mul_f32 v24, v24, v23
    v_mul_f32 v25, v25, v23
    v_cvt_pk_bf16_f32 v240, v24, v25
    v_lshlrev_b32 v24, 16, v241
    v_and_b32 v25, 0xffff0000, v241
    v_mul_f32 v24, v24, v23
    v_mul_f32 v25, v25, v23
    v_cvt_pk_bf16_f32 v241, v24, v25
    v_lshlrev_b32 v24, 16, v242
    v_and_b32 v25, 0xffff0000, v242
    v_mul_f32 v24, v24, v23
    v_mul_f32 v25, v25, v23
    v_cvt_pk_bf16_f32 v242, v24, v25
    v_lshlrev_b32 v24, 16, v243
    v_and_b32 v25, 0xffff0000, v243
    v_mul_f32 v24, v24, v23
    v_mul_f32 v25, v25, v23
    v_cvt_pk_bf16_f32 v243, v24, v25
    buffer_store_dwordx4 v[240:243], v16, s[4:7], s37 offen offset:0 sc1
    v_lshlrev_b32 v24, 16, v244
    v_and_b32 v25, 0xffff0000, v244
    v_mul_f32 v24, v24, v23
    v_mul_f32 v25, v25, v23
    v_cvt_pk_bf16_f32 v244, v24, v25
    v_lshlrev_b32 v24, 16, v245
    v_and_b32 v25, 0xffff0000, v245
    v_mul_f32 v24, v24, v23
    v_mul_f32 v25, v25, v23
    v_cvt_pk_bf16_f32 v245, v24, v25
    v_lshlrev_b32 v24, 16, v246
    v_and_b32 v25, 0xffff0000, v246
    v_mul_f32 v24, v24, v23
    v_mul_f32 v25, v25, v23
    v_cvt_pk_bf16_f32 v246, v24, v25
    v_lshlrev_b32 v24, 16, v247
    v_and_b32 v25, 0xffff0000, v247
    v_mul_f32 v24, v24, v23
    v_mul_f32 v25, v25, v23
    v_cvt_pk_bf16_f32 v247, v24, v25
    buffer_store_dwordx4 v[244:247], v16, s[4:7], s37 offen offset:2048 sc1
    s_add_u32 s37, s37, 4096
    v_lshlrev_b32 v24, 16, v248
    v_and_b32 v25, 0xffff0000, v248
    v_mul_f32 v24, v24, v23
    v_mul_f32 v25, v25, v23
    v_cvt_pk_bf16_f32 v248, v24, v25
    v_lshlrev_b32 v24, 16, v249
    v_and_b32 v25, 0xffff0000, v249
    v_mul_f32 v24, v24, v23
    v_mul_f32 v25, v25, v23
    v_cvt_pk_bf16_f32 v249, v24, v25
    v_lshlrev_b32 v24, 16, v250
    v_and_b32 v25, 0xffff0000, v250
    v_mul_f32 v24, v24, v23
    v_mul_f32 v25, v25, v23
    v_cvt_pk_bf16_f32 v250, v24, v25
    v_lshlrev_b32 v24, 16, v251
    v_and_b32 v25, 0xffff0000, v251
    v_mul_f32 v24, v24, v23
    v_mul_f32 v25, v25, v23
    v_cvt_pk_bf16_f32 v251, v24, v25
    buffer_store_dwordx4 v[248:251], v16, s[4:7], s37 offen offset:0 sc1
    v_lshlrev_b32 v24, 16, v252
    v_and_b32 v25, 0xffff0000, v252
    v_mul_f32 v24, v24, v23
    v_mul_f32 v25, v25, v23
    v_cvt_pk_bf16_f32 v252, v24, v25
    v_lshlrev_b32 v24, 16, v253
    v_and_b32 v25, 0xffff0000, v253
    v_mul_f32 v24, v24, v23
    v_mul_f32 v25, v25, v23
    v_cvt_pk_bf16_f32 v253, v24, v25
    v_lshlrev_b32 v24, 16, v254
    v_and_b32 v25, 0xffff0000, v254
    v_mul_f32 v24, v24, v23
    v_mul_f32 v25, v25, v23
    v_cvt_pk_bf16_f32 v254, v24, v25
    v_lshlrev_b32 v24, 16, v255
    v_and_b32 v25, 0xffff0000, v255
    v_mul_f32 v24, v24, v23
    v_mul_f32 v25, v25, v23
    v_cvt_pk_bf16_f32 v255, v24, v25
    buffer_store_dwordx4 v[252:255], v16, s[4:7], s37 offen offset:2048 sc1
    s_add_u32 s37, s37, 4096
    s_waitcnt vmcnt(0)
    s_barrier
    s_cmp_lg_u32 s12, 0
    s_cbranch_scc1 ds_114
    v_mov_b32 v3, 136
    v_mov_b32 v2, 1
    s_mov_b64 exec, 1
    buffer_atomic_add v2, v3, s[8:11], 0 offen sc1
    s_mov_b64 exec, -1
ds_114:
nox1_112:
    s_waitcnt vmcnt(0)
    s_barrier
    v_lshrrev_b32 v5, 4, v1
    v_lshlrev_b32 v5, 3, v5
    v_bfe_u32 v6, v1, 2, 2
    v_add_u32 v5, v5, v6
    v_lshlrev_b32 v7, 6, v5
    v_lshlrev_b32 v5, 7, v5
    v_and_b32 v6, 3, v1
    v_lshlrev_b32 v6, 3, v6
    s_lshl_b32 s32, s12, 5
    v_add3_u32 v5, v5, v6, s32
    s_and_b32 s32, s12, 1
    s_lshl_b32 s32, s32, 5
    s_lshr_b32 s33, s12, 1
    s_mul_i32 s33, s33, 49152
    s_add_u32 s32, s32, s33
    v_add3_u32 v7, v7, v6, s32
    v_add_u32 v6, 0, v5
    ds_read_b64_tr_b16 a[0:1], v6 offset:0
    ds_read_b64_tr_b16 a[2:3], v6 offset:512
    ds_read_b64_tr_b16 a[4:5], v6 offset:4096
    ds_read_b64_tr_b16 a[6:7], v6 offset:4608
    ds_read_b64_tr_b16 a[8:9], v6 offset:8192
    ds_read_b64_tr_b16 a[10:11], v6 offset:8704
    ds_read_b64_tr_b16 a[12:13], v6 offset:12288
    ds_read_b64_tr_b16 a[14:15], v6 offset:12800
    s_waitcnt lgkmcnt(0)
    ds_read_b64_tr_b16 a[16:17], v6 offset:16384
    ds_read_b64_tr_b16 a[18:19], v6 offset:16896
    ds_read_b64_tr_b16 a[20:21], v6 offset:20480
    ds_read_b64_tr_b16 a[22:23], v6 offset:20992
    ds_read_b64_tr_b16 a[24:25], v6 offset:24576
    ds_read_b64_tr_b16 a[26:27], v6 offset:25088
    ds_read_b64_tr_b16 a[28:29], v6 offset:28672
    ds_read_b64_tr_b16 a[30:31], v6 offset:29184
    s_waitcnt lgkmcnt(0)
    v_add_u32 v6, 32768, v5
    ds_read_b64_tr_b16 a[32:33], v6 offset:0
    ds_read_b64_tr_b16 a[34:35], v6 offset:512
    ds_read_b64_tr_b16 a[36:37], v6 offset:4096
    ds_read_b64_tr_b16 a[38:39], v6 offset:4608
    ds_read_b64_tr_b16 a[40:41], v6 offset:8192
    ds_read_b64_tr_b16 a[42:43], v6 offset:8704
    ds_read_b64_tr_b16 a[44:45], v6 offset:12288
    ds_read_b64_tr_b16 a[46:47], v6 offset:12800
    s_waitcnt lgkmcnt(0)
    ds_read_b64_tr_b16 a[48:49], v6 offset:16384
    ds_read_b64_tr_b16 a[50:51], v6 offset:16896
    ds_read_b64_tr_b16 a[52:53], v6 offset:20480
    ds_read_b64_tr_b16 a[54:55], v6 offset:20992
    ds_read_b64_tr_b16 a[56:57], v6 offset:24576
    ds_read_b64_tr_b16 a[58:59], v6 offset:25088
    ds_read_b64_tr_b16 a[60:61], v6 offset:28672
    ds_read_b64_tr_b16 a[62:63], v6 offset:29184
    s_waitcnt lgkmcnt(0)
    v_add_u32 v6, 65536, v5
    ds_read_b64_tr_b16 a[64:65], v6 offset:0
    ds_read_b64_tr_b16 a[66:67], v6 offset:512
    ds_read_b64_tr_b16 a[68:69], v6 offset:4096
    ds_read_b64_tr_b16 a[70:71], v6 offset:4608
    ds_read_b64_tr_b16 a[72:73], v6 offset:8192
    ds_read_b64_tr_b16 a[74:75], v6 offset:8704
    ds_read_b64_tr_b16 a[76:77], v6 offset:12288
    ds_read_b64_tr_b16 a[78:79], v6 offset:12800
    s_waitcnt lgkmcnt(0)
    v_add_u32 v6, 81920, v5
    ds_read_b64_tr_b16 a[80:81], v6 offset:0
    ds_read_b64_tr_b16 a[82:83], v6 offset:512
    ds_read_b64_tr_b16 a[84:85], v6 offset:4096
    ds_read_b64_tr_b16 a[86:87], v6 offset:4608
    ds_read_b64_tr_b16 a[88:89], v6 offset:8192
    ds_read_b64_tr_b16 a[90:91], v6 offset:8704
    ds_read_b64_tr_b16 a[92:93], v6 offset:12288
    ds_read_b64_tr_b16 a[94:95], v6 offset:12800
    s_waitcnt lgkmcnt(0)
    ds_read_b64_tr_b16 a[96:97], v6 offset:16384
    ds_read_b64_tr_b16 a[98:99], v6 offset:16896
    ds_read_b64_tr_b16 a[100:101], v6 offset:20480
    ds_read_b64_tr_b16 a[102:103], v6 offset:20992
    ds_read_b64_tr_b16 a[104:105], v6 offset:24576
    ds_read_b64_tr_b16 a[106:107], v6 offset:25088
    ds_read_b64_tr_b16 a[108:109], v6 offset:28672
    ds_read_b64_tr_b16 a[110:111], v6 offset:29184
    s_waitcnt lgkmcnt(0)
    v_add_u32 v6, 114688, v5
    ds_read_b64_tr_b16 a[112:113], v6 offset:0
    ds_read_b64_tr_b16 a[114:115], v6 offset:512
    ds_read_b64_tr_b16 a[116:117], v6 offset:4096
    ds_read_b64_tr_b16 a[118:119], v6 offset:4608
    ds_read_b64_tr_b16 a[120:121], v6 offset:8192
    ds_read_b64_tr_b16 a[122:123], v6 offset:8704
    ds_read_b64_tr_b16 a[124:125], v6 offset:12288
    ds_read_b64_tr_b16 a[126:127], v6 offset:12800
    s_waitcnt lgkmcnt(0)
    ds_read_b64_tr_b16 a[128:129], v6 offset:16384
    ds_read_b64_tr_b16 a[130:131], v6 offset:16896
    ds_read_b64_tr_b16 a[132:133], v6 offset:20480
    ds_read_b64_tr_b16 a[134:135], v6 offset:20992
    ds_read_b64_tr_b16 a[136:137], v6 offset:24576
    ds_read_b64_tr_b16 a[138:139], v6 offset:25088
    ds_read_b64_tr_b16 a[140:141], v6 offset:28672
    ds_read_b64_tr_b16 a[142:143], v6 offset:29184
    s_waitcnt lgkmcnt(0)
    v_add_u32 v6, 147456, v5
    ds_read_b64_tr_b16 a[144:145], v6 offset:0
    ds_read_b64_tr_b16 a[146:147], v6 offset:512
    ds_read_b64_tr_b16 a[148:149], v6 offset:4096
    ds_read_b64_tr_b16 a[150:151], v6 offset:4608
    ds_read_b64_tr_b16 a[152:153], v6 offset:8192
    ds_read_b64_tr_b16 a[154:155], v6 offset:8704
    ds_read_b64_tr_b16 a[156:157], v6 offset:12288
    ds_read_b64_tr_b16 a[158:159], v6 offset:12800
    s_waitcnt lgkmcnt(0)
    s_barrier
    s_cmp_ge_u32 s14, 20
    s_cbranch_scc1 nowd_115
    v_lshrrev_b32 v4, 2, v1
    v_mul_u32_u24 v4, 1280, v4
    v_and_b32 v6, 3, v1
    v_lshlrev_b32 v6, 4, v6
    v_add_u32 v4, v4, v6
    s_lshl_b32 s41, s14, 6
    s_mul_i32 s32, s12, 491520
    s_add_u32 s41, s41, s32
    s_mul_i32 s42, s12, 24576
    s_add_u32 m0, s42, 0
    s_add_u32 s37, s41, 0
    buffer_load_dwordx4 v4, s[28:31], s37 offen lds
    s_add_u32 m0, s42, 1024
    s_add_u32 s37, s41, 20480
    buffer_load_dwordx4 v4, s[28:31], s37 offen lds
    s_add_u32 m0, s42, 2048
    s_add_u32 s37, s41, 40960
    buffer_load_dwordx4 v4, s[28:31], s37 offen lds
    s_add_u32 m0, s42, 3072
    s_add_u32 s37, s41, 61440
    buffer_load_dwordx4 v4, s[28:31], s37 offen lds
    s_add_u32 m0, s42, 4096
    s_add_u32 s37, s41, 81920
    buffer_load_dwordx4 v4, s[28:31], s37 offen lds
    s_add_u32 m0, s42, 5120
    s_add_u32 s37, s41, 102400
    buffer_load_dwordx4 v4, s[28:31], s37 offen lds
    s_add_u32 m0, s42, 6144
    s_add_u32 s37, s41, 122880
    buffer_load_dwordx4 v4, s[28:31], s37 offen lds
    s_add_u32 m0, s42, 7168
    s_add_u32 s37, s41, 143360
    buffer_load_dwordx4 v4, s[28:31], s37 offen lds
    s_add_u32 m0, s42, 8192
    s_add_u32 s37, s41, 163840
    buffer_load_dwordx4 v4, s[28:31], s37 offen lds
    s_add_u32 m0, s42, 9216
    s_add_u32 s37, s41, 184320
    buffer_load_dwordx4 v4, s[28:31], s37 offen lds
    s_add_u32 m0, s42, 10240
    s_add_u32 s37, s41, 204800
    buffer_load_dwordx4 v4, s[28:31], s37 offen lds
    s_add_u32 m0, s42, 11264
    s_add_u32 s37, s41, 225280
    buffer_load_dwordx4 v4, s[28:31], s37 offen lds
    s_add_u32 m0, s42, 12288
    s_add_u32 s37, s41, 245760
    buffer_load_dwordx4 v4, s[28:31], s37 offen lds
    s_add_u32 m0, s42, 13312
    s_add_u32 s37, s41, 266240
    buffer_load_dwordx4 v4, s[28:31], s37 offen lds
    s_add_u32 m0, s42, 14336
    s_add_u32 s37, s41, 286720
    buffer_load_dwordx4 v4, s[28:31], s37 offen lds
    s_add_u32 m0, s42, 15360
    s_add_u32 s37, s41, 307200
    buffer_load_dwordx4 v4, s[28:31], s37 offen lds
    s_add_u32 m0, s42, 16384
    s_add_u32 s37, s41, 327680
    buffer_load_dwordx4 v4, s[28:31], s37 offen lds
    s_add_u32 m0, s42, 17408
    s_add_u32 s37, s41, 348160
    buffer_load_dwordx4 v4, s[28:31], s37 offen lds
    s_add_u32 m0, s42, 18432
    s_add_u32 s37, s41, 368640
    buffer_load_dwordx4 v4, s[28:31], s37 offen lds
    s_add_u32 m0, s42, 19456
    s_add_u32 s37, s41, 389120
    buffer_load_dwordx4 v4, s[28:31], s37 offen lds
    s_add_u32 m0, s42, 20480
    s_add_u32 s37, s41, 409600
    buffer_load_dwordx4 v4, s[28:31], s37 offen lds
    s_add_u32 m0, s42, 21504
    s_add_u32 s37, s41, 430080
    buffer_load_dwordx4 v4, s[28:31], s37 offen lds
    s_add_u32 m0, s42, 22528
    s_add_u32 s37, s41, 450560
    buffer_load_dwordx4 v4, s[28:31], s37 offen lds
    s_add_u32 m0, s42, 23552
    s_add_u32 s37, s41, 471040
    buffer_load_dwordx4 v4, s[28:31], s37 offen lds
nowd_115:
    s_cmp_lg_u32 s12, 0
    s_cbranch_scc1 dwo_117
    v_mov_b32 v3, 136
    s_mov_b32 s39, 0
dw_116:
    buffer_load_dword v2, v3, s[8:11], 0 offen sc1
    s_waitcnt vmcnt(0)
    v_readfirstlane_b32 s32, v2
    s_cmp_ge_u32 s32, 16
    s_cbranch_scc1 dwo_117
    s_sleep 4
    s_add_u32 s39, s39, 1
    s_cmp_lt_u32 s39, 20000
    s_cbranch_scc1 dw_116
    s_branch L_end3
dwo_117:
    s_barrier
    v_lshlrev_b32 v4, 4, v1
    s_mov_b32 s32, 2113536
    buffer_load_dwordx4 v[16:19], v4, s[4:7], s32 offen sc1
    s_mov_b32 s32, 2114560
    buffer_load_dwordx4 v[20:23], v4, s[4:7], s32 offen sc1
    s_mov_b32 s32, 2115584
    buffer_load_dwordx4 v[24:27], v4, s[4:7], s32 offen sc1
    s_mov_b32 s32, 2116608
    buffer_load_dwordx4 v[28:31], v4, s[4:7], s32 offen sc1
    s_mov_b32 s32, 2117632
    buffer_load_dwordx4 v[32:35], v4, s[4:7], s32 offen sc1
    s_mov_b32 s32, 2118656
    buffer_load_dwordx4 v[36:39], v4, s[4:7], s32 offen sc1
    s_mov_b32 s32, 2119680
    buffer_load_dwordx4 v[40:43], v4, s[4:7], s32 offen sc1
    s_mov_b32 s32, 2120704
    buffer_load_dwordx4 v[44:47], v4, s[4:7], s32 offen sc1
    s_waitcnt vmcnt(0)
    s_barrier
    s_mov_b32 s34, -1
    v_sub_u32 v48, s34, v16
    v_sub_u32 v49, s34, v17
    v_sub_u32 v50, s34, v18
    v_sub_u32 v51, s34, v19
    v_sub_u32 v52, s34, v20
    v_sub_u32 v53, s34, v21
    v_sub_u32 v54, s34, v22
    v_sub_u32 v55, s34, v23
    v_sub_u32 v56, s34, v24
    v_sub_u32 v57, s34, v25
    v_sub_u32 v58, s34, v26
    v_sub_u32 v59, s34, v27
    v_sub_u32 v60, s34, v28
    v_sub_u32 v61, s34, v29
    v_sub_u32 v62, s34, v30
    v_sub_u32 v63, s34, v31
    v_sub_u32 v64, s34, v32
    v_sub_u32 v65, s34, v33
    v_sub_u32 v66, s34, v34
    v_sub_u32 v67, s34, v35
    v_sub_u32 v68, s34, v36
    v_sub_u32 v69, s34, v37
    v_sub_u32 v70, s34, v38
    v_sub_u32 v71, s34, v39
    v_sub_u32 v72, s34, v40
    v_sub_u32 v73, s34, v41
    v_sub_u32 v74, s34, v42
    v_sub_u32 v75, s34, v43
    v_sub_u32 v76, s34, v44
    v_sub_u32 v77, s34, v45
    v_sub_u32 v78, s34, v46
    v_sub_u32 v79, s34, v47
    v_min3_u32 v48, v48, v49, v50
    v_min3_u32 v48, v48, v51, v52
    v_min3_u32 v48, v48, v53, v54
    v_min3_u32 v48, v48, v55, v56
    v_min3_u32 v48, v48, v57, v58
    v_min3_u32 v48, v48, v59, v60
    v_min3_u32 v48, v48, v61, v62
    v_min3_u32 v48, v48, v63, v64
    v_min3_u32 v48, v48, v65, v66
    v_min3_u32 v48, v48, v67, v68
    v_min3_u32 v48, v48, v69, v70
    v_min3_u32 v48, v48, v71, v72
    v_min3_u32 v48, v48, v73, v74
    v_min3_u32 v48, v48, v75, v76
    v_min3_u32 v48, v48, v77, v78
    v_min_u32 v48, v48, v79
    s_nop 1
    v_min_u32_dpp v48, v48, v48 quad_perm:[1,0,3,2] row_mask:0xf bank_mask:0xf
    s_nop 1
    v_min_u32_dpp v48, v48, v48 quad_perm:[2,3,0,1] row_mask:0xf bank_mask:0xf
    s_nop 1
    v_min_u32_dpp v48, v48, v48 row_half_mirror row_mask:0xf bank_mask:0xf
    s_nop 1
    v_min_u32_dpp v48, v48, v48 row_mirror row_mask:0xf bank_mask:0xf
    s_nop 0
    v_readlane_b32 s32, v48, 0
    v_readlane_b32 s33, v48, 16
    s_min_u32 s32, s32, s33
    v_readlane_b32 s33, v48, 32
    s_min_u32 s32, s32, s33
    v_readlane_b32 s33, v48, 48
    s_min_u32 s32, s32, s33
    s_sub_u32 s44, s34, s32
    s_sub_u32 s34, s44, 1
    s_nop 0
    v_sub_u32 v48, s34, v16
    v_sub_u32 v49, s34, v17
    v_sub_u32 v50, s34, v18
    v_sub_u32 v51, s34, v19
    v_sub_u32 v52, s34, v20
    v_sub_u32 v53, s34, v21
    v_sub_u32 v54, s34, v22
    v_sub_u32 v55, s34, v23
    v_sub_u32 v56, s34, v24
    v_sub_u32 v57, s34, v25
    v_sub_u32 v58, s34, v26
    v_sub_u32 v59, s34, v27
    v_sub_u32 v60, s34, v28
    v_sub_u32 v61, s34, v29
    v_sub_u32 v62, s34, v30
    v_sub_u32 v63, s34, v31
    v_sub_u32 v64, s34, v32
    v_sub_u32 v65, s34, v33
    v_sub_u32 v66, s34, v34
    v_sub_u32 v67, s34, v35
    v_sub_u32 v68, s34, v36
    v_sub_u32 v69, s34, v37
    v_sub_u32 v70, s34, v38
    v_sub_u32 v71, s34, v39
    v_sub_u32 v72, s34, v40
    v_sub_u32 v73, s34, v41
    v_sub_u32 v74, s34, v42
    v_sub_u32 v75, s34, v43
    v_sub_u32 v76, s34, v44
    v_sub_u32 v77, s34, v45
    v_sub_u32 v78, s34, v46
    v_sub_u32 v79, s34, v47
    v_min3_u32 v48, v48, v49, v50
    v_min3_u32 v48, v48, v51, v52
    v_min3_u32 v48, v48, v53, v54
    v_min3_u32 v48, v48, v55, v56
    v_min3_u32 v48, v48, v57, v58
    v_min3_u32 v48, v48, v59, v60
    v_min3_u32 v48, v48, v61, v62
    v_min3_u32 v48, v48, v63, v64
    v_min3_u32 v48, v48, v65, v66
    v_min3_u32 v48, v48, v67, v68
    v_min3_u32 v48, v48, v69, v70
    v_min3_u32 v48, v48, v71, v72
    v_min3_u32 v48, v48, v73, v74
    v_min3_u32 v48, v48, v75, v76
    v_min3_u32 v48, v48, v77, v78
    v_min_u32 v48, v48, v79
    s_nop 1
    v_min_u32_dpp v48, v48, v48 quad_perm:[1,0,3,2] row_mask:0xf bank_mask:0xf
    s_nop 1
    v_min_u32_dpp v48, v48, v48 quad_perm:[2,3,0,1] row_mask:0xf bank_mask:0xf
    s_nop 1
    v_min_u32_dpp v48, v48, v48 row_half_mirror row_mask:0xf bank_mask:0xf
    s_nop 1
    v_min_u32_dpp v48, v48, v48 row_mirror row_mask:0xf bank_mask:0xf
    s_nop 0
    v_readlane_b32 s32, v48, 0
    v_readlane_b32 s33, v48, 16
    s_min_u32 s32, s32, s33
    v_readlane_b32 s33, v48, 32
    s_min_u32 s32, s32, s33
    v_readlane_b32 s33, v48, 48
    s_min_u32 s32, s32, s33
    s_sub_u32 s45, s34, s32
    s_sub_u32 s34, s45, 1
    s_nop 0
    v_sub_u32 v48, s34, v16
    v_sub_u32 v49, s34, v17
    v_sub_u32 v50, s34, v18
    v_sub_u32 v51, s34, v19
    v_sub_u32 v52, s34, v20
    v_sub_u32 v53, s34, v21
    v_sub_u32 v54, s34, v22
    v_sub_u32 v55, s34, v23
    v_sub_u32 v56, s34, v24
    v_sub_u32 v57, s34, v25
    v_sub_u32 v58, s34, v26
    v_sub_u32 v59, s34, v27
    v_sub_u32 v60, s34, v28
    v_sub_u32 v61, s34, v29
    v_sub_u32 v62, s34, v30
    v_sub_u32 v63, s34, v31
    v_sub_u32 v64, s34, v32
    v_sub_u32 v65, s34, v33
    v_sub_u32 v66, s34, v34
    v_sub_u32 v67, s34, v35
    v_sub_u32 v68, s34, v36
    v_sub_u32 v69, s34, v37
    v_sub_u32 v70, s34, v38
    v_sub_u32 v71, s34, v39
    v_sub_u32 v72, s34, v40
    v_sub_u32 v73, s34, v41
    v_sub_u32 v74, s34, v42
    v_sub_u32 v75, s34, v43
    v_sub_u32 v76, s34, v44
    v_sub_u32 v77, s34, v45
    v_sub_u32 v78, s34, v46
    v_sub_u32 v79, s34, v47
    v_min3_u32 v48, v48, v49, v50
    v_min3_u32 v48, v48, v51, v52
    v_min3_u32 v48, v48, v53, v54
    v_min3_u32 v48, v48, v55, v56
    v_min3_u32 v48, v48, v57, v58
    v_min3_u32 v48, v48, v59, v60
    v_min3_u32 v48, v48, v61, v62
    v_min3_u32 v48, v48, v63, v64
    v_min3_u32 v48, v48, v65, v66
    v_min3_u32 v48, v48, v67, v68
    v_min3_u32 v48, v48, v69, v70
    v_min3_u32 v48, v48, v71, v72
    v_min3_u32 v48, v48, v73, v74
    v_min3_u32 v48, v48, v75, v76
    v_min3_u32 v48, v48, v77, v78
    v_min_u32 v48, v48, v79
    s_nop 1
    v_min_u32_dpp v48, v48, v48 quad_perm:[1,0,3,2] row_mask:0xf bank_mask:0xf
    s_nop 1
    v_min_u32_dpp v48, v48, v48 quad_perm:[2,3,0,1] row_mask:0xf bank_mask:0xf
    s_nop 1
    v_min_u32_dpp v48, v48, v48 row_half_mirror row_mask:0xf bank_mask:0xf
    s_nop 1
    v_min_u32_dpp v48, v48, v48 row_mirror row_mask:0xf bank_mask:0xf
    s_nop 0
    v_readlane_b32 s32, v48, 0
    v_readlane_b32 s33, v48, 16
    s_min_u32 s32, s32, s33
    v_readlane_b32 s33, v48, 32
    s_min_u32 s32, s32, s33
    v_readlane_b32 s33, v48, 48
    s_min_u32 s32, s32, s33
    s_sub_u32 s46, s34, s32
    s_sub_u32 s34, s46, 1
    s_nop 0
    v_sub_u32 v48, s34, v16
    v_sub_u32 v49, s34, v17
    v_sub_u32 v50, s34, v18
    v_sub_u32 v51, s34, v19
    v_sub_u32 v52, s34, v20
    v_sub_u32 v53, s34, v21
    v_sub_u32 v54, s34, v22
    v_sub_u32 v55, s34, v23
    v_sub_u32 v56, s34, v24
    v_sub_u32 v57, s34, v25
    v_sub_u32 v58, s34, v26
    v_sub_u32 v59, s34, v27
    v_sub_u32 v60, s34, v28
    v_sub_u32 v61, s34, v29
    v_sub_u32 v62, s34, v30
    v_sub_u32 v63, s34, v31
    v_sub_u32 v64, s34, v32
    v_sub_u32 v65, s34, v33
    v_sub_u32 v66, s34, v34
    v_sub_u32 v67, s34, v35
    v_sub_u32 v68, s34, v36
    v_sub_u32 v69, s34, v37
    v_sub_u32 v70, s34, v38
    v_sub_u32 v71, s34, v39
    v_sub_u32 v72, s34, v40
    v_sub_u32 v73, s34, v41
    v_sub_u32 v74, s34, v42
    v_sub_u32 v75, s34, v43
    v_sub_u32 v76, s34, v44
    v_sub_u32 v77, s34, v45
    v_sub_u32 v78, s34, v46
    v_sub_u32 v79, s34, v47
    v_min3_u32 v48, v48, v49, v50
    v_min3_u32 v48, v48, v51, v52
    v_min3_u32 v48, v48, v53, v54
    v_min3_u32 v48, v48, v55, v56
    v_min3_u32 v48, v48, v57, v58
    v_min3_u32 v48, v48, v59, v60
    v_min3_u32 v48, v48, v61, v62
    v_min3_u32 v48, v48, v63, v64
    v_min3_u32 v48, v48, v65, v66
    v_min3_u32 v48, v48, v67, v68
    v_min3_u32 v48, v48, v69, v70
    v_min3_u32 v48, v48, v71, v72
    v_min3_u32 v48, v48, v73, v74
    v_min3_u32 v48, v48, v75, v76
    v_min3_u32 v48, v48, v77, v78
    v_min_u32 v48, v48, v79
    s_nop 1
    v_min_u32_dpp v48, v48, v48 quad_perm:[1,0,3,2] row_mask:0xf bank_mask:0xf
    s_nop 1
    v_min_u32_dpp v48, v48, v48 quad_perm:[2,3,0,1] row_mask:0xf bank_mask:0xf
    s_nop 1
    v_min_u32_dpp v48, v48, v48 row_half_mirror row_mask:0xf bank_mask:0xf
    s_nop 1
    v_min_u32_dpp v48, v48, v48 row_mirror row_mask:0xf bank_mask:0xf
    s_nop 0
    v_readlane_b32 s32, v48, 0
    v_readlane_b32 s33, v48, 16
    s_min_u32 s32, s32, s33
    v_readlane_b32 s33, v48, 32
    s_min_u32 s32, s32, s33
    v_readlane_b32 s33, v48, 48
    s_min_u32 s32, s32, s33
    s_sub_u32 s47, s34, s32
    s_sub_u32 s34, s47, 1
    s_nop 0
    v_sub_u32 v48, s34, v16
    v_sub_u32 v49, s34, v17
    v_sub_u32 v50, s34, v18
    v_sub_u32 v51, s34, v19
    v_sub_u32 v52, s34, v20
    v_sub_u32 v53, s34, v21
    v_sub_u32 v54, s34, v22
    v_sub_u32 v55, s34, v23
    v_sub_u32 v56, s34, v24
    v_sub_u32 v57, s34, v25
    v_sub_u32 v58, s34, v26
    v_sub_u32 v59, s34, v27
    v_sub_u32 v60, s34, v28
    v_sub_u32 v61, s34, v29
    v_sub_u32 v62, s34, v30
    v_sub_u32 v63, s34, v31
    v_sub_u32 v64, s34, v32
    v_sub_u32 v65, s34, v33
    v_sub_u32 v66, s34, v34
    v_sub_u32 v67, s34, v35
    v_sub_u32 v68, s34, v36
    v_sub_u32 v69, s34, v37
    v_sub_u32 v70, s34, v38
    v_sub_u32 v71, s34, v39
    v_sub_u32 v72, s34, v40
    v_sub_u32 v73, s34, v41
    v_sub_u32 v74, s34, v42
    v_sub_u32 v75, s34, v43
    v_sub_u32 v76, s34, v44
    v_sub_u32 v77, s34, v45
    v_sub_u32 v78, s34, v46
    v_sub_u32 v79, s34, v47
    v_min3_u32 v48, v48, v49, v50
    v_min3_u32 v48, v48, v51, v52
    v_min3_u32 v48, v48, v53, v54
    v_min3_u32 v48, v48, v55, v56
    v_min3_u32 v48, v48, v57, v58
    v_min3_u32 v48, v48, v59, v60
    v_min3_u32 v48, v48, v61, v62
    v_min3_u32 v48, v48, v63, v64
    v_min3_u32 v48, v48, v65, v66
    v_min3_u32 v48, v48, v67, v68
    v_min3_u32 v48, v48, v69, v70
    v_min3_u32 v48, v48, v71, v72
    v_min3_u32 v48, v48, v73, v74
    v_min3_u32 v48, v48, v75, v76
    v_min3_u32 v48, v48, v77, v78
    v_min_u32 v48, v48, v79
    s_nop 1
    v_min_u32_dpp v48, v48, v48 quad_perm:[1,0,3,2] row_mask:0xf bank_mask:0xf
    s_nop 1
    v_min_u32_dpp v48, v48, v48 quad_perm:[2,3,0,1] row_mask:0xf bank_mask:0xf
    s_nop 1
    v_min_u32_dpp v48, v48, v48 row_half_mirror row_mask:0xf bank_mask:0xf
    s_nop 1
    v_min_u32_dpp v48, v48, v48 row_mirror row_mask:0xf bank_mask:0xf
    s_nop 0
    v_readlane_b32 s32, v48, 0
    v_readlane_b32 s33, v48, 16
    s_min_u32 s32, s32, s33
    v_readlane_b32 s33, v48, 32
    s_min_u32 s32, s32, s33
    v_readlane_b32 s33, v48, 48
    s_min_u32 s32, s32, s33
    s_sub_u32 s48, s34, s32
    s_sub_u32 s34, s48, 1
    s_nop 0
    v_sub_u32 v48, s34, v16
    v_sub_u32 v49, s34, v17
    v_sub_u32 v50, s34, v18
    v_sub_u32 v51, s34, v19
    v_sub_u32 v52, s34, v20
    v_sub_u32 v53, s34, v21
    v_sub_u32 v54, s34, v22
    v_sub_u32 v55, s34, v23
    v_sub_u32 v56, s34, v24
    v_sub_u32 v57, s34, v25
    v_sub_u32 v58, s34, v26
    v_sub_u32 v59, s34, v27
    v_sub_u32 v60, s34, v28
    v_sub_u32 v61, s34, v29
    v_sub_u32 v62, s34, v30
    v_sub_u32 v63, s34, v31
    v_sub_u32 v64, s34, v32
    v_sub_u32 v65, s34, v33
    v_sub_u32 v66, s34, v34
    v_sub_u32 v67, s34, v35
    v_sub_u32 v68, s34, v36
    v_sub_u32 v69, s34, v37
    v_sub_u32 v70, s34, v38
    v_sub_u32 v71, s34, v39
    v_sub_u32 v72, s34, v40
    v_sub_u32 v73, s34, v41
    v_sub_u32 v74, s34, v42
    v_sub_u32 v75, s34, v43
    v_sub_u32 v76, s34, v44
    v_sub_u32 v77, s34, v45
    v_sub_u32 v78, s34, v46
    v_sub_u32 v79, s34, v47
    v_min3_u32 v48, v48, v49, v50
    v_min3_u32 v48, v48, v51, v52
    v_min3_u32 v48, v48, v53, v54
    v_min3_u32 v48, v48, v55, v56
    v_min3_u32 v48, v48, v57, v58
    v_min3_u32 v48, v48, v59, v60
    v_min3_u32 v48, v48, v61, v62
    v_min3_u32 v48, v48, v63, v64
    v_min3_u32 v48, v48, v65, v66
    v_min3_u32 v48, v48, v67, v68
    v_min3_u32 v48, v48, v69, v70
    v_min3_u32 v48, v48, v71, v72
    v_min3_u32 v48, v48, v73, v74
    v_min3_u32 v48, v48, v75, v76
    v_min3_u32 v48, v48, v77, v78
    v_min_u32 v48, v48, v79
    s_nop 1
    v_min_u32_dpp v48, v48, v48 quad_perm:[1,0,3,2] row_mask:0xf bank_mask:0xf
    s_nop 1
    v_min_u32_dpp v48, v48, v48 quad_perm:[2,3,0,1] row_mask:0xf bank_mask:0xf
    s_nop 1
    v_min_u32_dpp v48, v48, v48 row_half_mirror row_mask:0xf bank_mask:0xf
    s_nop 1
    v_min_u32_dpp v48, v48, v48 row_mirror row_mask:0xf bank_mask:0xf
    s_nop 0
    v_readlane_b32 s32, v48, 0
    v_readlane_b32 s33, v48, 16
    s_min_u32 s32, s32, s33
    v_readlane_b32 s33, v48, 32
    s_min_u32 s32, s32, s33
    v_readlane_b32 s33, v48, 48
    s_min_u32 s32, s32, s33
    s_sub_u32 s49, s34, s32
    s_sub_u32 s34, s49, 1
    s_nop 0
    v_sub_u32 v48, s34, v16
    v_sub_u32 v49, s34, v17
    v_sub_u32 v50, s34, v18
    v_sub_u32 v51, s34, v19
    v_sub_u32 v52, s34, v20
    v_sub_u32 v53, s34, v21
    v_sub_u32 v54, s34, v22
    v_sub_u32 v55, s34, v23
    v_sub_u32 v56, s34, v24
    v_sub_u32 v57, s34, v25
    v_sub_u32 v58, s34, v26
    v_sub_u32 v59, s34, v27
    v_sub_u32 v60, s34, v28
    v_sub_u32 v61, s34, v29
    v_sub_u32 v62, s34, v30
    v_sub_u32 v63, s34, v31
    v_sub_u32 v64, s34, v32
    v_sub_u32 v65, s34, v33
    v_sub_u32 v66, s34, v34
    v_sub_u32 v67, s34, v35
    v_sub_u32 v68, s34, v36
    v_sub_u32 v69, s34, v37
    v_sub_u32 v70, s34, v38
    v_sub_u32 v71, s34, v39
    v_sub_u32 v72, s34, v40
    v_sub_u32 v73, s34, v41
    v_sub_u32 v74, s34, v42
    v_sub_u32 v75, s34, v43
    v_sub_u32 v76, s34, v44
    v_sub_u32 v77, s34, v45
    v_sub_u32 v78, s34, v46
    v_sub_u32 v79, s34, v47
    v_min3_u32 v48, v48, v49, v50
    v_min3_u32 v48, v48, v51, v52
    v_min3_u32 v48, v48, v53, v54
    v_min3_u32 v48, v48, v55, v56
    v_min3_u32 v48, v48, v57, v58
    v_min3_u32 v48, v48, v59, v60
    v_min3_u32 v48, v48, v61, v62
    v_min3_u32 v48, v48, v63, v64
    v_min3_u32 v48, v48, v65, v66
    v_min3_u32 v48, v48, v67, v68
    v_min3_u32 v48, v48, v69, v70
    v_min3_u32 v48, v48, v71, v72
    v_min3_u32 v48, v48, v73, v74
    v_min3_u32 v48, v48, v75, v76
    v_min3_u32 v48, v48, v77, v78
    v_min_u32 v48, v48, v79
    s_nop 1
    v_min_u32_dpp v48, v48, v48 quad_perm:[1,0,3,2] row_mask:0xf bank_mask:0xf
    s_nop 1
    v_min_u32_dpp v48, v48, v48 quad_perm:[2,3,0,1] row_mask:0xf bank_mask:0xf
    s_nop 1
    v_min_u32_dpp v48, v48, v48 row_half_mirror row_mask:0xf bank_mask:0xf
    s_nop 1
    v_min_u32_dpp v48, v48, v48 row_mirror row_mask:0xf bank_mask:0xf
    s_nop 0
    v_readlane_b32 s32, v48, 0
    v_readlane_b32 s33, v48, 16
    s_min_u32 s32, s32, s33
    v_readlane_b32 s33, v48, 32
    s_min_u32 s32, s32, s33
    v_readlane_b32 s33, v48, 48
    s_min_u32 s32, s32, s33
    s_sub_u32 s50, s34, s32
    s_sub_u32 s34, s50, 1
    s_nop 0
    v_sub_u32 v48, s34, v16
    v_sub_u32 v49, s34, v17
    v_sub_u32 v50, s34, v18
    v_sub_u32 v51, s34, v19
    v_sub_u32 v52, s34, v20
    v_sub_u32 v53, s34, v21
    v_sub_u32 v54, s34, v22
    v_sub_u32 v55, s34, v23
    v_sub_u32 v56, s34, v24
    v_sub_u32 v57, s34, v25
    v_sub_u32 v58, s34, v26
    v_sub_u32 v59, s34, v27
    v_sub_u32 v60, s34, v28
    v_sub_u32 v61, s34, v29
    v_sub_u32 v62, s34, v30
    v_sub_u32 v63, s34, v31
    v_sub_u32 v64, s34, v32
    v_sub_u32 v65, s34, v33
    v_sub_u32 v66, s34, v34
    v_sub_u32 v67, s34, v35
    v_sub_u32 v68, s34, v36
    v_sub_u32 v69, s34, v37
    v_sub_u32 v70, s34, v38
    v_sub_u32 v71, s34, v39
    v_sub_u32 v72, s34, v40
    v_sub_u32 v73, s34, v41
    v_sub_u32 v74, s34, v42
    v_sub_u32 v75, s34, v43
    v_sub_u32 v76, s34, v44
    v_sub_u32 v77, s34, v45
    v_sub_u32 v78, s34, v46
    v_sub_u32 v79, s34, v47
    v_min3_u32 v48, v48, v49, v50
    v_min3_u32 v48, v48, v51, v52
    v_min3_u32 v48, v48, v53, v54
    v_min3_u32 v48, v48, v55, v56
    v_min3_u32 v48, v48, v57, v58
    v_min3_u32 v48, v48, v59, v60
    v_min3_u32 v48, v48, v61, v62
    v_min3_u32 v48, v48, v63, v64
    v_min3_u32 v48, v48, v65, v66
    v_min3_u32 v48, v48, v67, v68
    v_min3_u32 v48, v48, v69, v70
    v_min3_u32 v48, v48, v71, v72
    v_min3_u32 v48, v48, v73, v74
    v_min3_u32 v48, v48, v75, v76
    v_min3_u32 v48, v48, v77, v78
    v_min_u32 v48, v48, v79
    s_nop 1
    v_min_u32_dpp v48, v48, v48 quad_perm:[1,0,3,2] row_mask:0xf bank_mask:0xf
    s_nop 1
    v_min_u32_dpp v48, v48, v48 quad_perm:[2,3,0,1] row_mask:0xf bank_mask:0xf
    s_nop 1
    v_min_u32_dpp v48, v48, v48 row_half_mirror row_mask:0xf bank_mask:0xf
    s_nop 1
    v_min_u32_dpp v48, v48, v48 row_mirror row_mask:0xf bank_mask:0xf
    s_nop 0
    v_readlane_b32 s32, v48, 0
    v_readlane_b32 s33, v48, 16
    s_min_u32 s32, s32, s33
    v_readlane_b32 s33, v48, 32
    s_min_u32 s32, s32, s33
    v_readlane_b32 s33, v48, 48
    s_min_u32 s32, s32, s33
    s_sub_u32 s51, s34, s32
    s_sub_u32 s34, s51, 1
    s_nop 0
    v_and_b32 v9, 7, v1
    v_mov_b32 v8, s44
    v_cmp_eq_u32 vcc, 1, v9
    v_mov_b32 v10, s45
    s_nop 0
    v_cndmask_b32 v8, v8, v10, vcc
    v_cmp_eq_u32 vcc, 2, v9
    v_mov_b32 v10, s46
    s_nop 0
    v_cndmask_b32 v8, v8, v10, vcc
    v_cmp_eq_u32 vcc, 3, v9
    v_mov_b32 v10, s47
    s_nop 0
    v_cndmask_b32 v8, v8, v10, vcc
    v_cmp_eq_u32 vcc, 4, v9
    v_mov_b32 v10, s48
    s_nop 0
    v_cndmask_b32 v8, v8, v10, vcc
    v_cmp_eq_u32 vcc, 5, v9
    v_mov_b32 v10, s49
    s_nop 0
    v_cndmask_b32 v8, v8, v10, vcc
    v_cmp_eq_u32 vcc, 6, v9
    v_mov_b32 v10, s50
    s_nop 0
    v_cndmask_b32 v8, v8, v10, vcc
    v_cmp_eq_u32 vcc, 7, v9
    v_mov_b32 v10, s51
    s_nop 0
    v_cndmask_b32 v8, v8, v10, vcc
    v_and_b32 v8, 0x7ff, v8
    v_sub_u32 v8, 2047, v8
    v_mul_u32_u24 v8, 1280, v8
    v_lshrrev_b32 v10, 4, v1
    v_lshlrev_b32 v10, 4, v10
    v_add_u32 v8, v8, v10
    buffer_load_dwordx4 v[16:19], v8, s[16:19], 0 offen offset:0
    buffer_load_dwordx4 v[20:23], v8, s[16:19], 0 offen offset:64
    buffer_load_dwordx4 v[24:27], v8, s[16:19], 0 offen offset:128
    buffer_load_dwordx4 v[28:31], v8, s[16:19], 0 offen offset:192
    buffer_load_dwordx4 v[32:35], v8, s[16:19], 0 offen offset:256
    buffer_load_dwordx4 v[36:39], v8, s[16:19], 0 offen offset:320
    buffer_load_dwordx4 v[40:43], v8, s[16:19], 0 offen offset:384
    buffer_load_dwordx4 v[44:47], v8, s[16:19], 0 offen offset:448
    buffer_load_dwordx4 v[48:51], v8, s[16:19], 0 offen offset:512
    buffer_load_dwordx4 v[52:55], v8, s[16:19], 0 offen offset:576
    buffer_load_dwordx4 v[56:59], v8, s[16:19], 0 offen offset:640
    buffer_load_dwordx4 v[60:63], v8, s[16:19], 0 offen offset:704
    buffer_load_dwordx4 v[64:67], v8, s[16:19], 0 offen offset:768
    buffer_load_dwordx4 v[68:71], v8, s[16:19], 0 offen offset:832
    buffer_load_dwordx4 v[72:75], v8, s[16:19], 0 offen offset:896
    buffer_load_dwordx4 v[76:79], v8, s[16:19], 0 offen offset:960
    buffer_load_dwordx4 v[80:83], v8, s[16:19], 0 offen offset:1024
    buffer_load_dwordx4 v[84:87], v8, s[16:19], 0 offen offset:1088
    buffer_load_dwordx4 v[88:91], v8, s[16:19], 0 offen offset:1152
    buffer_load_dwordx4 v[92:95], v8, s[16:19], 0 offen offset:1216
    s_cmp_ge_u32 s14, 20
    s_cbranch_scc1 nowd2_118
    ds_read_b64_tr_b16 a[160:161], v7 offset:0
    ds_read_b64_tr_b16 a[162:163], v7 offset:256
    ds_read_b64_tr_b16 a[164:165], v7 offset:2048
    ds_read_b64_tr_b16 a[166:167], v7 offset:2304
    ds_read_b64_tr_b16 a[168:169], v7 offset:4096
    ds_read_b64_tr_b16 a[170:171], v7 offset:4352
    ds_read_b64_tr_b16 a[172:173], v7 offset:6144
    ds_read_b64_tr_b16 a[174:175], v7 offset:6400
    s_waitcnt lgkmcnt(0)
    ds_read_b64_tr_b16 a[176:177], v7 offset:8192
    ds_read_b64_tr_b16 a[178:179], v7 offset:8448
    ds_read_b64_tr_b16 a[180:181], v7 offset:10240
    ds_read_b64_tr_b16 a[182:183], v7 offset:10496
    ds_read_b64_tr_b16 a[184:185], v7 offset:12288
    ds_read_b64_tr_b16 a[186:187], v7 offset:12544
    ds_read_b64_tr_b16 a[188:189], v7 offset:14336
    ds_read_b64_tr_b16 a[190:191], v7 offset:14592
    s_waitcnt lgkmcnt(0)
    ds_read_b64_tr_b16 a[192:193], v7 offset:16384
    ds_read_b64_tr_b16 a[194:195], v7 offset:16640
    ds_read_b64_tr_b16 a[196:197], v7 offset:18432
    ds_read_b64_tr_b16 a[198:199], v7 offset:18688
    ds_read_b64_tr_b16 a[200:201], v7 offset:20480
    ds_read_b64_tr_b16 a[202:203], v7 offset:20736
    ds_read_b64_tr_b16 a[204:205], v7 offset:22528
    ds_read_b64_tr_b16 a[206:207], v7 offset:22784
    s_waitcnt lgkmcnt(0)
    ds_read_b64_tr_b16 a[208:209], v7 offset:24576
    ds_read_b64_tr_b16 a[210:211], v7 offset:24832
    ds_read_b64_tr_b16 a[212:213], v7 offset:26624
    ds_read_b64_tr_b16 a[214:215], v7 offset:26880
    ds_read_b64_tr_b16 a[216:217], v7 offset:28672
    ds_read_b64_tr_b16 a[218:219], v7 offset:28928
    ds_read_b64_tr_b16 a[220:221], v7 offset:30720
    ds_read_b64_tr_b16 a[222:223], v7 offset:30976
    s_waitcnt lgkmcnt(0)
    ds_read_b64_tr_b16 a[224:225], v7 offset:32768
    ds_read_b64_tr_b16 a[226:227], v7 offset:33024
    ds_read_b64_tr_b16 a[228:229], v7 offset:34816
    ds_read_b64_tr_b16 a[230:231], v7 offset:35072
    ds_read_b64_tr_b16 a[232:233], v7 offset:36864
    ds_read_b64_tr_b16 a[234:235], v7 offset:37120
    ds_read_b64_tr_b16 a[236:237], v7 offset:38912
    ds_read_b64_tr_b16 a[238:239], v7 offset:39168
    s_waitcnt lgkmcnt(0)
    ds_read_b64_tr_b16 a[240:241], v7 offset:40960
    ds_read_b64_tr_b16 a[242:243], v7 offset:41216
    ds_read_b64_tr_b16 a[244:245], v7 offset:43008
    ds_read_b64_tr_b16 a[246:247], v7 offset:43264
    ds_read_b64_tr_b16 a[248:249], v7 offset:45056
    ds_read_b64_tr_b16 a[250:251], v7 offset:45312
    ds_read_b64_tr_b16 a[252:253], v7 offset:47104
    ds_read_b64_tr_b16 a[254:255], v7 offset:47360
    s_waitcnt lgkmcnt(0)
nowd2_118:
    s_waitcnt vmcnt(0)
    v_mfma_f32_16x16x32_bf16 v[96:99], v[16:19], a[0:3], 0
    v_mfma_f32_16x16x32_bf16 v[100:103], v[16:19], a[80:83], 0
    v_mfma_f32_16x16x32_bf16 v[96:99], v[20:23], a[4:7], v[96:99]
    v_mfma_f32_16x16x32_bf16 v[100:103], v[20:23], a[84:87], v[100:103]
    v_mfma_f32_16x16x32_bf16 v[96:99], v[24:27], a[8:11], v[96:99]
    v_mfma_f32_16x16x32_bf16 v[100:103], v[24:27], a[88:91], v[100:103]
    v_mfma_f32_16x16x32_bf16 v[96:99], v[28:31], a[12:15], v[96:99]
    v_mfma_f32_16x16x32_bf16 v[100:103], v[28:31], a[92:95], v[100:103]
    v_mfma_f32_16x16x32_bf16 v[96:99], v[32:35], a[16:19], v[96:99]
    v_mfma_f32_16x16x32_bf16 v[100:103], v[32:35], a[96:99], v[100:103]
    v_mfma_f32_16x16x32_bf16 v[96:99], v[36:39], a[20:23], v[96:99]
    v_mfma_f32_16x16x32_bf16 v[100:103], v[36:39], a[100:103], v[100:103]
    v_mfma_f32_16x16x32_bf16 v[96:99], v[40:43], a[24:27], v[96:99]
    v_mfma_f32_16x16x32_bf16 v[100:103], v[40:43], a[104:107], v[100:103]
    v_mfma_f32_16x16x32_bf16 v[96:99], v[44:47], a[28:31], v[96:99]
    v_mfma_f32_16x16x32_bf16 v[100:103], v[44:47], a[108:111], v[100:103]
    v_mfma_f32_16x16x32_bf16 v[96:99], v[48:51], a[32:35], v[96:99]
    v_mfma_f32_16x16x32_bf16 v[100:103], v[48:51], a[112:115], v[100:103]
    v_mfma_f32_16x16x32_bf16 v[96:99], v[52:55], a[36:39], v[96:99]
    v_mfma_f32_16x16x32_bf16 v[100:103], v[52:55], a[116:119], v[100:103]
    v_mfma_f32_16x16x32_bf16 v[96:99], v[56:59], a[40:43], v[96:99]
    v_mfma_f32_16x16x32_bf16 v[100:103], v[56:59], a[120:123], v[100:103]
    v_mfma_f32_16x16x32_bf16 v[96:99], v[60:63], a[44:47], v[96:99]
    v_mfma_f32_16x16x32_bf16 v[100:103], v[60:63], a[124:127], v[100:103]
    v_mfma_f32_16x16x32_bf16 v[96:99], v[64:67], a[48:51], v[96:99]
    v_mfma_f32_16x16x32_bf16 v[100:103], v[64:67], a[128:131], v[100:103]
    v_mfma_f32_16x16x32_bf16 v[96:99], v[68:71], a[52:55], v[96:99]
    v_mfma_f32_16x16x32_bf16 v[100:103], v[68:71], a[132:135], v[100:103]
    v_mfma_f32_16x16x32_bf16 v[96:99], v[72:75], a[56:59], v[96:99]
    v_mfma_f32_16x16x32_bf16 v[100:103], v[72:75], a[136:139], v[100:103]
    v_mfma_f32_16x16x32_bf16 v[96:99], v[76:79], a[60:63], v[96:99]
    v_mfma_f32_16x16x32_bf16 v[100:103], v[76:79], a[140:143], v[100:103]
    v_mfma_f32_16x16x32_bf16 v[96:99], v[80:83], a[64:67], v[96:99]
    v_mfma_f32_16x16x32_bf16 v[100:103], v[80:83], a[144:147], v[100:103]
    v_mfma_f32_16x16x32_bf16 v[96:99], v[84:87], a[68:71], v[96:99]
    v_mfma_f32_16x16x32_bf16 v[100:103], v[84:87], a[148:151], v[100:103]
    v_mfma_f32_16x16x32_bf16 v[96:99], v[88:91], a[72:75], v[96:99]
    v_mfma_f32_16x16x32_bf16 v[100:103], v[88:91], a[152:155], v[100:103]
    v_mfma_f32_16x16x32_bf16 v[96:99], v[92:95], a[76:79], v[96:99]
    v_mfma_f32_16x16x32_bf16 v[100:103], v[92:95], a[156:159], v[100:103]
    v_bfe_u32 v9, v1, 4, 1
    v_mul_u32_u24 v9, 12288, v9
    v_and_b32 v10, 15, v1
    v_lshlrev_b32 v10, 1, v10
    v_add_u32 v9, v9, v10
    s_lshl_b32 s32, s14, 7
    s_lshl_b32 s33, s12, 5
    s_add_u32 s32, s32, s33
    s_add_u32 s37, s32, 2129920
    v_cvt_pk_bf16_f32 v104, v96, v96
    v_and_b32 v104, 0xffff0000, v104
    v_mul_f32 v105, s40, v104
    v_exp_f32 v105, v105
    s_nop 0
    v_add_f32 v105, 1.0, v105
    v_rcp_f32 v105, v105
    s_nop 0
    v_mul_f32 v104, v104, v105
    v_cvt_pk_bf16_f32 v104, v104, v104
    v_and_b32 v104, 0xffff0000, v104
    v_cvt_pk_bf16_f32 v105, v100, v100
    v_and_b32 v105, 0xffff0000, v105
    v_mul_f32 v104, v104, v105
    v_cvt_pk_bf16_f32 v108, v104, v104
    v_cvt_pk_bf16_f32 v104, v97, v97
    v_and_b32 v104, 0xffff0000, v104
    v_mul_f32 v105, s40, v104
    v_exp_f32 v105, v105
    s_nop 0
    v_add_f32 v105, 1.0, v105
    v_rcp_f32 v105, v105
    s_nop 0
    v_mul_f32 v104, v104, v105
    v_cvt_pk_bf16_f32 v104, v104, v104
    v_and_b32 v104, 0xffff0000, v104
    v_cvt_pk_bf16_f32 v105, v101, v101
    v_and_b32 v105, 0xffff0000, v105
    v_mul_f32 v104, v104, v105
    v_cvt_pk_bf16_f32 v109, v104, v104
    v_cvt_pk_bf16_f32 v104, v98, v98
    v_and_b32 v104, 0xffff0000, v104
    v_mul_f32 v105, s40, v104
    v_exp_f32 v105, v105
    s_nop 0
    v_add_f32 v105, 1.0, v105
    v_rcp_f32 v105, v105
    s_nop 0
    v_mul_f32 v104, v104, v105
    v_cvt_pk_bf16_f32 v104, v104, v104
    v_and_b32 v104, 0xffff0000, v104
    v_cvt_pk_bf16_f32 v105, v102, v102
    v_and_b32 v105, 0xffff0000, v105
    v_mul_f32 v104, v104, v105
    v_cvt_pk_bf16_f32 v110, v104, v104
    v_cvt_pk_bf16_f32 v104, v99, v99
    v_and_b32 v104, 0xffff0000, v104
    v_mul_f32 v105, s40, v104
    v_exp_f32 v105, v105
    s_nop 0
    v_add_f32 v105, 1.0, v105
    v_rcp_f32 v105, v105
    s_nop 0
    v_mul_f32 v104, v104, v105
    v_cvt_pk_bf16_f32 v104, v104, v104
    v_and_b32 v104, 0xffff0000, v104
    v_cvt_pk_bf16_f32 v105, v103, v103
    v_and_b32 v105, 0xffff0000, v105
    v_mul_f32 v104, v104, v105
    v_cvt_pk_bf16_f32 v111, v104, v104
    s_mov_b32 exec_hi, 0
    buffer_store_short v108, v9, s[4:7], s37 offen sc1
    s_add_u32 s37, s37, 3072
    buffer_store_short v109, v9, s[4:7], s37 offen sc1
    s_add_u32 s37, s37, 3072
    buffer_store_short v110, v9, s[4:7], s37 offen sc1
    s_add_u32 s37, s37, 3072
    buffer_store_short v111, v9, s[4:7], s37 offen sc1
    s_add_u32 s37, s37, 3072
    s_mov_b64 exec, -1
    s_waitcnt vmcnt(0)
    s_barrier
    s_cmp_lg_u32 s12, 0
    s_cbranch_scc1 ds_119
    v_mov_b32 v3, 140
    v_mov_b32 v2, 1
    s_mov_b64 exec, 1
    buffer_atomic_add v2, v3, s[8:11], 0 offen sc1
    s_mov_b64 exec, -1
ds_119:
    s_cmp_lg_u32 s14, 23
    s_cbranch_scc1 noagg_120
    s_cmp_lg_u32 s12, 0
    s_cbranch_scc1 noagg_120
    v_lshlrev_b32 v4, 7, v1
    v_add_u32 v4, 2162688, v4
    v_add_u32 v5, 0x2000, v4
    v_mov_b32 v8, 2179200
    v_mov_b32 v10, 136
    s_mov_b32 s39, 0
agg_121:
    buffer_load_dword v6, v4, s[4:7], 0 offen sc1
    buffer_load_dword v7, v5, s[4:7], 0 offen sc1
    buffer_load_dword v9, v10, s[8:11], 0 offen sc1
    s_waitcnt vmcnt(0)
    v_min_u32_dpp v6, v6, v6 quad_perm:[1,0,3,2] row_mask:0xf bank_mask:0xf
    v_min_u32_dpp v7, v7, v7 quad_perm:[1,0,3,2] row_mask:0xf bank_mask:0xf
    s_nop 0
    v_min_u32_dpp v6, v6, v6 quad_perm:[2,3,0,1] row_mask:0xf bank_mask:0xf
    v_min_u32_dpp v7, v7, v7 quad_perm:[2,3,0,1] row_mask:0xf bank_mask:0xf
    s_nop 0
    v_min_u32_dpp v6, v6, v6 row_half_mirror row_mask:0xf bank_mask:0xf
    v_min_u32_dpp v7, v7, v7 row_half_mirror row_mask:0xf bank_mask:0xf
    s_nop 0
    v_min_u32_dpp v6, v6, v6 row_mirror row_mask:0xf bank_mask:0xf
    v_min_u32_dpp v7, v7, v7 row_mirror row_mask:0xf bank_mask:0xf
    s_nop 0
    v_readlane_b32 s34, v6, 0
    v_readlane_b32 s33, v6, 16
    s_min_u32 s34, s34, s33
    v_readlane_b32 s33, v6, 32
    s_min_u32 s34, s34, s33
    v_readlane_b32 s33, v6, 48
    s_min_u32 s34, s34, s33
    v_readlane_b32 s35, v7, 0
    v_readlane_b32 s33, v7, 16
    s_min_u32 s35, s35, s33
    v_readlane_b32 s33, v7, 32
    s_min_u32 s35, s35, s33
    v_readlane_b32 s33, v7, 48
    s_min_u32 s35, s35, s33
    v_mov_b32 v6, s34
    v_mov_b32 v7, s35
    s_mov_b64 exec, 1
    buffer_store_dwordx2 v[6:7], v8, s[4:7], 0 offen sc1
    s_mov_b64 exec, -1
    s_min_u32 s34, s34, s35
    s_cmp_ge_u32 s34, 64
    s_cbranch_scc1 noagg_120
    v_readfirstlane_b32 s34, v9
    s_cmp_ge_u32 s34, 1000
    s_cbranch_scc1 noagg_120
    s_sleep 20
    s_add_u32 s39, s39, 1
    s_cmp_lt_u32 s39, 20000
    s_cbranch_scc1 agg_121
noagg_120:
    s_cmp_ge_u32 s14, 20
    s_cbranch_scc1 L_o
    v_bfe_u32 v9, v1, 4, 1
    v_cmp_eq_u32 vcc, 1, v9
    v_mov_b32 v120, s44
    v_mov_b32 v10, s48
    v_cndmask_b32 v120, v120, v10, vcc
    v_mov_b32 v121, s45
    v_mov_b32 v10, s49
    v_cndmask_b32 v121, v121, v10, vcc
    v_mov_b32 v122, s46
    v_mov_b32 v10, s50
    v_cndmask_b32 v122, v122, v10, vcc
    v_mov_b32 v123, s47
    v_mov_b32 v10, s51
    v_cndmask_b32 v123, v123, v10, vcc
    s_lshl_b32 s32, s14, 6
    s_and_b32 s33, s12, 1
    s_lshl_b32 s33, s33, 5
    s_add_u32 s35, s32, s33
    v_and_b32 v10, 15, v1
    v_lshlrev_b32 v10, 1, v10
    v_and_b32 v124, 0x7ff, v120
    v_sub_u32 v124, 2047, v124
    v_mul_u32_u24 v11, 1280, v124
    v_add_u32 v11, v11, v10
    buffer_load_ushort v128, v11, s[16:19], s35 offen
    v_lshlrev_b32 v11, 2, v124
    v_add_u32 v11, 2101248, v11
    buffer_load_dword v132, v11, s[4:7], 0 offen sc1
    v_and_b32 v120, 0xffff0000, v120
    v_not_b32 v11, v120
    v_ashrrev_i32 v11, 31, v11
    v_or_b32 v11, 0x80000000, v11
    v_xor_b32 v120, v120, v11
    v_and_b32 v120, 0xffff0000, v120
    v_mul_f32 v120, s40, v120
    v_exp_f32 v120, v120
    s_nop 0
    v_add_f32 v120, 1.0, v120
    v_rcp_f32 v120, v120
    s_nop 0
    v_cvt_pk_bf16_f32 v120, v120, v120
    v_and_b32 v120, 0xffff0000, v120
    v_and_b32 v125, 0x7ff, v121
    v_sub_u32 v125, 2047, v125
    v_mul_u32_u24 v11, 1280, v125
    v_add_u32 v11, v11, v10
    buffer_load_ushort v129, v11, s[16:19], s35 offen
    v_lshlrev_b32 v11, 2, v125
    v_add_u32 v11, 2101248, v11
    buffer_load_dword v133, v11, s[4:7], 0 offen sc1
    v_and_b32 v121, 0xffff0000, v121
    v_not_b32 v11, v121
    v_ashrrev_i32 v11, 31, v11
    v_or_b32 v11, 0x80000000, v11
    v_xor_b32 v121, v121, v11
    v_and_b32 v121, 0xffff0000, v121
    v_mul_f32 v121, s40, v121
    v_exp_f32 v121, v121
    s_nop 0
    v_add_f32 v121, 1.0, v121
    v_rcp_f32 v121, v121
    s_nop 0
    v_cvt_pk_bf16_f32 v121, v121, v121
    v_and_b32 v121, 0xffff0000, v121
    v_and_b32 v126, 0x7ff, v122
    v_sub_u32 v126, 2047, v126
    v_mul_u32_u24 v11, 1280, v126
    v_add_u32 v11, v11, v10
    buffer_load_ushort v130, v11, s[16:19], s35 offen
    v_lshlrev_b32 v11, 2, v126
    v_add_u32 v11, 2101248, v11
    buffer_load_dword v134, v11, s[4:7], 0 offen sc1
    v_and_b32 v122, 0xffff0000, v122
    v_not_b32 v11, v122
    v_ashrrev_i32 v11, 31, v11
    v_or_b32 v11, 0x80000000, v11
    v_xor_b32 v122, v122, v11
    v_and_b32 v122, 0xffff0000, v122
    v_mul_f32 v122, s40, v122
    v_exp_f32 v122, v122
    s_nop 0
    v_add_f32 v122, 1.0, v122
    v_rcp_f32 v122, v122
    s_nop 0
    v_cvt_pk_bf16_f32 v122, v122, v122
    v_and_b32 v122, 0xffff0000, v122
    v_and_b32 v127, 0x7ff, v123
    v_sub_u32 v127, 2047, v127
    v_mul_u32_u24 v11, 1280, v127
    v_add_u32 v11, v11, v10
    buffer_load_ushort v131, v11, s[16:19], s35 offen
    v_lshlrev_b32 v11, 2, v127
    v_add_u32 v11, 2101248, v11
    buffer_load_dword v135, v11, s[4:7], 0 offen sc1
    v_and_b32 v123, 0xffff0000, v123
    v_not_b32 v11, v123
    v_ashrrev_i32 v11, 31, v11
    v_or_b32 v11, 0x80000000, v11
    v_xor_b32 v123, v123, v11
    v_and_b32 v123, 0xffff0000, v123
    v_mul_f32 v123, s40, v123
    v_exp_f32 v123, v123
    s_nop 0
    v_add_f32 v123, 1.0, v123
    v_rcp_f32 v123, v123
    s_nop 0
    v_cvt_pk_bf16_f32 v123, v123, v123
    v_and_b32 v123, 0xffff0000, v123
    s_cmp_lg_u32 s12, 0
    s_cbranch_scc1 dwo_123
    v_mov_b32 v3, 140
    s_mov_b32 s39, 0
dw_122:
    buffer_load_dword v2, v3, s[8:11], 0 offen sc1
    s_waitcnt vmcnt(0)
    v_readfirstlane_b32 s32, v2
    s_cmp_ge_u32 s32, 24
    s_cbranch_scc1 dwo_123
    s_sleep 4
    s_add_u32 s39, s39, 1
    s_cmp_lt_u32 s39, 20000
    s_cbranch_scc1 dw_122
    s_branch L_end3
dwo_123:
    s_barrier
    v_and_b32 v9, 7, v1
    v_mul_u32_u24 v9, 3072, v9
    v_lshrrev_b32 v11, 4, v1
    v_lshlrev_b32 v11, 4, v11
    v_add_u32 v9, v9, v11
    s_lshr_b32 s32, s12, 1
    s_mul_i32 s32, s32, 1536
    s_add_u32 s32, s32, 2129920
    buffer_load_dwordx4 v[16:19], v9, s[4:7], s32 offen offset:0 sc1
    buffer_load_dwordx4 v[20:23], v9, s[4:7], s32 offen offset:64 sc1
    buffer_load_dwordx4 v[24:27], v9, s[4:7], s32 offen offset:128 sc1
    buffer_load_dwordx4 v[28:31], v9, s[4:7], s32 offen offset:192 sc1
    buffer_load_dwordx4 v[32:35], v9, s[4:7], s32 offen offset:256 sc1
    buffer_load_dwordx4 v[36:39], v9, s[4:7], s32 offen offset:320 sc1
    buffer_load_dwordx4 v[40:43], v9, s[4:7], s32 offen offset:384 sc1
    buffer_load_dwordx4 v[44:47], v9, s[4:7], s32 offen offset:448 sc1
    buffer_load_dwordx4 v[48:51], v9, s[4:7], s32 offen offset:512 sc1
    buffer_load_dwordx4 v[52:55], v9, s[4:7], s32 offen offset:576 sc1
    buffer_load_dwordx4 v[56:59], v9, s[4:7], s32 offen offset:640 sc1
    buffer_load_dwordx4 v[60:63], v9, s[4:7], s32 offen offset:704 sc1
    buffer_load_dwordx4 v[64:67], v9, s[4:7], s32 offen offset:768 sc1
    buffer_load_dwordx4 v[68:71], v9, s[4:7], s32 offen offset:832 sc1
    buffer_load_dwordx4 v[72:75], v9, s[4:7], s32 offen offset:896 sc1
    buffer_load_dwordx4 v[76:79], v9, s[4:7], s32 offen offset:960 sc1
    buffer_load_dwordx4 v[80:83], v9, s[4:7], s32 offen offset:1024 sc1
    buffer_load_dwordx4 v[84:87], v9, s[4:7], s32 offen offset:1088 sc1
    buffer_load_dwordx4 v[88:91], v9, s[4:7], s32 offen offset:1152 sc1
    buffer_load_dwordx4 v[92:95], v9, s[4:7], s32 offen offset:1216 sc1
    buffer_load_dwordx4 v[96:99], v9, s[4:7], s32 offen offset:1280 sc1
    buffer_load_dwordx4 v[100:103], v9, s[4:7], s32 offen offset:1344 sc1
    buffer_load_dwordx4 v[104:107], v9, s[4:7], s32 offen offset:1408 sc1
    buffer_load_dwordx4 v[108:111], v9, s[4:7], s32 offen offset:1472 sc1
    s_waitcnt vmcnt(0)
    v_mfma_f32_16x16x32_bf16 v[112:115], v[16:19], a[160:163], 0
    v_mfma_f32_16x16x32_bf16 v[112:115], v[20:23], a[164:167], v[112:115]
    v_mfma_f32_16x16x32_bf16 v[112:115], v[24:27], a[168:171], v[112:115]
    v_mfma_f32_16x16x32_bf16 v[112:115], v[28:31], a[172:175], v[112:115]
    v_mfma_f32_16x16x32_bf16 v[112:115], v[32:35], a[176:179], v[112:115]
    v_mfma_f32_16x16x32_bf16 v[112:115], v[36:39], a[180:183], v[112:115]
    v_mfma_f32_16x16x32_bf16 v[112:115], v[40:43], a[184:187], v[112:115]
    v_mfma_f32_16x16x32_bf16 v[112:115], v[44:47], a[188:191], v[112:115]
    v_mfma_f32_16x16x32_bf16 v[112:115], v[48:51], a[192:195], v[112:115]
    v_mfma_f32_16x16x32_bf16 v[112:115], v[52:55], a[196:199], v[112:115]
    v_mfma_f32_16x16x32_bf16 v[112:115], v[56:59], a[200:203], v[112:115]
    v_mfma_f32_16x16x32_bf16 v[112:115], v[60:63], a[204:207], v[112:115]
    v_mfma_f32_16x16x32_bf16 v[112:115], v[64:67], a[208:211], v[112:115]
    v_mfma_f32_16x16x32_bf16 v[112:115], v[68:71], a[212:215], v[112:115]
    v_mfma_f32_16x16x32_bf16 v[112:115], v[72:75], a[216:219], v[112:115]
    v_mfma_f32_16x16x32_bf16 v[112:115], v[76:79], a[220:223], v[112:115]
    v_mfma_f32_16x16x32_bf16 v[112:115], v[80:83], a[224:227], v[112:115]
    v_mfma_f32_16x16x32_bf16 v[112:115], v[84:87], a[228:231], v[112:115]
    v_mfma_f32_16x16x32_bf16 v[112:115], v[88:91], a[232:235], v[112:115]
    v_mfma_f32_16x16x32_bf16 v[112:115], v[92:95], a[236:239], v[112:115]
    v_mfma_f32_16x16x32_bf16 v[112:115], v[96:99], a[240:243], v[112:115]
    v_mfma_f32_16x16x32_bf16 v[112:115], v[100:103], a[244:247], v[112:115]
    v_mfma_f32_16x16x32_bf16 v[112:115], v[104:107], a[248:251], v[112:115]
    v_mfma_f32_16x16x32_bf16 v[112:115], v[108:111], a[252:255], v[112:115]
    s_and_b32 s32, s12, 1
    s_lshl_b32 s32, s32, 10
    v_lshlrev_b32 v9, 4, v1
    v_add_u32 v9, s32, v9
    s_nop 4
    s_barrier
    s_cmp_lt_u32 s12, 2
    s_cbranch_scc1 L_x4_lo
    ds_write_b128 v9, v[112:115]
    s_waitcnt lgkmcnt(0)
    s_barrier
    s_branch L_x4_sig
L_x4_lo:
    s_barrier
    ds_read_b128 v[116:119], v9
    s_waitcnt lgkmcnt(0)
    s_lshr_b32 s32, s35, 5
    s_lshl_b32 s32, s32, 10
    s_add_u32 s32, s32, 168820736
    s_mov_b32 s33, 40960
    v_add_f32 v112, v112, v116
    v_cvt_pk_bf16_f32 v112, v112, v112
    v_and_b32 v112, 0xffff0000, v112
    v_mul_f32 v112, v112, v120
    v_cvt_pk_bf16_f32 v112, v112, v112
    v_and_b32 v112, 0xffff0000, v112
    v_lshlrev_b32 v128, 16, v128
    v_add_f32 v112, v112, v128
    v_cvt_pk_bf16_f32 v112, v112, v112
    v_and_b32 v112, 0xffff0000, v112
    v_sub_f32 v132, 1.0, v132
    v_cvt_pk_bf16_f32 v132, v132, v132
    v_and_b32 v132, 0xffff0000, v132
    v_mul_f32 v112, v112, v132
    v_cvt_pk_bf16_f32 v112, v112, v112
    v_lshrrev_b32 v11, 5, v124
    v_mul_lo_u32 v11, v11, s33
    v_and_b32 v124, 31, v124
    v_lshlrev_b32 v124, 5, v124
    v_add3_u32 v124, v124, v11, v10
    v_add_f32 v113, v113, v117
    v_cvt_pk_bf16_f32 v113, v113, v113
    v_and_b32 v113, 0xffff0000, v113
    v_mul_f32 v113, v113, v121
    v_cvt_pk_bf16_f32 v113, v113, v113
    v_and_b32 v113, 0xffff0000, v113
    v_lshlrev_b32 v129, 16, v129
    v_add_f32 v113, v113, v129
    v_cvt_pk_bf16_f32 v113, v113, v113
    v_and_b32 v113, 0xffff0000, v113
    v_sub_f32 v133, 1.0, v133
    v_cvt_pk_bf16_f32 v133, v133, v133
    v_and_b32 v133, 0xffff0000, v133
    v_mul_f32 v113, v113, v133
    v_cvt_pk_bf16_f32 v113, v113, v113
    v_lshrrev_b32 v11, 5, v125
    v_mul_lo_u32 v11, v11, s33
    v_and_b32 v125, 31, v125
    v_lshlrev_b32 v125, 5, v125
    v_add3_u32 v125, v125, v11, v10
    v_add_f32 v114, v114, v118
    v_cvt_pk_bf16_f32 v114, v114, v114
    v_and_b32 v114, 0xffff0000, v114
    v_mul_f32 v114, v114, v122
    v_cvt_pk_bf16_f32 v114, v114, v114
    v_and_b32 v114, 0xffff0000, v114
    v_lshlrev_b32 v130, 16, v130
    v_add_f32 v114, v114, v130
    v_cvt_pk_bf16_f32 v114, v114, v114
    v_and_b32 v114, 0xffff0000, v114
    v_sub_f32 v134, 1.0, v134
    v_cvt_pk_bf16_f32 v134, v134, v134
    v_and_b32 v134, 0xffff0000, v134
    v_mul_f32 v114, v114, v134
    v_cvt_pk_bf16_f32 v114, v114, v114
    v_lshrrev_b32 v11, 5, v126
    v_mul_lo_u32 v11, v11, s33
    v_and_b32 v126, 31, v126
    v_lshlrev_b32 v126, 5, v126
    v_add3_u32 v126, v126, v11, v10
    v_add_f32 v115, v115, v119
    v_cvt_pk_bf16_f32 v115, v115, v115
    v_and_b32 v115, 0xffff0000, v115
    v_mul_f32 v115, v115, v123
    v_cvt_pk_bf16_f32 v115, v115, v115
    v_and_b32 v115, 0xffff0000, v115
    v_lshlrev_b32 v131, 16, v131
    v_add_f32 v115, v115, v131
    v_cvt_pk_bf16_f32 v115, v115, v115
    v_and_b32 v115, 0xffff0000, v115
    v_sub_f32 v135, 1.0, v135
    v_cvt_pk_bf16_f32 v135, v135, v135
    v_and_b32 v135, 0xffff0000, v135
    v_mul_f32 v115, v115, v135
    v_cvt_pk_bf16_f32 v115, v115, v115
    v_lshrrev_b32 v11, 5, v127
    v_mul_lo_u32 v11, v11, s33
    v_and_b32 v127, 31, v127
    v_lshlrev_b32 v127, 5, v127
    v_add3_u32 v127, v127, v11, v10
    s_mov_b32 exec_hi, 0
    buffer_store_short v112, v124, s[4:7], s32 offen sc1
    buffer_store_short v113, v125, s[4:7], s32 offen sc1
    buffer_store_short v114, v126, s[4:7], s32 offen sc1
    buffer_store_short v115, v127, s[4:7], s32 offen sc1
    s_mov_b64 exec, -1
L_x4_sig:
    s_waitcnt vmcnt(0)
    s_barrier
    s_cmp_lg_u32 s12, 0
    s_cbranch_scc1 ds_124
    v_mov_b32 v3, 144
    v_mov_b32 v2, 1
    s_mov_b64 exec, 1
    buffer_atomic_add v2, v3, s[8:11], 0 offen sc1
    s_mov_b64 exec, -1
ds_124:
    s_branch L_o
L_end3:
    s_endpgm
L_o:
    s_waitcnt vmcnt(0) lgkmcnt(0)
    s_load_dwordx2 s[20:21], s[0:1], 104
    s_mov_b32 s22, 2621440
    s_mov_b32 s23, 0x20000
    s_mov_b64 exec, -1
    v_lshlrev_b32 v4, 4, v1
    v_lshlrev_b32 v60, 7, v1
    v_add_u32 v12, 2170880, v60
    s_mul_i32 s32, s12, 20480
    v_add_u32 v5, s32, v4
    v_lshrrev_b32 v60, 4, v1
    v_mul_u32_u24 v62, 2560, v60
    v_and_b32 v61, 15, v1
    v_lshlrev_b32 v63, 4, v61
    v_add3_u32 v6, v62, v63, s32
    v_add_u32 v6, 2048, v6
    v_lshlrev_b32 v60, 8, v60
    v_lshlrev_b32 v61, 2, v61
    s_mul_i32 s32, s12, 10240
    v_add3_u32 v7, v60, v61, s32
    v_lshlrev_b32 v8, 3, v0
    v_lshrrev_b32 v60, 3, v0
    v_mul_u32_u24 v61, 1280, v60
    v_and_b32 v62, 7, v0
    v_lshlrev_b32 v62, 2, v62
    v_add_u32 v9, v61, v62
    v_lshlrev_b32 v10, 2, v0
    v_lshlrev_b32 v11, 2, v60
    v_add_u32 v11, 2101248, v11
    s_mov_b32 s42, 0
    s_waitcnt lgkmcnt(0)
    s_and_b32 s32, s13, 63
ost_125:
    s_cmp_eq_u32 s32, 0
    s_cbranch_scc1 oste_126
    s_sleep 20
    s_sub_u32 s32, s32, 1
    s_branch ost_125
oste_126:
    s_cmp_lg_u32 s12, 0
    s_cbranch_scc1 dwo_128
    v_mov_b32 v3, 144
    s_mov_b32 s39, 0
dw_127:
    buffer_load_dword v2, v3, s[8:11], 0 offen sc1
    s_waitcnt vmcnt(0)
    v_readfirstlane_b32 s32, v2
    s_cmp_ge_u32 s32, 20
    s_cbranch_scc1 dwo_128
    s_sleep 32
    s_add_u32 s39, s39, 1
    s_cmp_lt_u32 s39, 20000
    s_cbranch_scc1 dw_127
    s_branch L_oend
dwo_128:
    s_barrier
o_again_133:
    s_cmp_lg_u32 s12, 0
    s_cbranch_scc1 o_t0_132
    v_mov_b32 v2, 8
    v_mov_b32 v14, 1
    s_mov_b64 exec, 1
    buffer_atomic_add v14, v2, s[8:11], 0 offen sc0 sc1
    s_mov_b64 exec, -1
    s_waitcnt vmcnt(0)
o_t0_132:
o_top_129:
    s_add_u32 s42, s42, 1
    s_cmp_gt_u32 s42, 577
    s_cbranch_scc1 L_oend
    s_barrier
    s_cmp_lg_u32 s12, 0
    s_cbranch_scc1 o_tw_130
    s_mov_b64 exec, 1
    v_mov_b32 v2, 0xa000
    ds_write_b32 v2, v14
    s_waitcnt lgkmcnt(0)
    s_mov_b64 exec, -1
o_tw_130:
    s_barrier
    v_mov_b32 v2, 0xa000
    ds_read_b32 v3, v2
    s_waitcnt lgkmcnt(0)
    v_readfirstlane_b32 s40, v3
    s_cmp_ge_u32 s40, 576
    s_cbranch_scc1 L_oend
    s_cmp_ge_u32 s40, 496
    s_cbranch_scc1 o_small_131
    s_lshr_b32 s36, s40, 3
    s_and_b32 s41, s40, 7
    s_mul_i32 s41, s41, 5
    s_cmp_lg_u32 s12, 0
    s_cbranch_scc1 wpo_135
    s_mov_b32 s39, 0
wp_134:
    buffer_load_dword v2, v12, s[4:7], 0 offen sc1
    s_waitcnt vmcnt(0)
    v_cmp_ge_u32 vcc, s36, v2
    s_cbranch_vccz wpo_135
    s_sleep 64
    s_add_u32 s39, s39, 1
    s_cmp_lt_u32 s39, 20000
    s_cbranch_scc1 wp_134
    s_branch L_oend
wpo_135:
    s_barrier
    s_mul_i32 s37, s36, 40
    s_add_u32 s37, s37, s41
    s_lshl_b32 s35, s37, 10
    s_lshl_b32 s37, s37, 15
    s_lshl_b32 s32, s12, 13
    s_add_u32 s37, s37, s32
    s_add_u32 s37, s37, 79691776
    s_add_u32 s32, s37, 0
    buffer_load_dwordx4 a[0:3], v4, s[4:7], s32 offen offset:0 sc1
    buffer_load_dwordx4 a[4:7], v4, s[4:7], s32 offen offset:1024 sc1
    buffer_load_dwordx4 a[8:11], v4, s[4:7], s32 offen offset:2048 sc1
    buffer_load_dwordx4 a[12:15], v4, s[4:7], s32 offen offset:3072 sc1
    s_add_u32 s32, s37, 4096
    buffer_load_dwordx4 a[16:19], v4, s[4:7], s32 offen offset:0 sc1
    buffer_load_dwordx4 a[20:23], v4, s[4:7], s32 offen offset:1024 sc1
    buffer_load_dwordx4 a[24:27], v4, s[4:7], s32 offen offset:2048 sc1
    buffer_load_dwordx4 a[28:31], v4, s[4:7], s32 offen offset:3072 sc1
    s_add_u32 s32, s37, 32768
    buffer_load_dwordx4 a[32:35], v4, s[4:7], s32 offen offset:0 sc1
    buffer_load_dwordx4 a[36:39], v4, s[4:7], s32 offen offset:1024 sc1
    buffer_load_dwordx4 a[40:43], v4, s[4:7], s32 offen offset:2048 sc1
    buffer_load_dwordx4 a[44:47], v4, s[4:7], s32 offen offset:3072 sc1
    s_add_u32 s32, s37, 36864
    buffer_load_dwordx4 a[48:51], v4, s[4:7], s32 offen offset:0 sc1
    buffer_load_dwordx4 a[52:55], v4, s[4:7], s32 offen offset:1024 sc1
    buffer_load_dwordx4 a[56:59], v4, s[4:7], s32 offen offset:2048 sc1
    buffer_load_dwordx4 a[60:63], v4, s[4:7], s32 offen offset:3072 sc1
    s_add_u32 s32, s37, 65536
    buffer_load_dwordx4 a[64:67], v4, s[4:7], s32 offen offset:0 sc1
    buffer_load_dwordx4 a[68:71], v4, s[4:7], s32 offen offset:1024 sc1
    buffer_load_dwordx4 a[72:75], v4, s[4:7], s32 offen offset:2048 sc1
    buffer_load_dwordx4 a[76:79], v4, s[4:7], s32 offen offset:3072 sc1
    s_add_u32 s32, s37, 69632
    buffer_load_dwordx4 a[80:83], v4, s[4:7], s32 offen offset:0 sc1
    buffer_load_dwordx4 a[84:87], v4, s[4:7], s32 offen offset:1024 sc1
    buffer_load_dwordx4 a[88:91], v4, s[4:7], s32 offen offset:2048 sc1
    buffer_load_dwordx4 a[92:95], v4, s[4:7], s32 offen offset:3072 sc1
    s_add_u32 s32, s37, 98304
    buffer_load_dwordx4 a[96:99], v4, s[4:7], s32 offen offset:0 sc1
    buffer_load_dwordx4 a[100:103], v4, s[4:7], s32 offen offset:1024 sc1
    buffer_load_dwordx4 a[104:107], v4, s[4:7], s32 offen offset:2048 sc1
    buffer_load_dwordx4 a[108:111], v4, s[4:7], s32 offen offset:3072 sc1
    s_add_u32 s32, s37, 102400
    buffer_load_dwordx4 a[112:115], v4, s[4:7], s32 offen offset:0 sc1
    buffer_load_dwordx4 a[116:119], v4, s[4:7], s32 offen offset:1024 sc1
    buffer_load_dwordx4 a[120:123], v4, s[4:7], s32 offen offset:2048 sc1
    buffer_load_dwordx4 a[124:127], v4, s[4:7], s32 offen offset:3072 sc1
    s_add_u32 s32, s37, 131072
    buffer_load_dwordx4 a[128:131], v4, s[4:7], s32 offen offset:0 sc1
    buffer_load_dwordx4 a[132:135], v4, s[4:7], s32 offen offset:1024 sc1
    buffer_load_dwordx4 a[136:139], v4, s[4:7], s32 offen offset:2048 sc1
    buffer_load_dwordx4 a[140:143], v4, s[4:7], s32 offen offset:3072 sc1
    s_add_u32 s32, s37, 135168
    buffer_load_dwordx4 a[144:147], v4, s[4:7], s32 offen offset:0 sc1
    buffer_load_dwordx4 a[148:151], v4, s[4:7], s32 offen offset:1024 sc1
    buffer_load_dwordx4 a[152:155], v4, s[4:7], s32 offen offset:2048 sc1
    buffer_load_dwordx4 a[156:159], v4, s[4:7], s32 offen offset:3072 sc1
    s_add_u32 s35, s35, 168820736
    s_add_u32 s32, s35, 0
    buffer_load_dword v16, v10, s[4:7], s32 offen offset:0 sc1
    buffer_load_dword v17, v10, s[4:7], s32 offen offset:1024 sc1
    buffer_load_dword v18, v10, s[4:7], s32 offen offset:2048 sc1
    buffer_load_dword v19, v10, s[4:7], s32 offen offset:3072 sc1
    s_add_u32 s32, s35, 4096
    buffer_load_dword v20, v10, s[4:7], s32 offen offset:0 sc1
    s_lshl_b32 s32, s36, 7
    buffer_load_dword v13, v11, s[4:7], s32 offen sc1
    s_cmp_lg_u32 s12, 0
    s_cbranch_scc1 wco_137
    s_mov_b32 s39, 0
    v_mov_b32 v3, 2179072
wc_136:
    buffer_load_dword v2, v3, s[4:7], 0 offen sc1
    s_waitcnt vmcnt(0)
    v_readfirstlane_b32 s32, v2
    s_cmp_gt_u32 s32, s36
    s_cbranch_scc1 wco_137
    s_cmp_eq_u32 s32, 62
    s_cbranch_scc1 wcf_138
    s_add_u32 s32, s32, 1
    s_sleep 12
    s_cmp_ge_u32 s32, s36
    s_cbranch_scc1 wcn_139
    s_sleep 64
wcn_139:
    s_add_u32 s39, s39, 1
    s_cmp_lt_u32 s39, 20000
    s_cbranch_scc1 wc_136
    s_branch L_oend
wcf_138:
    s_mov_b32 s39, 0
    s_mov_b32 s32, 16384
    v_mov_b32 v3, 8
wf_140:
    buffer_load_dword v14, v3, s[8:11], 0 offen sc1
    buffer_load_dword v2, v12, s[4:7], s32 offen sc1
    s_waitcnt vmcnt(0)
    v_cmp_eq_u32 vcc, 0, v2
    s_cbranch_vccz wco_137
    s_sleep 2
    s_add_u32 s39, s39, 1
    s_cmp_lt_u32 s39, 20000
    s_cbranch_scc1 wf_140
    s_branch L_oend
wco_137:
    s_barrier
    s_mul_i32 s37, s36, 81920
    s_add_u32 s37, s37, 163577856
    s_add_u32 s32, s37, 0
    buffer_load_dwordx4 v[104:107], v5, s[4:7], s32 offen offset:0 sc1
    buffer_load_dwordx4 v[108:111], v5, s[4:7], s32 offen offset:1024 sc1
    s_add_u32 s32, s37, 2560
    buffer_load_dwordx4 v[112:115], v5, s[4:7], s32 offen offset:0 sc1
    buffer_load_dwordx4 v[116:119], v5, s[4:7], s32 offen offset:1024 sc1
    s_add_u32 s32, s37, 5120
    buffer_load_dwordx4 v[120:123], v5, s[4:7], s32 offen offset:0 sc1
    buffer_load_dwordx4 v[124:127], v5, s[4:7], s32 offen offset:1024 sc1
    s_add_u32 s32, s37, 7680
    buffer_load_dwordx4 v[128:131], v5, s[4:7], s32 offen offset:0 sc1
    buffer_load_dwordx4 v[132:135], v5, s[4:7], s32 offen offset:1024 sc1
    s_add_u32 s32, s37, 10240
    buffer_load_dwordx4 v[136:139], v5, s[4:7], s32 offen offset:0 sc1
    buffer_load_dwordx4 v[140:143], v5, s[4:7], s32 offen offset:1024 sc1
    s_add_u32 s32, s37, 12800
    buffer_load_dwordx4 v[144:147], v5, s[4:7], s32 offen offset:0 sc1
    buffer_load_dwordx4 v[148:151], v5, s[4:7], s32 offen offset:1024 sc1
    s_add_u32 s32, s37, 15360
    buffer_load_dwordx4 v[152:155], v5, s[4:7], s32 offen offset:0 sc1
    buffer_load_dwordx4 v[156:159], v5, s[4:7], s32 offen offset:1024 sc1
    s_add_u32 s32, s37, 17920
    buffer_load_dwordx4 v[160:163], v5, s[4:7], s32 offen offset:0 sc1
    buffer_load_dwordx4 v[164:167], v5, s[4:7], s32 offen offset:1024 sc1
    s_add_u32 s32, s37, 0
    buffer_load_dwordx4 v[168:171], v6, s[4:7], s32 offen offset:0 sc1
    buffer_load_dwordx4 v[172:175], v6, s[4:7], s32 offen offset:256 sc1
    s_add_u32 s32, s37, 10240
    buffer_load_dwordx4 v[176:179], v6, s[4:7], s32 offen offset:0 sc1
    buffer_load_dwordx4 v[180:183], v6, s[4:7], s32 offen offset:256 sc1
    s_mul_i32 s37, s36, 40
    s_add_u32 s37, s37, s41
    s_lshl_b32 s37, s37, 13
    s_lshl_b32 s32, s12, 11
    s_add_u32 s37, s37, s32
    s_add_u32 s37, s37, 171966464
    s_add_u32 s32, s37, 0
    buffer_load_dwordx4 v[184:187], v4, s[4:7], s32 offen offset:0 sc1
    buffer_load_dwordx4 v[188:191], v4, s[4:7], s32 offen offset:1024 sc1
    s_add_u32 s32, s37, 8192
    buffer_load_dwordx4 v[192:195], v4, s[4:7], s32 offen offset:0 sc1
    buffer_load_dwordx4 v[196:199], v4, s[4:7], s32 offen offset:1024 sc1
    s_add_u32 s32, s37, 16384
    buffer_load_dwordx4 v[200:203], v4, s[4:7], s32 offen offset:0 sc1
    buffer_load_dwordx4 v[204:207], v4, s[4:7], s32 offen offset:1024 sc1
    s_add_u32 s32, s37, 24576
    buffer_load_dwordx4 v[208:211], v4, s[4:7], s32 offen offset:0 sc1
    buffer_load_dwordx4 v[212:215], v4, s[4:7], s32 offen offset:1024 sc1
    s_add_u32 s32, s37, 32768
    buffer_load_dwordx4 v[216:219], v4, s[4:7], s32 offen offset:0 sc1
    buffer_load_dwordx4 v[220:223], v4, s[4:7], s32 offen offset:1024 sc1
    s_waitcnt vmcnt(28)
    v_mfma_f32_16x16x32_bf16 v[64:67], v[104:107], a[0:3], 0
    v_mfma_f32_16x16x32_bf16 v[68:71], v[108:111], a[0:3], 0
    v_mfma_f32_16x16x32_bf16 v[72:75], v[104:107], a[32:35], 0
    v_mfma_f32_16x16x32_bf16 v[76:79], v[108:111], a[32:35], 0
    v_mfma_f32_16x16x32_bf16 v[80:83], v[104:107], a[64:67], 0
    v_mfma_f32_16x16x32_bf16 v[84:87], v[108:111], a[64:67], 0
    v_mfma_f32_16x16x32_bf16 v[88:91], v[104:107], a[96:99], 0
    v_mfma_f32_16x16x32_bf16 v[92:95], v[108:111], a[96:99], 0
    v_mfma_f32_16x16x32_bf16 v[96:99], v[104:107], a[128:131], 0
    v_mfma_f32_16x16x32_bf16 v[100:103], v[108:111], a[128:131], 0
    s_waitcnt vmcnt(26)
    v_mfma_f32_16x16x32_bf16 v[64:67], v[112:115], a[4:7], v[64:67]
    v_mfma_f32_16x16x32_bf16 v[68:71], v[116:119], a[4:7], v[68:71]
    v_mfma_f32_16x16x32_bf16 v[72:75], v[112:115], a[36:39], v[72:75]
    v_mfma_f32_16x16x32_bf16 v[76:79], v[116:119], a[36:39], v[76:79]
    v_mfma_f32_16x16x32_bf16 v[80:83], v[112:115], a[68:71], v[80:83]
    v_mfma_f32_16x16x32_bf16 v[84:87], v[116:119], a[68:71], v[84:87]
    v_mfma_f32_16x16x32_bf16 v[88:91], v[112:115], a[100:103], v[88:91]
    v_mfma_f32_16x16x32_bf16 v[92:95], v[116:119], a[100:103], v[92:95]
    v_mfma_f32_16x16x32_bf16 v[96:99], v[112:115], a[132:135], v[96:99]
    v_mfma_f32_16x16x32_bf16 v[100:103], v[116:119], a[132:135], v[100:103]
    s_waitcnt vmcnt(24)
    v_mfma_f32_16x16x32_bf16 v[64:67], v[120:123], a[8:11], v[64:67]
    v_mfma_f32_16x16x32_bf16 v[68:71], v[124:127], a[8:11], v[68:71]
    v_mfma_f32_16x16x32_bf16 v[72:75], v[120:123], a[40:43], v[72:75]
    v_mfma_f32_16x16x32_bf16 v[76:79], v[124:127], a[40:43], v[76:79]
    v_mfma_f32_16x16x32_bf16 v[80:83], v[120:123], a[72:75], v[80:83]
    v_mfma_f32_16x16x32_bf16 v[84:87], v[124:127], a[72:75], v[84:87]
    v_mfma_f32_16x16x32_bf16 v[88:91], v[120:123], a[104:107], v[88:91]
    v_mfma_f32_16x16x32_bf16 v[92:95], v[124:127], a[104:107], v[92:95]
    v_mfma_f32_16x16x32_bf16 v[96:99], v[120:123], a[136:139], v[96:99]
    v_mfma_f32_16x16x32_bf16 v[100:103], v[124:127], a[136:139], v[100:103]
    s_waitcnt vmcnt(22)
    v_mfma_f32_16x16x32_bf16 v[64:67], v[128:131], a[12:15], v[64:67]
    v_mfma_f32_16x16x32_bf16 v[68:71], v[132:135], a[12:15], v[68:71]
    v_mfma_f32_16x16x32_bf16 v[72:75], v[128:131], a[44:47], v[72:75]
    v_mfma_f32_16x16x32_bf16 v[76:79], v[132:135], a[44:47], v[76:79]
    v_mfma_f32_16x16x32_bf16 v[80:83], v[128:131], a[76:79], v[80:83]
    v_mfma_f32_16x16x32_bf16 v[84:87], v[132:135], a[76:79], v[84:87]
    v_mfma_f32_16x16x32_bf16 v[88:91], v[128:131], a[108:111], v[88:91]
    v_mfma_f32_16x16x32_bf16 v[92:95], v[132:135], a[108:111], v[92:95]
    v_mfma_f32_16x16x32_bf16 v[96:99], v[128:131], a[140:143], v[96:99]
    v_mfma_f32_16x16x32_bf16 v[100:103], v[132:135], a[140:143], v[100:103]
    s_waitcnt vmcnt(20)
    v_mfma_f32_16x16x32_bf16 v[64:67], v[136:139], a[16:19], v[64:67]
    v_mfma_f32_16x16x32_bf16 v[68:71], v[140:143], a[16:19], v[68:71]
    v_mfma_f32_16x16x32_bf16 v[72:75], v[136:139], a[48:51], v[72:75]
    v_mfma_f32_16x16x32_bf16 v[76:79], v[140:143], a[48:51], v[76:79]
    v_mfma_f32_16x16x32_bf16 v[80:83], v[136:139], a[80:83], v[80:83]
    v_mfma_f32_16x16x32_bf16 v[84:87], v[140:143], a[80:83], v[84:87]
    v_mfma_f32_16x16x32_bf16 v[88:91], v[136:139], a[112:115], v[88:91]
    v_mfma_f32_16x16x32_bf16 v[92:95], v[140:143], a[112:115], v[92:95]
    v_mfma_f32_16x16x32_bf16 v[96:99], v[136:139], a[144:147], v[96:99]
    v_mfma_f32_16x16x32_bf16 v[100:103], v[140:143], a[144:147], v[100:103]
    s_waitcnt vmcnt(18)
    v_mfma_f32_16x16x32_bf16 v[64:67], v[144:147], a[20:23], v[64:67]
    v_mfma_f32_16x16x32_bf16 v[68:71], v[148:151], a[20:23], v[68:71]
    v_mfma_f32_16x16x32_bf16 v[72:75], v[144:147], a[52:55], v[72:75]
    v_mfma_f32_16x16x32_bf16 v[76:79], v[148:151], a[52:55], v[76:79]
    v_mfma_f32_16x16x32_bf16 v[80:83], v[144:147], a[84:87], v[80:83]
    v_mfma_f32_16x16x32_bf16 v[84:87], v[148:151], a[84:87], v[84:87]
    v_mfma_f32_16x16x32_bf16 v[88:91], v[144:147], a[116:119], v[88:91]
    v_mfma_f32_16x16x32_bf16 v[92:95], v[148:151], a[116:119], v[92:95]
    v_mfma_f32_16x16x32_bf16 v[96:99], v[144:147], a[148:151], v[96:99]
    v_mfma_f32_16x16x32_bf16 v[100:103], v[148:151], a[148:151], v[100:103]
    s_waitcnt vmcnt(16)
    v_mfma_f32_16x16x32_bf16 v[64:67], v[152:155], a[24:27], v[64:67]
    v_mfma_f32_16x16x32_bf16 v[68:71], v[156:159], a[24:27], v[68:71]
    v_mfma_f32_16x16x32_bf16 v[72:75], v[152:155], a[56:59], v[72:75]
    v_mfma_f32_16x16x32_bf16 v[76:79], v[156:159], a[56:59], v[76:79]
    v_mfma_f32_16x16x32_bf16 v[80:83], v[152:155], a[88:91], v[80:83]
    v_mfma_f32_16x16x32_bf16 v[84:87], v[156:159], a[88:91], v[84:87]
    v_mfma_f32_16x16x32_bf16 v[88:91], v[152:155], a[120:123], v[88:91]
    v_mfma_f32_16x16x32_bf16 v[92:95], v[156:159], a[120:123], v[92:95]
    v_mfma_f32_16x16x32_bf16 v[96:99], v[152:155], a[152:155], v[96:99]
    v_mfma_f32_16x16x32_bf16 v[100:103], v[156:159], a[152:155], v[100:103]
    s_waitcnt vmcnt(14)
    v_mfma_f32_16x16x32_bf16 v[64:67], v[160:163], a[28:31], v[64:67]
    v_mfma_f32_16x16x32_bf16 v[68:71], v[164:167], a[28:31], v[68:71]
    v_mfma_f32_16x16x32_bf16 v[72:75], v[160:163], a[60:63], v[72:75]
    v_mfma_f32_16x16x32_bf16 v[76:79], v[164:167], a[60:63], v[76:79]
    v_mfma_f32_16x16x32_bf16 v[80:83], v[160:163], a[92:95], v[80:83]
    v_mfma_f32_16x16x32_bf16 v[84:87], v[164:167], a[92:95], v[84:87]
    v_mfma_f32_16x16x32_bf16 v[88:91], v[160:163], a[124:127], v[88:91]
    v_mfma_f32_16x16x32_bf16 v[92:95], v[164:167], a[124:127], v[92:95]
    v_mfma_f32_16x16x32_bf16 v[96:99], v[160:163], a[156:159], v[96:99]
    v_mfma_f32_16x16x32_bf16 v[100:103], v[164:167], a[156:159], v[100:103]
    s_waitcnt vmcnt(0)
    v_mfma_f32_16x16x32_bf16 v[64:67], v[168:171], v[184:187], v[64:67]
    v_mfma_f32_16x16x32_bf16 v[68:71], v[172:175], v[184:187], v[68:71]
    v_mfma_f32_16x16x32_bf16 v[72:75], v[168:171], v[192:195], v[72:75]
    v_mfma_f32_16x16x32_bf16 v[76:79], v[172:175], v[192:195], v[76:79]
    v_mfma_f32_16x16x32_bf16 v[80:83], v[168:171], v[200:203], v[80:83]
    v_mfma_f32_16x16x32_bf16 v[84:87], v[172:175], v[200:203], v[84:87]
    v_mfma_f32_16x16x32_bf16 v[88:91], v[168:171], v[208:211], v[88:91]
    v_mfma_f32_16x16x32_bf16 v[92:95], v[172:175], v[208:211], v[92:95]
    v_mfma_f32_16x16x32_bf16 v[96:99], v[168:171], v[216:219], v[96:99]
    v_mfma_f32_16x16x32_bf16 v[100:103], v[172:175], v[216:219], v[100:103]
    v_mfma_f32_16x16x32_bf16 v[64:67], v[176:179], v[188:191], v[64:67]
    v_mfma_f32_16x16x32_bf16 v[68:71], v[180:183], v[188:191], v[68:71]
    v_mfma_f32_16x16x32_bf16 v[72:75], v[176:179], v[196:199], v[72:75]
    v_mfma_f32_16x16x32_bf16 v[76:79], v[180:183], v[196:199], v[76:79]
    v_mfma_f32_16x16x32_bf16 v[80:83], v[176:179], v[204:207], v[80:83]
    v_mfma_f32_16x16x32_bf16 v[84:87], v[180:183], v[204:207], v[84:87]
    v_mfma_f32_16x16x32_bf16 v[88:91], v[176:179], v[212:215], v[88:91]
    v_mfma_f32_16x16x32_bf16 v[92:95], v[180:183], v[212:215], v[92:95]
    v_mfma_f32_16x16x32_bf16 v[96:99], v[176:179], v[220:223], v[96:99]
    v_mfma_f32_16x16x32_bf16 v[100:103], v[180:183], v[220:223], v[100:103]
    ds_write_b32 v7, v64 offset:0
    ds_write_b32 v7, v65 offset:64
    ds_write_b32 v7, v66 offset:128
    ds_write_b32 v7, v67 offset:192
    ds_write_b32 v7, v68 offset:1024
    ds_write_b32 v7, v69 offset:1088
    ds_write_b32 v7, v70 offset:1152
    ds_write_b32 v7, v71 offset:1216
    s_waitcnt lgkmcnt(4)
    ds_write_b32 v7, v72 offset:2048
    ds_write_b32 v7, v73 offset:2112
    ds_write_b32 v7, v74 offset:2176
    ds_write_b32 v7, v75 offset:2240
    ds_write_b32 v7, v76 offset:3072
    ds_write_b32 v7, v77 offset:3136
    ds_write_b32 v7, v78 offset:3200
    ds_write_b32 v7, v79 offset:3264
    s_waitcnt lgkmcnt(4)
    ds_write_b32 v7, v80 offset:4096
    ds_write_b32 v7, v81 offset:4160
    ds_write_b32 v7, v82 offset:4224
    ds_write_b32 v7, v83 offset:4288
    ds_write_b32 v7, v84 offset:5120
    ds_write_b32 v7, v85 offset:5184
    ds_write_b32 v7, v86 offset:5248
    ds_write_b32 v7, v87 offset:5312
    s_waitcnt lgkmcnt(4)
    ds_write_b32 v7, v88 offset:6144
    ds_write_b32 v7, v89 offset:6208
    ds_write_b32 v7, v90 offset:6272
    ds_write_b32 v7, v91 offset:6336
    ds_write_b32 v7, v92 offset:7168
    ds_write_b32 v7, v93 offset:7232
    ds_write_b32 v7, v94 offset:7296
    ds_write_b32 v7, v95 offset:7360
    s_waitcnt lgkmcnt(4)
    ds_write_b32 v7, v96 offset:8192
    ds_write_b32 v7, v97 offset:8256
    ds_write_b32 v7, v98 offset:8320
    ds_write_b32 v7, v99 offset:8384
    ds_write_b32 v7, v100 offset:9216
    ds_write_b32 v7, v101 offset:9280
    ds_write_b32 v7, v102 offset:9344
    ds_write_b32 v7, v103 offset:9408
    s_waitcnt lgkmcnt(4)
    s_waitcnt lgkmcnt(0)
    s_barrier
    s_mul_i32 s32, s36, 40960
    s_lshl_b32 s33, s41, 5
    s_add_u32 s32, s32, s33
    ds_read_b64 v[24:25], v8 offset:0
    ds_read_b64 v[26:27], v8 offset:10240
    ds_read_b64 v[28:29], v8 offset:20480
    ds_read_b64 v[30:31], v8 offset:30720
    ds_read_b64 v[32:33], v8 offset:2048
    ds_read_b64 v[34:35], v8 offset:12288
    ds_read_b64 v[36:37], v8 offset:22528
    ds_read_b64 v[38:39], v8 offset:32768
    ds_read_b64 v[40:41], v8 offset:4096
    ds_read_b64 v[42:43], v8 offset:14336
    ds_read_b64 v[44:45], v8 offset:24576
    ds_read_b64 v[46:47], v8 offset:34816
    s_waitcnt lgkmcnt(4)
    ds_read_b64 v[48:49], v8 offset:6144
    ds_read_b64 v[50:51], v8 offset:16384
    ds_read_b64 v[52:53], v8 offset:26624
    ds_read_b64 v[54:55], v8 offset:36864
    ds_read_b64 v[56:57], v8 offset:8192
    ds_read_b64 v[58:59], v8 offset:18432
    ds_read_b64 v[60:61], v8 offset:28672
    ds_read_b64 v[62:63], v8 offset:38912
    s_waitcnt lgkmcnt(0)
    v_add_f32 v24, v24, v26
    v_add_f32 v25, v25, v27
    v_add_f32 v28, v28, v30
    v_add_f32 v29, v29, v31
    v_add_f32 v24, v24, v28
    v_add_f32 v25, v25, v29
    v_cvt_pk_bf16_f32 v24, v24, v25
    v_and_b32 v25, 0xffff0000, v24
    v_lshlrev_b32 v24, 16, v24
    v_mul_f32 v24, v24, v13
    v_mul_f32 v25, v25, v13
    v_cvt_pk_bf16_f32 v24, v24, v25
    v_lshlrev_b32 v26, 16, v16
    v_and_b32 v27, 0xffff0000, v16
    v_and_b32 v25, 0xffff0000, v24
    v_lshlrev_b32 v24, 16, v24
    v_add_f32 v24, v24, v26
    v_add_f32 v25, v25, v27
    v_cvt_pk_bf16_f32 v24, v24, v25
    buffer_store_dword v24, v9, s[20:23], s32 offen offset:0
    v_add_f32 v32, v32, v34
    v_add_f32 v33, v33, v35
    v_add_f32 v36, v36, v38
    v_add_f32 v37, v37, v39
    v_add_f32 v32, v32, v36
    v_add_f32 v33, v33, v37
    v_cvt_pk_bf16_f32 v32, v32, v33
    v_and_b32 v33, 0xffff0000, v32
    v_lshlrev_b32 v32, 16, v32
    v_mul_f32 v32, v32, v13
    v_mul_f32 v33, v33, v13
    v_cvt_pk_bf16_f32 v32, v32, v33
    v_lshlrev_b32 v34, 16, v17
    v_and_b32 v35, 0xffff0000, v17
    v_and_b32 v33, 0xffff0000, v32
    v_lshlrev_b32 v32, 16, v32
    v_add_f32 v32, v32, v34
    v_add_f32 v33, v33, v35
    v_cvt_pk_bf16_f32 v32, v32, v33
    buffer_store_dword v32, v9, s[20:23], s32 offen offset:32
    v_add_f32 v40, v40, v42
    v_add_f32 v41, v41, v43
    v_add_f32 v44, v44, v46
    v_add_f32 v45, v45, v47
    v_add_f32 v40, v40, v44
    v_add_f32 v41, v41, v45
    v_cvt_pk_bf16_f32 v40, v40, v41
    v_and_b32 v41, 0xffff0000, v40
    v_lshlrev_b32 v40, 16, v40
    v_mul_f32 v40, v40, v13
    v_mul_f32 v41, v41, v13
    v_cvt_pk_bf16_f32 v40, v40, v41
    v_lshlrev_b32 v42, 16, v18
    v_and_b32 v43, 0xffff0000, v18
    v_and_b32 v41, 0xffff0000, v40
    v_lshlrev_b32 v40, 16, v40
    v_add_f32 v40, v40, v42
    v_add_f32 v41, v41, v43
    v_cvt_pk_bf16_f32 v40, v40, v41
    buffer_store_dword v40, v9, s[20:23], s32 offen offset:64
    v_add_f32 v48, v48, v50
    v_add_f32 v49, v49, v51
    v_add_f32 v52, v52, v54
    v_add_f32 v53, v53, v55
    v_add_f32 v48, v48, v52
    v_add_f32 v49, v49, v53
    v_cvt_pk_bf16_f32 v48, v48, v49
    v_and_b32 v49, 0xffff0000, v48
    v_lshlrev_b32 v48, 16, v48
    v_mul_f32 v48, v48, v13
    v_mul_f32 v49, v49, v13
    v_cvt_pk_bf16_f32 v48, v48, v49
    v_lshlrev_b32 v50, 16, v19
    v_and_b32 v51, 0xffff0000, v19
    v_and_b32 v49, 0xffff0000, v48
    v_lshlrev_b32 v48, 16, v48
    v_add_f32 v48, v48, v50
    v_add_f32 v49, v49, v51
    v_cvt_pk_bf16_f32 v48, v48, v49
    buffer_store_dword v48, v9, s[20:23], s32 offen offset:96
    v_add_f32 v56, v56, v58
    v_add_f32 v57, v57, v59
    v_add_f32 v60, v60, v62
    v_add_f32 v61, v61, v63
    v_add_f32 v56, v56, v60
    v_add_f32 v57, v57, v61
    v_cvt_pk_bf16_f32 v56, v56, v57
    v_and_b32 v57, 0xffff0000, v56
    v_lshlrev_b32 v56, 16, v56
    v_mul_f32 v56, v56, v13
    v_mul_f32 v57, v57, v13
    v_cvt_pk_bf16_f32 v56, v56, v57
    v_lshlrev_b32 v58, 16, v20
    v_and_b32 v59, 0xffff0000, v20
    v_and_b32 v57, 0xffff0000, v56
    v_lshlrev_b32 v56, 16, v56
    v_add_f32 v56, v56, v58
    v_add_f32 v57, v57, v59
    v_cvt_pk_bf16_f32 v56, v56, v57
    buffer_store_dword v56, v9, s[20:23], s32 offen offset:128
    s_branch o_again_133
o_small_131:
    s_sub_u32 s41, s40, 496
    s_cmp_ge_u32 s41, 40
    s_cselect_b32 s36, 63, 62
    s_cselect_b32 s32, 40, 0
    s_sub_u32 s41, s41, s32
    s_cmp_lg_u32 s12, 0
    s_cbranch_scc1 wpo_142
    s_mov_b32 s39, 0
wp_141:
    buffer_load_dword v2, v12, s[4:7], 0 offen sc1
    s_waitcnt vmcnt(0)
    v_cmp_ge_u32 vcc, s36, v2
    s_cbranch_vccz wpo_142
    s_sleep 64
    s_add_u32 s39, s39, 1
    s_cmp_lt_u32 s39, 20000
    s_cbranch_scc1 wp_141
    s_branch L_oend
wpo_142:
    s_barrier
    s_mul_i32 s37, s36, 40
    s_add_u32 s37, s37, s41
    s_lshl_b32 s35, s37, 10
    s_lshl_b32 s37, s37, 15
    s_lshl_b32 s32, s12, 13
    s_add_u32 s37, s37, s32
    s_add_u32 s37, s37, 79691776
    s_add_u32 s32, s37, 0
    buffer_load_dwordx4 a[0:3], v4, s[4:7], s32 offen offset:0 sc1
    buffer_load_dwordx4 a[4:7], v4, s[4:7], s32 offen offset:1024 sc1
    buffer_load_dwordx4 a[8:11], v4, s[4:7], s32 offen offset:2048 sc1
    buffer_load_dwordx4 a[12:15], v4, s[4:7], s32 offen offset:3072 sc1
    s_add_u32 s32, s37, 4096
    buffer_load_dwordx4 a[16:19], v4, s[4:7], s32 offen offset:0 sc1
    buffer_load_dwordx4 a[20:23], v4, s[4:7], s32 offen offset:1024 sc1
    buffer_load_dwordx4 a[24:27], v4, s[4:7], s32 offen offset:2048 sc1
    buffer_load_dwordx4 a[28:31], v4, s[4:7], s32 offen offset:3072 sc1
    s_add_u32 s35, s35, 168820736
    s_add_u32 s32, s35, 0
    buffer_load_dword v16, v10, s[4:7], s32 offen offset:0 sc1
    s_lshl_b32 s32, s36, 7
    buffer_load_dword v13, v11, s[4:7], s32 offen sc1
    s_cmp_lg_u32 s12, 0
    s_cbranch_scc1 wco_144
    s_mov_b32 s39, 0
    v_mov_b32 v3, 2179072
wc_143:
    buffer_load_dword v2, v3, s[4:7], 0 offen sc1
    s_waitcnt vmcnt(0)
    v_readfirstlane_b32 s32, v2
    s_cmp_gt_u32 s32, s36
    s_cbranch_scc1 wco_144
    s_cmp_eq_u32 s32, 62
    s_cbranch_scc1 wcf_145
    s_add_u32 s32, s32, 1
    s_sleep 12
    s_cmp_ge_u32 s32, s36
    s_cbranch_scc1 wcn_146
    s_sleep 64
wcn_146:
    s_add_u32 s39, s39, 1
    s_cmp_lt_u32 s39, 20000
    s_cbranch_scc1 wc_143
    s_branch L_oend
wcf_145:
    s_mov_b32 s39, 0
    s_mov_b32 s32, 16384
    v_mov_b32 v3, 8
wf_147:
    buffer_load_dword v14, v3, s[8:11], 0 offen sc1
    buffer_load_dword v2, v12, s[4:7], s32 offen sc1
    s_waitcnt vmcnt(0)
    v_cmp_eq_u32 vcc, 0, v2
    s_cbranch_vccz wco_144
    s_sleep 2
    s_add_u32 s39, s39, 1
    s_cmp_lt_u32 s39, 20000
    s_cbranch_scc1 wf_147
    s_branch L_oend
wco_144:
    s_barrier
    s_mul_i32 s37, s36, 81920
    s_add_u32 s37, s37, 163577856
    s_add_u32 s32, s37, 0
    buffer_load_dwordx4 v[104:107], v5, s[4:7], s32 offen offset:0 sc1
    buffer_load_dwordx4 v[108:111], v5, s[4:7], s32 offen offset:1024 sc1
    s_add_u32 s32, s37, 2560
    buffer_load_dwordx4 v[112:115], v5, s[4:7], s32 offen offset:0 sc1
    buffer_load_dwordx4 v[116:119], v5, s[4:7], s32 offen offset:1024 sc1
    s_add_u32 s32, s37, 5120
    buffer_load_dwordx4 v[120:123], v5, s[4:7], s32 offen offset:0 sc1
    buffer_load_dwordx4 v[124:127], v5, s[4:7], s32 offen offset:1024 sc1
    s_add_u32 s32, s37, 7680
    buffer_load_dwordx4 v[128:131], v5, s[4:7], s32 offen offset:0 sc1
    buffer_load_dwordx4 v[132:135], v5, s[4:7], s32 offen offset:1024 sc1
    s_add_u32 s32, s37, 10240
    buffer_load_dwordx4 v[136:139], v5, s[4:7], s32 offen offset:0 sc1
    buffer_load_dwordx4 v[140:143], v5, s[4:7], s32 offen offset:1024 sc1
    s_add_u32 s32, s37, 12800
    buffer_load_dwordx4 v[144:147], v5, s[4:7], s32 offen offset:0 sc1
    buffer_load_dwordx4 v[148:151], v5, s[4:7], s32 offen offset:1024 sc1
    s_add_u32 s32, s37, 15360
    buffer_load_dwordx4 v[152:155], v5, s[4:7], s32 offen offset:0 sc1
    buffer_load_dwordx4 v[156:159], v5, s[4:7], s32 offen offset:1024 sc1
    s_add_u32 s32, s37, 17920
    buffer_load_dwordx4 v[160:163], v5, s[4:7], s32 offen offset:0 sc1
    buffer_load_dwordx4 v[164:167], v5, s[4:7], s32 offen offset:1024 sc1
    s_add_u32 s32, s37, 0
    buffer_load_dwordx4 v[168:171], v6, s[4:7], s32 offen offset:0 sc1
    buffer_load_dwordx4 v[172:175], v6, s[4:7], s32 offen offset:256 sc1
    s_add_u32 s32, s37, 10240
    buffer_load_dwordx4 v[176:179], v6, s[4:7], s32 offen offset:0 sc1
    buffer_load_dwordx4 v[180:183], v6, s[4:7], s32 offen offset:256 sc1
    s_mul_i32 s37, s36, 40
    s_add_u32 s37, s37, s41
    s_lshl_b32 s37, s37, 13
    s_lshl_b32 s32, s12, 11
    s_add_u32 s37, s37, s32
    s_add_u32 s37, s37, 171966464
    s_add_u32 s32, s37, 0
    buffer_load_dwordx4 v[184:187], v4, s[4:7], s32 offen offset:0 sc1
    buffer_load_dwordx4 v[188:191], v4, s[4:7], s32 offen offset:1024 sc1
    s_waitcnt vmcnt(20)
    v_mfma_f32_16x16x32_bf16 v[64:67], v[104:107], a[0:3], 0
    v_mfma_f32_16x16x32_bf16 v[68:71], v[108:111], a[0:3], 0
    s_waitcnt vmcnt(18)
    v_mfma_f32_16x16x32_bf16 v[64:67], v[112:115], a[4:7], v[64:67]
    v_mfma_f32_16x16x32_bf16 v[68:71], v[116:119], a[4:7], v[68:71]
    s_waitcnt vmcnt(16)
    v_mfma_f32_16x16x32_bf16 v[64:67], v[120:123], a[8:11], v[64:67]
    v_mfma_f32_16x16x32_bf16 v[68:71], v[124:127], a[8:11], v[68:71]
    s_waitcnt vmcnt(14)
    v_mfma_f32_16x16x32_bf16 v[64:67], v[128:131], a[12:15], v[64:67]
    v_mfma_f32_16x16x32_bf16 v[68:71], v[132:135], a[12:15], v[68:71]
    s_waitcnt vmcnt(12)
    v_mfma_f32_16x16x32_bf16 v[64:67], v[136:139], a[16:19], v[64:67]
    v_mfma_f32_16x16x32_bf16 v[68:71], v[140:143], a[16:19], v[68:71]
    s_waitcnt vmcnt(10)
    v_mfma_f32_16x16x32_bf16 v[64:67], v[144:147], a[20:23], v[64:67]
    v_mfma_f32_16x16x32_bf16 v[68:71], v[148:151], a[20:23], v[68:71]
    s_waitcnt vmcnt(8)
    v_mfma_f32_16x16x32_bf16 v[64:67], v[152:155], a[24:27], v[64:67]
    v_mfma_f32_16x16x32_bf16 v[68:71], v[156:159], a[24:27], v[68:71]
    s_waitcnt vmcnt(6)
    v_mfma_f32_16x16x32_bf16 v[64:67], v[160:163], a[28:31], v[64:67]
    v_mfma_f32_16x16x32_bf16 v[68:71], v[164:167], a[28:31], v[68:71]
    s_waitcnt vmcnt(0)
    v_mfma_f32_16x16x32_bf16 v[64:67], v[168:171], v[184:187], v[64:67]
    v_mfma_f32_16x16x32_bf16 v[68:71], v[172:175], v[184:187], v[68:71]
    v_mfma_f32_16x16x32_bf16 v[64:67], v[176:179], v[188:191], v[64:67]
    v_mfma_f32_16x16x32_bf16 v[68:71], v[180:183], v[188:191], v[68:71]
    s_nop 6
    ds_write_b32 v7, v64 offset:0
    ds_write_b32 v7, v65 offset:64
    ds_write_b32 v7, v66 offset:128
    ds_write_b32 v7, v67 offset:192
    ds_write_b32 v7, v68 offset:1024
    ds_write_b32 v7, v69 offset:1088
    ds_write_b32 v7, v70 offset:1152
    ds_write_b32 v7, v71 offset:1216
    s_waitcnt lgkmcnt(4)
    s_waitcnt lgkmcnt(0)
    s_barrier
    s_mul_i32 s32, s36, 40960
    s_lshl_b32 s33, s41, 5
    s_add_u32 s32, s32, s33
    ds_read_b64 v[24:25], v8 offset:0
    ds_read_b64 v[26:27], v8 offset:10240
    ds_read_b64 v[28:29], v8 offset:20480
    ds_read_b64 v[30:31], v8 offset:30720
    s_waitcnt lgkmcnt(0)
    v_add_f32 v24, v24, v26
    v_add_f32 v25, v25, v27
    v_add_f32 v28, v28, v30
    v_add_f32 v29, v29, v31
    v_add_f32 v24, v24, v28
    v_add_f32 v25, v25, v29
    v_cvt_pk_bf16_f32 v24, v24, v25
    v_and_b32 v25, 0xffff0000, v24
    v_lshlrev_b32 v24, 16, v24
    v_mul_f32 v24, v24, v13
    v_mul_f32 v25, v25, v13
    v_cvt_pk_bf16_f32 v24, v24, v25
    v_lshlrev_b32 v26, 16, v16
    v_and_b32 v27, 0xffff0000, v16
    v_and_b32 v25, 0xffff0000, v24
    v_lshlrev_b32 v24, 16, v24
    v_add_f32 v24, v24, v26
    v_add_f32 v25, v25, v27
    v_cvt_pk_bf16_f32 v24, v24, v25
    buffer_store_dword v24, v9, s[20:23], s32 offen offset:0
    s_cmp_lg_u32 s12, 0
    s_cbranch_scc1 o_top_129
    v_readfirstlane_b32 s32, v14
    s_cmp_ge_u32 s32, 576
    s_cbranch_scc1 o_top_129
    s_branch o_again_133
L_oend:
    s_endpgm
L_bulk:
    s_cmp_ge_u32 s13, 192
    s_cbranch_scc1 L_vu
    s_and_b32 s14, s13, 31
    s_bfe_u32 s40, s13, 0x10005
    s_xor_b32 s40, s40, 0
    s_load_dwordx2 s[16:17], s[0:1], 16
    s_load_dwordx2 s[24:25], s[0:1], 24
    s_load_dwordx2 s[28:29], s[0:1], 32
    s_load_dwordx2 s[20:21], s[0:1], 0
    s_mov_b32 s22, 2621440
    s_mov_b32 s23, 0x20000
    s_mov_b32 s18, 7864320
    s_mov_b32 s19, 0x20000
    s_waitcnt lgkmcnt(0)
    s_cmp_eq_u32 s40, 1
    s_cselect_b64 s[16:17], s[24:25], s[16:17]
    s_cmp_eq_u32 s40, 2
    s_cselect_b64 s[16:17], s[28:29], s[16:17]
    v_add_u32 v16, 0, v1
    v_mul_u32_u24 v17, 2731, v16
    v_lshrrev_b32 v17, 16, v17
    v_mul_u32_u24 v18, 24, v17
    v_sub_u32 v16, v16, v18
    v_lshlrev_b32 v16, 4, v16
    v_mul_u32_u24 v17, 12288, v17
    v_add_u32 v4, v16, v17
    v_add_u32 v16, 64, v1
    v_mul_u32_u24 v17, 2731, v16
    v_lshrrev_b32 v17, 16, v17
    v_mul_u32_u24 v18, 24, v17
    v_sub_u32 v16, v16, v18
    v_lshlrev_b32 v16, 4, v16
    v_mul_u32_u24 v17, 12288, v17
    v_add_u32 v5, v16, v17
    v_add_u32 v16, 128, v1
    v_mul_u32_u24 v17, 2731, v16
    v_lshrrev_b32 v17, 16, v17
    v_mul_u32_u24 v18, 24, v17
    v_sub_u32 v16, v16, v18
    v_lshlrev_b32 v16, 4, v16
    v_mul_u32_u24 v17, 12288, v17
    v_add_u32 v6, v16, v17
    s_mul_i32 s41, s14, 384
    s_mul_i32 s32, s12, 196608
    s_add_u32 s41, s41, s32
    s_mul_i32 s42, s12, 6144
    v_add_u32 v16, 0, v1
    v_mul_u32_u24 v17, 3277, v16
    v_lshrrev_b32 v17, 18, v17
    v_mul_u32_u24 v18, 80, v17
    v_sub_u32 v16, v16, v18
    s_lshl_b32 s32, s12, 3
    v_add_u32 v17, s32, v17
    v_and_b32 v18, 15, v17
    v_xor_b32 v16, v16, v18
    v_lshlrev_b32 v16, 4, v16
    v_lshrrev_b32 v19, 2, v18
    v_lshlrev_b32 v19, 3, v19
    v_and_b32 v20, 3, v18
    v_add_u32 v19, v19, v20
    v_lshrrev_b32 v20, 4, v17
    v_lshlrev_b32 v20, 2, v20
    v_add_u32 v19, v19, v20
    s_cmp_eq_u32 s40, 2
    s_cselect_b64 vcc, -1, 0
    v_cndmask_b32 v17, v17, v19, vcc
    v_mul_u32_u24 v17, 1280, v17
    v_add_u32 v80, v16, v17
    v_add_u32 v16, 64, v1
    v_mul_u32_u24 v17, 3277, v16
    v_lshrrev_b32 v17, 18, v17
    v_mul_u32_u24 v18, 80, v17
    v_sub_u32 v16, v16, v18
    s_lshl_b32 s32, s12, 3
    v_add_u32 v17, s32, v17
    v_and_b32 v18, 15, v17
    v_xor_b32 v16, v16, v18
    v_lshlrev_b32 v16, 4, v16
    v_lshrrev_b32 v19, 2, v18
    v_lshlrev_b32 v19, 3, v19
    v_and_b32 v20, 3, v18
    v_add_u32 v19, v19, v20
    v_lshrrev_b32 v20, 4, v17
    v_lshlrev_b32 v20, 2, v20
    v_add_u32 v19, v19, v20
    s_cmp_eq_u32 s40, 2
    s_cselect_b64 vcc, -1, 0
    v_cndmask_b32 v17, v17, v19, vcc
    v_mul_u32_u24 v17, 1280, v17
    v_add_u32 v81, v16, v17
    v_add_u32 v16, 128, v1
    v_mul_u32_u24 v17, 3277, v16
    v_lshrrev_b32 v17, 18, v17
    v_mul_u32_u24 v18, 80, v17
    v_sub_u32 v16, v16, v18
    s_lshl_b32 s32, s12, 3
    v_add_u32 v17, s32, v17
    v_and_b32 v18, 15, v17
    v_xor_b32 v16, v16, v18
    v_lshlrev_b32 v16, 4, v16
    v_lshrrev_b32 v19, 2, v18
    v_lshlrev_b32 v19, 3, v19
    v_and_b32 v20, 3, v18
    v_add_u32 v19, v19, v20
    v_lshrrev_b32 v20, 4, v17
    v_lshlrev_b32 v20, 2, v20
    v_add_u32 v19, v19, v20
    s_cmp_eq_u32 s40, 2
    s_cselect_b64 vcc, -1, 0
    v_cndmask_b32 v17, v17, v19, vcc
    v_mul_u32_u24 v17, 1280, v17
    v_add_u32 v82, v16, v17
    v_add_u32 v16, 192, v1
    v_mul_u32_u24 v17, 3277, v16
    v_lshrrev_b32 v17, 18, v17
    v_mul_u32_u24 v18, 80, v17
    v_sub_u32 v16, v16, v18
    s_lshl_b32 s32, s12, 3
    v_add_u32 v17, s32, v17
    v_and_b32 v18, 15, v17
    v_xor_b32 v16, v16, v18
    v_lshlrev_b32 v16, 4, v16
    v_lshrrev_b32 v19, 2, v18
    v_lshlrev_b32 v19, 3, v19
    v_and_b32 v20, 3, v18
    v_add_u32 v19, v19, v20
    v_lshrrev_b32 v20, 4, v17
    v_lshlrev_b32 v20, 2, v20
    v_add_u32 v19, v19, v20
    s_cmp_eq_u32 s40, 2
    s_cselect_b64 vcc, -1, 0
    v_cndmask_b32 v17, v17, v19, vcc
    v_mul_u32_u24 v17, 1280, v17
    v_add_u32 v83, v16, v17
    v_add_u32 v16, 256, v1
    v_mul_u32_u24 v17, 3277, v16
    v_lshrrev_b32 v17, 18, v17
    v_mul_u32_u24 v18, 80, v17
    v_sub_u32 v16, v16, v18
    s_lshl_b32 s32, s12, 3
    v_add_u32 v17, s32, v17
    v_and_b32 v18, 15, v17
    v_xor_b32 v16, v16, v18
    v_lshlrev_b32 v16, 4, v16
    v_lshrrev_b32 v19, 2, v18
    v_lshlrev_b32 v19, 3, v19
    v_and_b32 v20, 3, v18
    v_add_u32 v19, v19, v20
    v_lshrrev_b32 v20, 4, v17
    v_lshlrev_b32 v20, 2, v20
    v_add_u32 v19, v19, v20
    s_cmp_eq_u32 s40, 2
    s_cselect_b64 vcc, -1, 0
    v_cndmask_b32 v17, v17, v19, vcc
    v_mul_u32_u24 v17, 1280, v17
    v_add_u32 v84, v16, v17
    v_add_u32 v16, 320, v1
    v_mul_u32_u24 v17, 3277, v16
    v_lshrrev_b32 v17, 18, v17
    v_mul_u32_u24 v18, 80, v17
    v_sub_u32 v16, v16, v18
    s_lshl_b32 s32, s12, 3
    v_add_u32 v17, s32, v17
    v_and_b32 v18, 15, v17
    v_xor_b32 v16, v16, v18
    v_lshlrev_b32 v16, 4, v16
    v_lshrrev_b32 v19, 2, v18
    v_lshlrev_b32 v19, 3, v19
    v_and_b32 v20, 3, v18
    v_add_u32 v19, v19, v20
    v_lshrrev_b32 v20, 4, v17
    v_lshlrev_b32 v20, 2, v20
    v_add_u32 v19, v19, v20
    s_cmp_eq_u32 s40, 2
    s_cselect_b64 vcc, -1, 0
    v_cndmask_b32 v17, v17, v19, vcc
    v_mul_u32_u24 v17, 1280, v17
    v_add_u32 v85, v16, v17
    v_add_u32 v16, 384, v1
    v_mul_u32_u24 v17, 3277, v16
    v_lshrrev_b32 v17, 18, v17
    v_mul_u32_u24 v18, 80, v17
    v_sub_u32 v16, v16, v18
    s_lshl_b32 s32, s12, 3
    v_add_u32 v17, s32, v17
    v_and_b32 v18, 15, v17
    v_xor_b32 v16, v16, v18
    v_lshlrev_b32 v16, 4, v16
    v_lshrrev_b32 v19, 2, v18
    v_lshlrev_b32 v19, 3, v19
    v_and_b32 v20, 3, v18
    v_add_u32 v19, v19, v20
    v_lshrrev_b32 v20, 4, v17
    v_lshlrev_b32 v20, 2, v20
    v_add_u32 v19, v19, v20
    s_cmp_eq_u32 s40, 2
    s_cselect_b64 vcc, -1, 0
    v_cndmask_b32 v17, v17, v19, vcc
    v_mul_u32_u24 v17, 1280, v17
    v_add_u32 v86, v16, v17
    v_add_u32 v16, 448, v1
    v_mul_u32_u24 v17, 3277, v16
    v_lshrrev_b32 v17, 18, v17
    v_mul_u32_u24 v18, 80, v17
    v_sub_u32 v16, v16, v18
    s_lshl_b32 s32, s12, 3
    v_add_u32 v17, s32, v17
    v_and_b32 v18, 15, v17
    v_xor_b32 v16, v16, v18
    v_lshlrev_b32 v16, 4, v16
    v_lshrrev_b32 v19, 2, v18
    v_lshlrev_b32 v19, 3, v19
    v_and_b32 v20, 3, v18
    v_add_u32 v19, v19, v20
    v_lshrrev_b32 v20, 4, v17
    v_lshlrev_b32 v20, 2, v20
    v_add_u32 v19, v19, v20
    s_cmp_eq_u32 s40, 2
    s_cselect_b64 vcc, -1, 0
    v_cndmask_b32 v17, v17, v19, vcc
    v_mul_u32_u24 v17, 1280, v17
    v_add_u32 v87, v16, v17
    v_add_u32 v16, 512, v1
    v_mul_u32_u24 v17, 3277, v16
    v_lshrrev_b32 v17, 18, v17
    v_mul_u32_u24 v18, 80, v17
    v_sub_u32 v16, v16, v18
    s_lshl_b32 s32, s12, 3
    v_add_u32 v17, s32, v17
    v_and_b32 v18, 15, v17
    v_xor_b32 v16, v16, v18
    v_lshlrev_b32 v16, 4, v16
    v_lshrrev_b32 v19, 2, v18
    v_lshlrev_b32 v19, 3, v19
    v_and_b32 v20, 3, v18
    v_add_u32 v19, v19, v20
    v_lshrrev_b32 v20, 4, v17
    v_lshlrev_b32 v20, 2, v20
    v_add_u32 v19, v19, v20
    s_cmp_eq_u32 s40, 2
    s_cselect_b64 vcc, -1, 0
    v_cndmask_b32 v17, v17, v19, vcc
    v_mul_u32_u24 v17, 1280, v17
    v_add_u32 v88, v16, v17
    v_add_u32 v16, 576, v1
    v_mul_u32_u24 v17, 3277, v16
    v_lshrrev_b32 v17, 18, v17
    v_mul_u32_u24 v18, 80, v17
    v_sub_u32 v16, v16, v18
    s_lshl_b32 s32, s12, 3
    v_add_u32 v17, s32, v17
    v_and_b32 v18, 15, v17
    v_xor_b32 v16, v16, v18
    v_lshlrev_b32 v16, 4, v16
    v_lshrrev_b32 v19, 2, v18
    v_lshlrev_b32 v19, 3, v19
    v_and_b32 v20, 3, v18
    v_add_u32 v19, v19, v20
    v_lshrrev_b32 v20, 4, v17
    v_lshlrev_b32 v20, 2, v20
    v_add_u32 v19, v19, v20
    s_cmp_eq_u32 s40, 2
    s_cselect_b64 vcc, -1, 0
    v_cndmask_b32 v17, v17, v19, vcc
    v_mul_u32_u24 v17, 1280, v17
    v_add_u32 v89, v16, v17
    v_and_b32 v16, 15, v1
    v_lshrrev_b32 v17, 4, v1
    v_and_b32 v18, 3, v16
    v_xor_b32 v17, v17, v18
    v_and_b32 v18, 12, v16
    v_mul_u32_u24 v16, 1280, v16
    v_xor_b32 v19, 0, v18
    v_add_u32 v19, v19, v17
    v_lshlrev_b32 v19, 4, v19
    v_add_u32 v90, v19, v16
    v_xor_b32 v19, 4, v18
    v_add_u32 v19, v19, v17
    v_lshlrev_b32 v19, 4, v19
    v_add_u32 v91, v19, v16
    v_xor_b32 v19, 8, v18
    v_add_u32 v19, v19, v17
    v_lshlrev_b32 v19, 4, v19
    v_add_u32 v92, v19, v16
    v_xor_b32 v19, 12, v18
    v_add_u32 v19, v19, v17
    v_lshlrev_b32 v19, 4, v19
    v_add_u32 v93, v19, v16
    s_add_u32 m0, s42, 0
    s_add_u32 s37, s41, 0
    buffer_load_dwordx4 v4, s[16:19], s37 offen lds
    s_add_u32 m0, s42, 1024
    s_add_u32 s37, s41, 0
    buffer_load_dwordx4 v5, s[16:19], s37 offen lds
    s_add_u32 m0, s42, 2048
    s_add_u32 s37, s41, 0
    buffer_load_dwordx4 v6, s[16:19], s37 offen lds
    s_add_u32 m0, s42, 3072
    s_add_u32 s37, s41, 98304
    buffer_load_dwordx4 v4, s[16:19], s37 offen lds
    s_add_u32 m0, s42, 4096
    s_add_u32 s37, s41, 98304
    buffer_load_dwordx4 v5, s[16:19], s37 offen lds
    s_add_u32 m0, s42, 5120
    s_add_u32 s37, s41, 98304
    buffer_load_dwordx4 v6, s[16:19], s37 offen lds
    s_add_u32 m0, s42, 24576
    s_add_u32 s37, s41, 786432
    buffer_load_dwordx4 v4, s[16:19], s37 offen lds
    s_add_u32 m0, s42, 25600
    s_add_u32 s37, s41, 786432
    buffer_load_dwordx4 v5, s[16:19], s37 offen lds
    s_add_u32 m0, s42, 26624
    s_add_u32 s37, s41, 786432
    buffer_load_dwordx4 v6, s[16:19], s37 offen lds
    s_add_u32 m0, s42, 27648
    s_add_u32 s37, s41, 884736
    buffer_load_dwordx4 v4, s[16:19], s37 offen lds
    s_add_u32 m0, s42, 28672
    s_add_u32 s37, s41, 884736
    buffer_load_dwordx4 v5, s[16:19], s37 offen lds
    s_add_u32 m0, s42, 29696
    s_add_u32 s37, s41, 884736
    buffer_load_dwordx4 v6, s[16:19], s37 offen lds
    s_add_u32 m0, s42, 49152
    s_add_u32 s37, s41, 1572864
    buffer_load_dwordx4 v4, s[16:19], s37 offen lds
    s_add_u32 m0, s42, 50176
    s_add_u32 s37, s41, 1572864
    buffer_load_dwordx4 v5, s[16:19], s37 offen lds
    s_add_u32 m0, s42, 51200
    s_add_u32 s37, s41, 1572864
    buffer_load_dwordx4 v6, s[16:19], s37 offen lds
    s_add_u32 m0, s42, 52224
    s_add_u32 s37, s41, 1671168
    buffer_load_dwordx4 v4, s[16:19], s37 offen lds
    s_add_u32 m0, s42, 53248
    s_add_u32 s37, s41, 1671168
    buffer_load_dwordx4 v5, s[16:19], s37 offen lds
    s_add_u32 m0, s42, 54272
    s_add_u32 s37, s41, 1671168
    buffer_load_dwordx4 v6, s[16:19], s37 offen lds
    s_add_u32 m0, s42, 73728
    s_add_u32 s37, s41, 2359296
    buffer_load_dwordx4 v4, s[16:19], s37 offen lds
    s_add_u32 m0, s42, 74752
    s_add_u32 s37, s41, 2359296
    buffer_load_dwordx4 v5, s[16:19], s37 offen lds
    s_add_u32 m0, s42, 75776
    s_add_u32 s37, s41, 2359296
    buffer_load_dwordx4 v6, s[16:19], s37 offen lds
    s_add_u32 m0, s42, 76800
    s_add_u32 s37, s41, 2457600
    buffer_load_dwordx4 v4, s[16:19], s37 offen lds
    s_add_u32 m0, s42, 77824
    s_add_u32 s37, s41, 2457600
    buffer_load_dwordx4 v5, s[16:19], s37 offen lds
    s_add_u32 m0, s42, 78848
    s_add_u32 s37, s41, 2457600
    buffer_load_dwordx4 v6, s[16:19], s37 offen lds
    s_add_u32 m0, s42, 98304
    s_add_u32 s37, s41, 3145728
    buffer_load_dwordx4 v4, s[16:19], s37 offen lds
    s_add_u32 m0, s42, 99328
    s_add_u32 s37, s41, 3145728
    buffer_load_dwordx4 v5, s[16:19], s37 offen lds
    s_add_u32 m0, s42, 100352
    s_add_u32 s37, s41, 3145728
    buffer_load_dwordx4 v6, s[16:19], s37 offen lds
    s_add_u32 m0, s42, 101376
    s_add_u32 s37, s41, 3244032
    buffer_load_dwordx4 v4, s[16:19], s37 offen lds
    s_add_u32 m0, s42, 102400
    s_add_u32 s37, s41, 3244032
    buffer_load_dwordx4 v5, s[16:19], s37 offen lds
    s_add_u32 m0, s42, 103424
    s_add_u32 s37, s41, 3244032
    buffer_load_dwordx4 v6, s[16:19], s37 offen lds
    s_mov_b32 s36, 0
    s_mov_b32 s45, 122880
    s_mul_i32 s44, s36, 40960
    s_mul_i32 s32, s12, 10240
    s_add_u32 s47, s32, s45
    s_add_u32 m0, s47, 0
    s_nop 0
    buffer_load_dwordx4 v80, s[20:23], s44 offen lds
    s_add_u32 m0, s47, 1024
    s_nop 0
    buffer_load_dwordx4 v81, s[20:23], s44 offen lds
    s_add_u32 m0, s47, 2048
    s_nop 0
    buffer_load_dwordx4 v82, s[20:23], s44 offen lds
    s_add_u32 m0, s47, 3072
    s_nop 0
    buffer_load_dwordx4 v83, s[20:23], s44 offen lds
    s_add_u32 m0, s47, 4096
    s_nop 0
    buffer_load_dwordx4 v84, s[20:23], s44 offen lds
    s_add_u32 m0, s47, 5120
    s_nop 0
    buffer_load_dwordx4 v85, s[20:23], s44 offen lds
    s_add_u32 m0, s47, 6144
    s_nop 0
    buffer_load_dwordx4 v86, s[20:23], s44 offen lds
    s_add_u32 m0, s47, 7168
    s_nop 0
    buffer_load_dwordx4 v87, s[20:23], s44 offen lds
    s_add_u32 m0, s47, 8192
    s_nop 0
    buffer_load_dwordx4 v88, s[20:23], s44 offen lds
    s_add_u32 m0, s47, 9216
    s_nop 0
    buffer_load_dwordx4 v89, s[20:23], s44 offen lds
    v_lshrrev_b32 v16, 4, v1
    v_lshlrev_b32 v16, 3, v16
    v_bfe_u32 v17, v1, 2, 2
    v_add_u32 v16, v16, v17
    v_mul_u32_u24 v16, 384, v16
    v_and_b32 v17, 3, v1
    v_lshlrev_b32 v17, 3, v17
    s_mul_i32 s32, s12, 96
    v_add3_u32 v7, v16, v17, s32
    s_waitcnt vmcnt(34)
    s_barrier
    v_add_u32 v16, 0, v7
    ds_read_b64_tr_b16 a[0:1], v16 offset:0
    ds_read_b64_tr_b16 a[2:3], v16 offset:1536
    ds_read_b64_tr_b16 a[4:5], v16 offset:12288
    ds_read_b64_tr_b16 a[6:7], v16 offset:13824
    ds_read_b64_tr_b16 a[80:81], v16 offset:32
    ds_read_b64_tr_b16 a[82:83], v16 offset:1568
    ds_read_b64_tr_b16 a[84:85], v16 offset:12320
    ds_read_b64_tr_b16 a[86:87], v16 offset:13856
    ds_read_b64_tr_b16 a[160:161], v16 offset:64
    ds_read_b64_tr_b16 a[162:163], v16 offset:1600
    ds_read_b64_tr_b16 a[164:165], v16 offset:12352
    ds_read_b64_tr_b16 a[166:167], v16 offset:13888
    s_waitcnt lgkmcnt(0)
    s_barrier
    s_add_u32 m0, s42, 0
    s_add_u32 s37, s41, 3932160
    buffer_load_dwordx4 v4, s[16:19], s37 offen lds
    s_add_u32 m0, s42, 1024
    s_add_u32 s37, s41, 3932160
    buffer_load_dwordx4 v5, s[16:19], s37 offen lds
    s_add_u32 m0, s42, 2048
    s_add_u32 s37, s41, 3932160
    buffer_load_dwordx4 v6, s[16:19], s37 offen lds
    s_add_u32 m0, s42, 3072
    s_add_u32 s37, s41, 4030464
    buffer_load_dwordx4 v4, s[16:19], s37 offen lds
    s_add_u32 m0, s42, 4096
    s_add_u32 s37, s41, 4030464
    buffer_load_dwordx4 v5, s[16:19], s37 offen lds
    s_add_u32 m0, s42, 5120
    s_add_u32 s37, s41, 4030464
    buffer_load_dwordx4 v6, s[16:19], s37 offen lds
    s_waitcnt vmcnt(34)
    s_barrier
    v_add_u32 v16, 24576, v7
    ds_read_b64_tr_b16 a[8:9], v16 offset:0
    ds_read_b64_tr_b16 a[10:11], v16 offset:1536
    ds_read_b64_tr_b16 a[12:13], v16 offset:12288
    ds_read_b64_tr_b16 a[14:15], v16 offset:13824
    ds_read_b64_tr_b16 a[88:89], v16 offset:32
    ds_read_b64_tr_b16 a[90:91], v16 offset:1568
    ds_read_b64_tr_b16 a[92:93], v16 offset:12320
    ds_read_b64_tr_b16 a[94:95], v16 offset:13856
    ds_read_b64_tr_b16 a[168:169], v16 offset:64
    ds_read_b64_tr_b16 a[170:171], v16 offset:1600
    ds_read_b64_tr_b16 a[172:173], v16 offset:12352
    ds_read_b64_tr_b16 a[174:175], v16 offset:13888
    s_waitcnt lgkmcnt(0)
    s_barrier
    s_add_u32 m0, s42, 24576
    s_add_u32 s37, s41, 4718592
    buffer_load_dwordx4 v4, s[16:19], s37 offen lds
    s_add_u32 m0, s42, 25600
    s_add_u32 s37, s41, 4718592
    buffer_load_dwordx4 v5, s[16:19], s37 offen lds
    s_add_u32 m0, s42, 26624
    s_add_u32 s37, s41, 4718592
    buffer_load_dwordx4 v6, s[16:19], s37 offen lds
    s_add_u32 m0, s42, 27648
    s_add_u32 s37, s41, 4816896
    buffer_load_dwordx4 v4, s[16:19], s37 offen lds
    s_add_u32 m0, s42, 28672
    s_add_u32 s37, s41, 4816896
    buffer_load_dwordx4 v5, s[16:19], s37 offen lds
    s_add_u32 m0, s42, 29696
    s_add_u32 s37, s41, 4816896
    buffer_load_dwordx4 v6, s[16:19], s37 offen lds
    s_waitcnt vmcnt(34)
    s_barrier
    v_add_u32 v16, 49152, v7
    ds_read_b64_tr_b16 a[16:17], v16 offset:0
    ds_read_b64_tr_b16 a[18:19], v16 offset:1536
    ds_read_b64_tr_b16 a[20:21], v16 offset:12288
    ds_read_b64_tr_b16 a[22:23], v16 offset:13824
    ds_read_b64_tr_b16 a[96:97], v16 offset:32
    ds_read_b64_tr_b16 a[98:99], v16 offset:1568
    ds_read_b64_tr_b16 a[100:101], v16 offset:12320
    ds_read_b64_tr_b16 a[102:103], v16 offset:13856
    ds_read_b64_tr_b16 a[176:177], v16 offset:64
    ds_read_b64_tr_b16 a[178:179], v16 offset:1600
    ds_read_b64_tr_b16 a[180:181], v16 offset:12352
    ds_read_b64_tr_b16 a[182:183], v16 offset:13888
    s_waitcnt lgkmcnt(0)
    s_barrier
    s_add_u32 m0, s42, 49152
    s_add_u32 s37, s41, 5505024
    buffer_load_dwordx4 v4, s[16:19], s37 offen lds
    s_add_u32 m0, s42, 50176
    s_add_u32 s37, s41, 5505024
    buffer_load_dwordx4 v5, s[16:19], s37 offen lds
    s_add_u32 m0, s42, 51200
    s_add_u32 s37, s41, 5505024
    buffer_load_dwordx4 v6, s[16:19], s37 offen lds
    s_add_u32 m0, s42, 52224
    s_add_u32 s37, s41, 5603328
    buffer_load_dwordx4 v4, s[16:19], s37 offen lds
    s_add_u32 m0, s42, 53248
    s_add_u32 s37, s41, 5603328
    buffer_load_dwordx4 v5, s[16:19], s37 offen lds
    s_add_u32 m0, s42, 54272
    s_add_u32 s37, s41, 5603328
    buffer_load_dwordx4 v6, s[16:19], s37 offen lds
    s_waitcnt vmcnt(34)
    s_barrier
    v_add_u32 v16, 73728, v7
    ds_read_b64_tr_b16 a[24:25], v16 offset:0
    ds_read_b64_tr_b16 a[26:27], v16 offset:1536
    ds_read_b64_tr_b16 a[28:29], v16 offset:12288
    ds_read_b64_tr_b16 a[30:31], v16 offset:13824
    ds_read_b64_tr_b16 a[104:105], v16 offset:32
    ds_read_b64_tr_b16 a[106:107], v16 offset:1568
    ds_read_b64_tr_b16 a[108:109], v16 offset:12320
    ds_read_b64_tr_b16 a[110:111], v16 offset:13856
    ds_read_b64_tr_b16 a[184:185], v16 offset:64
    ds_read_b64_tr_b16 a[186:187], v16 offset:1600
    ds_read_b64_tr_b16 a[188:189], v16 offset:12352
    ds_read_b64_tr_b16 a[190:191], v16 offset:13888
    s_waitcnt lgkmcnt(0)
    s_barrier
    s_add_u32 m0, s42, 73728
    s_add_u32 s37, s41, 6291456
    buffer_load_dwordx4 v4, s[16:19], s37 offen lds
    s_add_u32 m0, s42, 74752
    s_add_u32 s37, s41, 6291456
    buffer_load_dwordx4 v5, s[16:19], s37 offen lds
    s_add_u32 m0, s42, 75776
    s_add_u32 s37, s41, 6291456
    buffer_load_dwordx4 v6, s[16:19], s37 offen lds
    s_add_u32 m0, s42, 76800
    s_add_u32 s37, s41, 6389760
    buffer_load_dwordx4 v4, s[16:19], s37 offen lds
    s_add_u32 m0, s42, 77824
    s_add_u32 s37, s41, 6389760
    buffer_load_dwordx4 v5, s[16:19], s37 offen lds
    s_add_u32 m0, s42, 78848
    s_add_u32 s37, s41, 6389760
    buffer_load_dwordx4 v6, s[16:19], s37 offen lds
    s_waitcnt vmcnt(34)
    s_barrier
    v_add_u32 v16, 98304, v7
    ds_read_b64_tr_b16 a[32:33], v16 offset:0
    ds_read_b64_tr_b16 a[34:35], v16 offset:1536
    ds_read_b64_tr_b16 a[36:37], v16 offset:12288
    ds_read_b64_tr_b16 a[38:39], v16 offset:13824
    ds_read_b64_tr_b16 a[112:113], v16 offset:32
    ds_read_b64_tr_b16 a[114:115], v16 offset:1568
    ds_read_b64_tr_b16 a[116:117], v16 offset:12320
    ds_read_b64_tr_b16 a[118:119], v16 offset:13856
    ds_read_b64_tr_b16 a[192:193], v16 offset:64
    ds_read_b64_tr_b16 a[194:195], v16 offset:1600
    ds_read_b64_tr_b16 a[196:197], v16 offset:12352
    ds_read_b64_tr_b16 a[198:199], v16 offset:13888
    s_waitcnt lgkmcnt(0)
    s_barrier
    s_add_u32 m0, s42, 98304
    s_add_u32 s37, s41, 7077888
    buffer_load_dwordx4 v4, s[16:19], s37 offen lds
    s_add_u32 m0, s42, 99328
    s_add_u32 s37, s41, 7077888
    buffer_load_dwordx4 v5, s[16:19], s37 offen lds
    s_add_u32 m0, s42, 100352
    s_add_u32 s37, s41, 7077888
    buffer_load_dwordx4 v6, s[16:19], s37 offen lds
    s_add_u32 m0, s42, 101376
    s_add_u32 s37, s41, 7176192
    buffer_load_dwordx4 v4, s[16:19], s37 offen lds
    s_add_u32 m0, s42, 102400
    s_add_u32 s37, s41, 7176192
    buffer_load_dwordx4 v5, s[16:19], s37 offen lds
    s_add_u32 m0, s42, 103424
    s_add_u32 s37, s41, 7176192
    buffer_load_dwordx4 v6, s[16:19], s37 offen lds
    s_waitcnt vmcnt(24)
    s_barrier
    v_add_u32 v16, 0, v7
    ds_read_b64_tr_b16 a[40:41], v16 offset:0
    ds_read_b64_tr_b16 a[42:43], v16 offset:1536
    ds_read_b64_tr_b16 a[44:45], v16 offset:12288
    ds_read_b64_tr_b16 a[46:47], v16 offset:13824
    ds_read_b64_tr_b16 a[120:121], v16 offset:32
    ds_read_b64_tr_b16 a[122:123], v16 offset:1568
    ds_read_b64_tr_b16 a[124:125], v16 offset:12320
    ds_read_b64_tr_b16 a[126:127], v16 offset:13856
    ds_read_b64_tr_b16 a[200:201], v16 offset:64
    ds_read_b64_tr_b16 a[202:203], v16 offset:1600
    ds_read_b64_tr_b16 a[204:205], v16 offset:12352
    ds_read_b64_tr_b16 a[206:207], v16 offset:13888
    s_waitcnt lgkmcnt(0)
    s_waitcnt vmcnt(18)
    s_barrier
    v_add_u32 v16, 24576, v7
    ds_read_b64_tr_b16 a[48:49], v16 offset:0
    ds_read_b64_tr_b16 a[50:51], v16 offset:1536
    ds_read_b64_tr_b16 a[52:53], v16 offset:12288
    ds_read_b64_tr_b16 a[54:55], v16 offset:13824
    ds_read_b64_tr_b16 a[128:129], v16 offset:32
    ds_read_b64_tr_b16 a[130:131], v16 offset:1568
    ds_read_b64_tr_b16 a[132:133], v16 offset:12320
    ds_read_b64_tr_b16 a[134:135], v16 offset:13856
    ds_read_b64_tr_b16 a[208:209], v16 offset:64
    ds_read_b64_tr_b16 a[210:211], v16 offset:1600
    ds_read_b64_tr_b16 a[212:213], v16 offset:12352
    ds_read_b64_tr_b16 a[214:215], v16 offset:13888
    s_waitcnt lgkmcnt(0)
    s_waitcnt vmcnt(12)
    s_barrier
    v_add_u32 v16, 49152, v7
    ds_read_b64_tr_b16 a[56:57], v16 offset:0
    ds_read_b64_tr_b16 a[58:59], v16 offset:1536
    ds_read_b64_tr_b16 a[60:61], v16 offset:12288
    ds_read_b64_tr_b16 a[62:63], v16 offset:13824
    ds_read_b64_tr_b16 a[136:137], v16 offset:32
    ds_read_b64_tr_b16 a[138:139], v16 offset:1568
    ds_read_b64_tr_b16 a[140:141], v16 offset:12320
    ds_read_b64_tr_b16 a[142:143], v16 offset:13856
    ds_read_b64_tr_b16 a[216:217], v16 offset:64
    ds_read_b64_tr_b16 a[218:219], v16 offset:1600
    ds_read_b64_tr_b16 a[220:221], v16 offset:12352
    ds_read_b64_tr_b16 a[222:223], v16 offset:13888
    s_waitcnt lgkmcnt(0)
    s_waitcnt vmcnt(6)
    s_barrier
    v_add_u32 v16, 73728, v7
    ds_read_b64_tr_b16 a[64:65], v16 offset:0
    ds_read_b64_tr_b16 a[66:67], v16 offset:1536
    ds_read_b64_tr_b16 a[68:69], v16 offset:12288
    ds_read_b64_tr_b16 a[70:71], v16 offset:13824
    ds_read_b64_tr_b16 a[144:145], v16 offset:32
    ds_read_b64_tr_b16 a[146:147], v16 offset:1568
    ds_read_b64_tr_b16 a[148:149], v16 offset:12320
    ds_read_b64_tr_b16 a[150:151], v16 offset:13856
    ds_read_b64_tr_b16 a[224:225], v16 offset:64
    ds_read_b64_tr_b16 a[226:227], v16 offset:1600
    ds_read_b64_tr_b16 a[228:229], v16 offset:12352
    ds_read_b64_tr_b16 a[230:231], v16 offset:13888
    s_waitcnt lgkmcnt(0)
    s_waitcnt vmcnt(0)
    s_barrier
    v_add_u32 v16, 98304, v7
    ds_read_b64_tr_b16 a[72:73], v16 offset:0
    ds_read_b64_tr_b16 a[74:75], v16 offset:1536
    ds_read_b64_tr_b16 a[76:77], v16 offset:12288
    ds_read_b64_tr_b16 a[78:79], v16 offset:13824
    ds_read_b64_tr_b16 a[152:153], v16 offset:32
    ds_read_b64_tr_b16 a[154:155], v16 offset:1568
    ds_read_b64_tr_b16 a[156:157], v16 offset:12320
    ds_read_b64_tr_b16 a[158:159], v16 offset:13856
    ds_read_b64_tr_b16 a[232:233], v16 offset:64
    ds_read_b64_tr_b16 a[234:235], v16 offset:1600
    ds_read_b64_tr_b16 a[236:237], v16 offset:12352
    ds_read_b64_tr_b16 a[238:239], v16 offset:13888
    s_waitcnt lgkmcnt(0)
    s_barrier
    v_mov_b32 v3, 128
    s_mov_b32 s39, 0
dw_148:
    buffer_load_dword v2, v3, s[8:11], 0 offen sc1
    s_waitcnt vmcnt(0)
    v_readfirstlane_b32 s32, v2
    s_cmp_ge_u32 s32, 40
    s_cbranch_scc1 dwo_149
    s_sleep 4
    s_add_u32 s39, s39, 1
    s_cmp_lt_u32 s39, 20000
    s_cbranch_scc1 dw_148
    s_branch L_end3
dwo_149:
    s_mov_b32 s34, 1
    s_mov_b32 s35, 0
    s_mul_i32 s44, s34, 40960
    s_mul_i32 s32, s12, 10240
    s_add_u32 s47, s32, s35
    s_add_u32 m0, s47, 0
    s_nop 0
    buffer_load_dwordx4 v80, s[20:23], s44 offen lds
    s_add_u32 m0, s47, 1024
    s_nop 0
    buffer_load_dwordx4 v81, s[20:23], s44 offen lds
    s_add_u32 m0, s47, 2048
    s_nop 0
    buffer_load_dwordx4 v82, s[20:23], s44 offen lds
    s_add_u32 m0, s47, 3072
    s_nop 0
    buffer_load_dwordx4 v83, s[20:23], s44 offen lds
    s_add_u32 m0, s47, 4096
    s_nop 0
    buffer_load_dwordx4 v84, s[20:23], s44 offen lds
    s_add_u32 m0, s47, 5120
    s_nop 0
    buffer_load_dwordx4 v85, s[20:23], s44 offen lds
    s_add_u32 m0, s47, 6144
    s_nop 0
    buffer_load_dwordx4 v86, s[20:23], s44 offen lds
    s_add_u32 m0, s47, 7168
    s_nop 0
    buffer_load_dwordx4 v87, s[20:23], s44 offen lds
    s_add_u32 m0, s47, 8192
    s_nop 0
    buffer_load_dwordx4 v88, s[20:23], s44 offen lds
    s_add_u32 m0, s47, 9216
    s_nop 0
    buffer_load_dwordx4 v89, s[20:23], s44 offen lds
    s_mul_i32 s43, s40, 25165824
    s_add_u32 s43, s43, 4194304
    s_mul_i32 s32, s14, 12288
    s_add_u32 s43, s43, s32
    s_mul_i32 s32, s12, 3072
    v_lshlrev_b32 v10, 4, v1
    v_add_u32 v10, s32, v10
    s_lshl_b32 s32, s40, 12
    s_lshl_b32 s33, s14, 7
    s_add_u32 s32, s32, s33
    s_add_u32 s32, s32, 2162688
    v_mov_b32 v12, s32
    s_mov_b32 s46, 40960
proj_loop_150:
    s_barrier
    v_add_u32 v94, s45, v90
    v_add_u32 v95, s45, v91
    v_add_u32 v96, s45, v92
    v_add_u32 v97, s45, v93
    ds_read_b128 v[100:103], v94 offset:0
    ds_read_b128 v[104:107], v94 offset:20480
    ds_read_b128 v[108:111], v95 offset:0
    ds_read_b128 v[112:115], v95 offset:20480
    ds_read_b128 v[116:119], v96 offset:0
    ds_read_b128 v[120:123], v96 offset:20480
    s_add_u32 s34, s36, 2
    s_min_u32 s34, s34, 63
    s_mul_i32 s44, s34, 40960
    s_mul_i32 s32, s12, 10240
    s_add_u32 s47, s32, s46
    ds_read_b128 v[124:127], v97 offset:0
    ds_read_b128 v[128:131], v97 offset:20480
    s_waitcnt lgkmcnt(6)
    v_mfma_f32_16x16x32_bf16 v[16:19], a[0:3], v[100:103], 0
    v_mfma_f32_16x16x32_bf16 v[20:23], a[0:3], v[104:107], 0
    v_mfma_f32_16x16x32_bf16 v[24:27], a[80:83], v[100:103], 0
    v_mfma_f32_16x16x32_bf16 v[28:31], a[80:83], v[104:107], 0
    s_add_u32 m0, s47, 0
    s_nop 0
    buffer_load_dwordx4 v80, s[20:23], s44 offen lds
    v_mfma_f32_16x16x32_bf16 v[32:35], a[160:163], v[100:103], 0
    v_mfma_f32_16x16x32_bf16 v[36:39], a[160:163], v[104:107], 0
    ds_read_b128 v[100:103], v94 offset:256
    ds_read_b128 v[104:107], v94 offset:20736
    s_waitcnt lgkmcnt(6)
    v_mfma_f32_16x16x32_bf16 v[16:19], a[4:7], v[108:111], v[16:19]
    v_mfma_f32_16x16x32_bf16 v[20:23], a[4:7], v[112:115], v[20:23]
    v_mfma_f32_16x16x32_bf16 v[24:27], a[84:87], v[108:111], v[24:27]
    v_mfma_f32_16x16x32_bf16 v[28:31], a[84:87], v[112:115], v[28:31]
    s_add_u32 m0, s47, 1024
    s_nop 0
    buffer_load_dwordx4 v81, s[20:23], s44 offen lds
    v_mfma_f32_16x16x32_bf16 v[32:35], a[164:167], v[108:111], v[32:35]
    v_mfma_f32_16x16x32_bf16 v[36:39], a[164:167], v[112:115], v[36:39]
    ds_read_b128 v[108:111], v95 offset:256
    ds_read_b128 v[112:115], v95 offset:20736
    s_waitcnt lgkmcnt(6)
    v_mfma_f32_16x16x32_bf16 v[16:19], a[8:11], v[116:119], v[16:19]
    v_mfma_f32_16x16x32_bf16 v[20:23], a[8:11], v[120:123], v[20:23]
    v_mfma_f32_16x16x32_bf16 v[24:27], a[88:91], v[116:119], v[24:27]
    v_mfma_f32_16x16x32_bf16 v[28:31], a[88:91], v[120:123], v[28:31]
    s_add_u32 m0, s47, 2048
    s_nop 0
    buffer_load_dwordx4 v82, s[20:23], s44 offen lds
    v_mfma_f32_16x16x32_bf16 v[32:35], a[168:171], v[116:119], v[32:35]
    v_mfma_f32_16x16x32_bf16 v[36:39], a[168:171], v[120:123], v[36:39]
    ds_read_b128 v[116:119], v96 offset:256
    ds_read_b128 v[120:123], v96 offset:20736
    s_waitcnt lgkmcnt(6)
    v_mfma_f32_16x16x32_bf16 v[16:19], a[12:15], v[124:127], v[16:19]
    v_mfma_f32_16x16x32_bf16 v[20:23], a[12:15], v[128:131], v[20:23]
    v_mfma_f32_16x16x32_bf16 v[24:27], a[92:95], v[124:127], v[24:27]
    v_mfma_f32_16x16x32_bf16 v[28:31], a[92:95], v[128:131], v[28:31]
    s_add_u32 m0, s47, 3072
    s_nop 0
    buffer_load_dwordx4 v83, s[20:23], s44 offen lds
    v_mfma_f32_16x16x32_bf16 v[32:35], a[172:175], v[124:127], v[32:35]
    v_mfma_f32_16x16x32_bf16 v[36:39], a[172:175], v[128:131], v[36:39]
    ds_read_b128 v[124:127], v97 offset:256
    ds_read_b128 v[128:131], v97 offset:20736
    s_waitcnt lgkmcnt(6)
    v_mfma_f32_16x16x32_bf16 v[16:19], a[16:19], v[100:103], v[16:19]
    v_mfma_f32_16x16x32_bf16 v[20:23], a[16:19], v[104:107], v[20:23]
    v_mfma_f32_16x16x32_bf16 v[24:27], a[96:99], v[100:103], v[24:27]
    v_mfma_f32_16x16x32_bf16 v[28:31], a[96:99], v[104:107], v[28:31]
    s_add_u32 m0, s47, 4096
    s_nop 0
    buffer_load_dwordx4 v84, s[20:23], s44 offen lds
    v_mfma_f32_16x16x32_bf16 v[32:35], a[176:179], v[100:103], v[32:35]
    v_mfma_f32_16x16x32_bf16 v[36:39], a[176:179], v[104:107], v[36:39]
    ds_read_b128 v[100:103], v94 offset:512
    ds_read_b128 v[104:107], v94 offset:20992
    s_waitcnt lgkmcnt(6)
    v_mfma_f32_16x16x32_bf16 v[16:19], a[20:23], v[108:111], v[16:19]
    v_mfma_f32_16x16x32_bf16 v[20:23], a[20:23], v[112:115], v[20:23]
    v_mfma_f32_16x16x32_bf16 v[24:27], a[100:103], v[108:111], v[24:27]
    v_mfma_f32_16x16x32_bf16 v[28:31], a[100:103], v[112:115], v[28:31]
    s_add_u32 m0, s47, 5120
    s_nop 0
    buffer_load_dwordx4 v85, s[20:23], s44 offen lds
    v_mfma_f32_16x16x32_bf16 v[32:35], a[180:183], v[108:111], v[32:35]
    v_mfma_f32_16x16x32_bf16 v[36:39], a[180:183], v[112:115], v[36:39]
    ds_read_b128 v[108:111], v95 offset:512
    ds_read_b128 v[112:115], v95 offset:20992
    s_waitcnt lgkmcnt(6)
    v_mfma_f32_16x16x32_bf16 v[16:19], a[24:27], v[116:119], v[16:19]
    v_mfma_f32_16x16x32_bf16 v[20:23], a[24:27], v[120:123], v[20:23]
    v_mfma_f32_16x16x32_bf16 v[24:27], a[104:107], v[116:119], v[24:27]
    v_mfma_f32_16x16x32_bf16 v[28:31], a[104:107], v[120:123], v[28:31]
    s_add_u32 m0, s47, 6144
    s_nop 0
    buffer_load_dwordx4 v86, s[20:23], s44 offen lds
    v_mfma_f32_16x16x32_bf16 v[32:35], a[184:187], v[116:119], v[32:35]
    v_mfma_f32_16x16x32_bf16 v[36:39], a[184:187], v[120:123], v[36:39]
    ds_read_b128 v[116:119], v96 offset:512
    ds_read_b128 v[120:123], v96 offset:20992
    s_waitcnt lgkmcnt(6)
    v_mfma_f32_16x16x32_bf16 v[16:19], a[28:31], v[124:127], v[16:19]
    v_mfma_f32_16x16x32_bf16 v[20:23], a[28:31], v[128:131], v[20:23]
    v_mfma_f32_16x16x32_bf16 v[24:27], a[108:111], v[124:127], v[24:27]
    v_mfma_f32_16x16x32_bf16 v[28:31], a[108:111], v[128:131], v[28:31]
    s_add_u32 m0, s47, 7168
    s_nop 0
    buffer_load_dwordx4 v87, s[20:23], s44 offen lds
    v_mfma_f32_16x16x32_bf16 v[32:35], a[188:191], v[124:127], v[32:35]
    v_mfma_f32_16x16x32_bf16 v[36:39], a[188:191], v[128:131], v[36:39]
    ds_read_b128 v[124:127], v97 offset:512
    ds_read_b128 v[128:131], v97 offset:20992
    s_waitcnt lgkmcnt(6)
    v_mfma_f32_16x16x32_bf16 v[16:19], a[32:35], v[100:103], v[16:19]
    v_mfma_f32_16x16x32_bf16 v[20:23], a[32:35], v[104:107], v[20:23]
    v_mfma_f32_16x16x32_bf16 v[24:27], a[112:115], v[100:103], v[24:27]
    v_mfma_f32_16x16x32_bf16 v[28:31], a[112:115], v[104:107], v[28:31]
    s_add_u32 m0, s47, 8192
    s_nop 0
    buffer_load_dwordx4 v88, s[20:23], s44 offen lds
    v_mfma_f32_16x16x32_bf16 v[32:35], a[192:195], v[100:103], v[32:35]
    v_mfma_f32_16x16x32_bf16 v[36:39], a[192:195], v[104:107], v[36:39]
    ds_read_b128 v[100:103], v94 offset:768
    ds_read_b128 v[104:107], v94 offset:21248
    s_waitcnt lgkmcnt(6)
    v_mfma_f32_16x16x32_bf16 v[16:19], a[36:39], v[108:111], v[16:19]
    v_mfma_f32_16x16x32_bf16 v[20:23], a[36:39], v[112:115], v[20:23]
    v_mfma_f32_16x16x32_bf16 v[24:27], a[116:119], v[108:111], v[24:27]
    v_mfma_f32_16x16x32_bf16 v[28:31], a[116:119], v[112:115], v[28:31]
    s_add_u32 m0, s47, 9216
    s_nop 0
    buffer_load_dwordx4 v89, s[20:23], s44 offen lds
    v_mfma_f32_16x16x32_bf16 v[32:35], a[196:199], v[108:111], v[32:35]
    v_mfma_f32_16x16x32_bf16 v[36:39], a[196:199], v[112:115], v[36:39]
    ds_read_b128 v[108:111], v95 offset:768
    ds_read_b128 v[112:115], v95 offset:21248
    s_waitcnt lgkmcnt(6)
    v_mfma_f32_16x16x32_bf16 v[16:19], a[40:43], v[116:119], v[16:19]
    v_mfma_f32_16x16x32_bf16 v[20:23], a[40:43], v[120:123], v[20:23]
    v_mfma_f32_16x16x32_bf16 v[24:27], a[120:123], v[116:119], v[24:27]
    v_mfma_f32_16x16x32_bf16 v[28:31], a[120:123], v[120:123], v[28:31]
    v_mfma_f32_16x16x32_bf16 v[32:35], a[200:203], v[116:119], v[32:35]
    v_mfma_f32_16x16x32_bf16 v[36:39], a[200:203], v[120:123], v[36:39]
    ds_read_b128 v[116:119], v96 offset:768
    ds_read_b128 v[120:123], v96 offset:21248
    s_waitcnt lgkmcnt(6)
    v_mfma_f32_16x16x32_bf16 v[16:19], a[44:47], v[124:127], v[16:19]
    v_mfma_f32_16x16x32_bf16 v[20:23], a[44:47], v[128:131], v[20:23]
    v_mfma_f32_16x16x32_bf16 v[24:27], a[124:127], v[124:127], v[24:27]
    v_mfma_f32_16x16x32_bf16 v[28:31], a[124:127], v[128:131], v[28:31]
    v_mfma_f32_16x16x32_bf16 v[32:35], a[204:207], v[124:127], v[32:35]
    v_mfma_f32_16x16x32_bf16 v[36:39], a[204:207], v[128:131], v[36:39]
    ds_read_b128 v[124:127], v97 offset:768
    ds_read_b128 v[128:131], v97 offset:21248
    s_waitcnt lgkmcnt(6)
    v_mfma_f32_16x16x32_bf16 v[16:19], a[48:51], v[100:103], v[16:19]
    v_mfma_f32_16x16x32_bf16 v[20:23], a[48:51], v[104:107], v[20:23]
    v_mfma_f32_16x16x32_bf16 v[24:27], a[128:131], v[100:103], v[24:27]
    v_mfma_f32_16x16x32_bf16 v[28:31], a[128:131], v[104:107], v[28:31]
    v_mfma_f32_16x16x32_bf16 v[32:35], a[208:211], v[100:103], v[32:35]
    v_mfma_f32_16x16x32_bf16 v[36:39], a[208:211], v[104:107], v[36:39]
    s_waitcnt vmcnt(10)
    s_barrier
    s_cmp_lg_u32 s12, 0
    s_cbranch_scc1 nofl_152
    v_mov_b32 v2, s36
    s_mov_b64 exec, 1
    buffer_store_dword v2, v12, s[4:7], 0 offen sc1
    s_mov_b64 exec, -1
nofl_152:
    ds_read_b128 v[100:103], v94 offset:1024
    ds_read_b128 v[104:107], v94 offset:21504
    s_waitcnt lgkmcnt(6)
    v_mfma_f32_16x16x32_bf16 v[16:19], a[52:55], v[108:111], v[16:19]
    v_mfma_f32_16x16x32_bf16 v[20:23], a[52:55], v[112:115], v[20:23]
    v_mfma_f32_16x16x32_bf16 v[24:27], a[132:135], v[108:111], v[24:27]
    v_mfma_f32_16x16x32_bf16 v[28:31], a[132:135], v[112:115], v[28:31]
    v_mfma_f32_16x16x32_bf16 v[32:35], a[212:215], v[108:111], v[32:35]
    v_mfma_f32_16x16x32_bf16 v[36:39], a[212:215], v[112:115], v[36:39]
    ds_read_b128 v[108:111], v95 offset:1024
    ds_read_b128 v[112:115], v95 offset:21504
    s_waitcnt lgkmcnt(6)
    v_mfma_f32_16x16x32_bf16 v[16:19], a[56:59], v[116:119], v[16:19]
    v_mfma_f32_16x16x32_bf16 v[20:23], a[56:59], v[120:123], v[20:23]
    v_mfma_f32_16x16x32_bf16 v[24:27], a[136:139], v[116:119], v[24:27]
    v_mfma_f32_16x16x32_bf16 v[28:31], a[136:139], v[120:123], v[28:31]
    v_mfma_f32_16x16x32_bf16 v[32:35], a[216:219], v[116:119], v[32:35]
    v_mfma_f32_16x16x32_bf16 v[36:39], a[216:219], v[120:123], v[36:39]
    ds_read_b128 v[116:119], v96 offset:1024
    ds_read_b128 v[120:123], v96 offset:21504
    s_waitcnt lgkmcnt(6)
    v_mfma_f32_16x16x32_bf16 v[16:19], a[60:63], v[124:127], v[16:19]
    v_mfma_f32_16x16x32_bf16 v[20:23], a[60:63], v[128:131], v[20:23]
    v_mfma_f32_16x16x32_bf16 v[24:27], a[140:143], v[124:127], v[24:27]
    v_mfma_f32_16x16x32_bf16 v[28:31], a[140:143], v[128:131], v[28:31]
    v_mfma_f32_16x16x32_bf16 v[32:35], a[220:223], v[124:127], v[32:35]
    v_mfma_f32_16x16x32_bf16 v[36:39], a[220:223], v[128:131], v[36:39]
    ds_read_b128 v[124:127], v97 offset:1024
    ds_read_b128 v[128:131], v97 offset:21504
    s_waitcnt lgkmcnt(6)
    v_mfma_f32_16x16x32_bf16 v[16:19], a[64:67], v[100:103], v[16:19]
    v_mfma_f32_16x16x32_bf16 v[20:23], a[64:67], v[104:107], v[20:23]
    v_mfma_f32_16x16x32_bf16 v[24:27], a[144:147], v[100:103], v[24:27]
    v_mfma_f32_16x16x32_bf16 v[28:31], a[144:147], v[104:107], v[28:31]
    v_mfma_f32_16x16x32_bf16 v[32:35], a[224:227], v[100:103], v[32:35]
    v_mfma_f32_16x16x32_bf16 v[36:39], a[224:227], v[104:107], v[36:39]
    s_waitcnt lgkmcnt(4)
    v_mfma_f32_16x16x32_bf16 v[16:19], a[68:71], v[108:111], v[16:19]
    v_mfma_f32_16x16x32_bf16 v[20:23], a[68:71], v[112:115], v[20:23]
    v_mfma_f32_16x16x32_bf16 v[24:27], a[148:151], v[108:111], v[24:27]
    v_mfma_f32_16x16x32_bf16 v[28:31], a[148:151], v[112:115], v[28:31]
    v_mfma_f32_16x16x32_bf16 v[32:35], a[228:231], v[108:111], v[32:35]
    v_mfma_f32_16x16x32_bf16 v[36:39], a[228:231], v[112:115], v[36:39]
    s_waitcnt lgkmcnt(2)
    v_mfma_f32_16x16x32_bf16 v[16:19], a[72:75], v[116:119], v[16:19]
    v_mfma_f32_16x16x32_bf16 v[20:23], a[72:75], v[120:123], v[20:23]
    v_mfma_f32_16x16x32_bf16 v[24:27], a[152:155], v[116:119], v[24:27]
    v_mfma_f32_16x16x32_bf16 v[28:31], a[152:155], v[120:123], v[28:31]
    v_mfma_f32_16x16x32_bf16 v[32:35], a[232:235], v[116:119], v[32:35]
    v_mfma_f32_16x16x32_bf16 v[36:39], a[232:235], v[120:123], v[36:39]
    s_waitcnt lgkmcnt(0)
    v_mfma_f32_16x16x32_bf16 v[16:19], a[76:79], v[124:127], v[16:19]
    v_mfma_f32_16x16x32_bf16 v[20:23], a[76:79], v[128:131], v[20:23]
    v_mfma_f32_16x16x32_bf16 v[24:27], a[156:159], v[124:127], v[24:27]
    v_mfma_f32_16x16x32_bf16 v[28:31], a[156:159], v[128:131], v[28:31]
    v_mfma_f32_16x16x32_bf16 v[32:35], a[236:239], v[124:127], v[32:35]
    v_mfma_f32_16x16x32_bf16 v[36:39], a[236:239], v[128:131], v[36:39]
    s_nop 7
    v_cvt_pk_bf16_f32 v56, v16, v17
    v_cvt_pk_bf16_f32 v57, v18, v19
    v_cvt_pk_bf16_f32 v58, v24, v25
    v_cvt_pk_bf16_f32 v59, v26, v27
    v_cvt_pk_bf16_f32 v64, v32, v33
    v_cvt_pk_bf16_f32 v65, v34, v35
    v_cvt_pk_bf16_f32 v60, v20, v21
    v_cvt_pk_bf16_f32 v61, v22, v23
    v_cvt_pk_bf16_f32 v62, v28, v29
    v_cvt_pk_bf16_f32 v63, v30, v31
    v_cvt_pk_bf16_f32 v66, v36, v37
    v_cvt_pk_bf16_f32 v67, v38, v39
    s_mul_i32 s37, s36, 393216
    s_add_u32 s37, s37, s43
    buffer_store_dwordx4 v[56:59], v10, s[4:7], s37 offen offset:0 sc1
    buffer_store_dwordx4 v[60:63], v10, s[4:7], s37 offen offset:1024 sc1
    buffer_store_dwordx4 v[64:67], v10, s[4:7], s37 offen offset:2048 sc1
    s_cmp_ge_u32 s36, 1
    s_cbranch_scc1 ff_153
    s_waitcnt vmcnt(0)
    s_barrier
    s_cmp_lg_u32 s12, 0
    s_cbranch_scc1 ff_153
    v_mov_b32 v2, s36
    v_add_u32 v2, 1, v2
    s_mov_b64 exec, 1
    buffer_store_dword v2, v12, s[4:7], 0 offen sc1
    s_mov_b64 exec, -1
ff_153:
    s_mov_b32 s32, s45
    s_add_u32 s45, s45, 40960
    s_cmp_eq_u32 s45, 163840
    s_cselect_b32 s45, 0, s45
    s_cmp_eq_u32 s45, 81920
    s_cselect_b32 s45, 122880, s45
    s_mov_b32 s46, s32
    s_add_u32 s36, s36, 1
    s_cmp_lt_u32 s36, 64
    s_cbranch_scc1 proj_loop_150
    s_waitcnt vmcnt(0)
    s_barrier
    s_cmp_lg_u32 s12, 0
    s_cbranch_scc1 proj_end_151
    v_mov_b32 v2, s36
    s_mov_b64 exec, 1
    buffer_store_dword v2, v12, s[4:7], 0 offen sc1
proj_end_151:
    s_branch L_o
L_vu:
    s_bfe_u32 s14, s13, 0x30003
    s_lshl_b32 s14, s14, 2
    s_and_b32 s32, s13, 3
    s_add_u32 s14, s14, s32
    s_bfe_u32 s40, s13, 0x10002
    s_load_dwordx2 s[16:17], s[0:1], 32
    s_mov_b32 s18, 7864320
    s_mov_b32 s19, 0x20000
    s_load_dwordx2 s[24:25], s[0:1], 40
    s_mov_b32 s26, 7864320
    s_mov_b32 s27, 0x20000
    s_load_dwordx2 s[20:21], s[0:1], 0
    s_mov_b32 s22, 2621440
    s_mov_b32 s23, 0x20000
    v_add_u32 v16, 0, v1
    v_mul_u32_u24 v17, 2731, v16
    v_lshrrev_b32 v17, 16, v17
    v_mul_u32_u24 v18, 24, v17
    v_sub_u32 v16, v16, v18
    v_lshlrev_b32 v16, 4, v16
    v_mul_u32_u24 v17, 12288, v17
    v_add_u32 v9, v16, v17
    v_add_u32 v16, 64, v1
    v_mul_u32_u24 v17, 2731, v16
    v_lshrrev_b32 v17, 16, v17
    v_mul_u32_u24 v18, 24, v17
    v_sub_u32 v16, v16, v18
    v_lshlrev_b32 v16, 4, v16
    v_mul_u32_u24 v17, 12288, v17
    v_add_u32 v10, v16, v17
    v_add_u32 v16, 128, v1
    v_mul_u32_u24 v17, 2731, v16
    v_lshrrev_b32 v17, 16, v17
    v_mul_u32_u24 v18, 24, v17
    v_sub_u32 v16, v16, v18
    v_lshlrev_b32 v16, 4, v16
    v_mul_u32_u24 v17, 12288, v17
    v_add_u32 v11, v16, v17
    v_lshrrev_b32 v16, 4, v1
    v_lshlrev_b32 v16, 3, v16
    v_bfe_u32 v17, v1, 2, 2
    v_add_u32 v16, v16, v17
    v_mul_u32_u24 v16, 384, v16
    v_and_b32 v17, 3, v1
    v_lshlrev_b32 v17, 3, v17
    s_mul_i32 s32, s12, 96
    v_add3_u32 v12, v16, v17, s32
    v_lshlrev_b32 v4, 4, v1
    s_mul_i32 s41, s14, 384
    s_mul_i32 s32, s12, 196608
    s_add_u32 s41, s41, s32
    s_mul_i32 s42, s12, 6144
    s_mul_i32 s43, s14, 245760
    s_mul_i32 s44, s12, 5120
    s_add_u32 s43, s43, s44
    v_lshrrev_b32 v16, 2, v1
    v_mul_u32_u24 v16, 1280, v16
    v_and_b32 v17, 3, v1
    v_lshlrev_b32 v17, 3, v17
    s_mul_i32 s32, s12, 320
    v_add3_u32 v13, v16, v17, s32
    v_add_u32 v16, 0, v1
    v_mul_u32_u24 v17, 3277, v16
    v_lshrrev_b32 v17, 18, v17
    v_mul_u32_u24 v18, 80, v17
    v_sub_u32 v16, v16, v18
    s_lshl_b32 s32, s12, 3
    v_add_u32 v17, s32, v17
    v_and_b32 v18, 15, v17
    v_xor_b32 v16, v16, v18
    v_lshlrev_b32 v16, 4, v16
    v_lshrrev_b32 v19, 2, v18
    v_lshlrev_b32 v19, 3, v19
    v_and_b32 v20, 3, v18
    v_add_u32 v19, v19, v20
    v_lshrrev_b32 v20, 4, v17
    v_lshlrev_b32 v20, 2, v20
    v_add_u32 v19, v19, v20
    v_mul_u32_u24 v19, 1280, v19
    v_add_u32 v112, v16, v19
    v_add_u32 v16, 64, v1
    v_mul_u32_u24 v17, 3277, v16
    v_lshrrev_b32 v17, 18, v17
    v_mul_u32_u24 v18, 80, v17
    v_sub_u32 v16, v16, v18
    s_lshl_b32 s32, s12, 3
    v_add_u32 v17, s32, v17
    v_and_b32 v18, 15, v17
    v_xor_b32 v16, v16, v18
    v_lshlrev_b32 v16, 4, v16
    v_lshrrev_b32 v19, 2, v18
    v_lshlrev_b32 v19, 3, v19
    v_and_b32 v20, 3, v18
    v_add_u32 v19, v19, v20
    v_lshrrev_b32 v20, 4, v17
    v_lshlrev_b32 v20, 2, v20
    v_add_u32 v19, v19, v20
    v_mul_u32_u24 v19, 1280, v19
    v_add_u32 v113, v16, v19
    v_add_u32 v16, 128, v1
    v_mul_u32_u24 v17, 3277, v16
    v_lshrrev_b32 v17, 18, v17
    v_mul_u32_u24 v18, 80, v17
    v_sub_u32 v16, v16, v18
    s_lshl_b32 s32, s12, 3
    v_add_u32 v17, s32, v17
    v_and_b32 v18, 15, v17
    v_xor_b32 v16, v16, v18
    v_lshlrev_b32 v16, 4, v16
    v_lshrrev_b32 v19, 2, v18
    v_lshlrev_b32 v19, 3, v19
    v_and_b32 v20, 3, v18
    v_add_u32 v19, v19, v20
    v_lshrrev_b32 v20, 4, v17
    v_lshlrev_b32 v20, 2, v20
    v_add_u32 v19, v19, v20
    v_mul_u32_u24 v19, 1280, v19
    v_add_u32 v114, v16, v19
    v_add_u32 v16, 192, v1
    v_mul_u32_u24 v17, 3277, v16
    v_lshrrev_b32 v17, 18, v17
    v_mul_u32_u24 v18, 80, v17
    v_sub_u32 v16, v16, v18
    s_lshl_b32 s32, s12, 3
    v_add_u32 v17, s32, v17
    v_and_b32 v18, 15, v17
    v_xor_b32 v16, v16, v18
    v_lshlrev_b32 v16, 4, v16
    v_lshrrev_b32 v19, 2, v18
    v_lshlrev_b32 v19, 3, v19
    v_and_b32 v20, 3, v18
    v_add_u32 v19, v19, v20
    v_lshrrev_b32 v20, 4, v17
    v_lshlrev_b32 v20, 2, v20
    v_add_u32 v19, v19, v20
    v_mul_u32_u24 v19, 1280, v19
    v_add_u32 v115, v16, v19
    v_add_u32 v16, 256, v1
    v_mul_u32_u24 v17, 3277, v16
    v_lshrrev_b32 v17, 18, v17
    v_mul_u32_u24 v18, 80, v17
    v_sub_u32 v16, v16, v18
    s_lshl_b32 s32, s12, 3
    v_add_u32 v17, s32, v17
    v_and_b32 v18, 15, v17
    v_xor_b32 v16, v16, v18
    v_lshlrev_b32 v16, 4, v16
    v_lshrrev_b32 v19, 2, v18
    v_lshlrev_b32 v19, 3, v19
    v_and_b32 v20, 3, v18
    v_add_u32 v19, v19, v20
    v_lshrrev_b32 v20, 4, v17
    v_lshlrev_b32 v20, 2, v20
    v_add_u32 v19, v19, v20
    v_mul_u32_u24 v19, 1280, v19
    v_add_u32 v116, v16, v19
    v_add_u32 v16, 320, v1
    v_mul_u32_u24 v17, 3277, v16
    v_lshrrev_b32 v17, 18, v17
    v_mul_u32_u24 v18, 80, v17
    v_sub_u32 v16, v16, v18
    s_lshl_b32 s32, s12, 3
    v_add_u32 v17, s32, v17
    v_and_b32 v18, 15, v17
    v_xor_b32 v16, v16, v18
    v_lshlrev_b32 v16, 4, v16
    v_lshrrev_b32 v19, 2, v18
    v_lshlrev_b32 v19, 3, v19
    v_and_b32 v20, 3, v18
    v_add_u32 v19, v19, v20
    v_lshrrev_b32 v20, 4, v17
    v_lshlrev_b32 v20, 2, v20
    v_add_u32 v19, v19, v20
    v_mul_u32_u24 v19, 1280, v19
    v_add_u32 v117, v16, v19
    v_add_u32 v16, 384, v1
    v_mul_u32_u24 v17, 3277, v16
    v_lshrrev_b32 v17, 18, v17
    v_mul_u32_u24 v18, 80, v17
    v_sub_u32 v16, v16, v18
    s_lshl_b32 s32, s12, 3
    v_add_u32 v17, s32, v17
    v_and_b32 v18, 15, v17
    v_xor_b32 v16, v16, v18
    v_lshlrev_b32 v16, 4, v16
    v_lshrrev_b32 v19, 2, v18
    v_lshlrev_b32 v19, 3, v19
    v_and_b32 v20, 3, v18
    v_add_u32 v19, v19, v20
    v_lshrrev_b32 v20, 4, v17
    v_lshlrev_b32 v20, 2, v20
    v_add_u32 v19, v19, v20
    v_mul_u32_u24 v19, 1280, v19
    v_add_u32 v118, v16, v19
    v_add_u32 v16, 448, v1
    v_mul_u32_u24 v17, 3277, v16
    v_lshrrev_b32 v17, 18, v17
    v_mul_u32_u24 v18, 80, v17
    v_sub_u32 v16, v16, v18
    s_lshl_b32 s32, s12, 3
    v_add_u32 v17, s32, v17
    v_and_b32 v18, 15, v17
    v_xor_b32 v16, v16, v18
    v_lshlrev_b32 v16, 4, v16
    v_lshrrev_b32 v19, 2, v18
    v_lshlrev_b32 v19, 3, v19
    v_and_b32 v20, 3, v18
    v_add_u32 v19, v19, v20
    v_lshrrev_b32 v20, 4, v17
    v_lshlrev_b32 v20, 2, v20
    v_add_u32 v19, v19, v20
    v_mul_u32_u24 v19, 1280, v19
    v_add_u32 v119, v16, v19
    v_add_u32 v16, 512, v1
    v_mul_u32_u24 v17, 3277, v16
    v_lshrrev_b32 v17, 18, v17
    v_mul_u32_u24 v18, 80, v17
    v_sub_u32 v16, v16, v18
    s_lshl_b32 s32, s12, 3
    v_add_u32 v17, s32, v17
    v_and_b32 v18, 15, v17
    v_xor_b32 v16, v16, v18
    v_lshlrev_b32 v16, 4, v16
    v_lshrrev_b32 v19, 2, v18
    v_lshlrev_b32 v19, 3, v19
    v_and_b32 v20, 3, v18
    v_add_u32 v19, v19, v20
    v_lshrrev_b32 v20, 4, v17
    v_lshlrev_b32 v20, 2, v20
    v_add_u32 v19, v19, v20
    v_mul_u32_u24 v19, 1280, v19
    v_add_u32 v120, v16, v19
    v_add_u32 v16, 576, v1
    v_mul_u32_u24 v17, 3277, v16
    v_lshrrev_b32 v17, 18, v17
    v_mul_u32_u24 v18, 80, v17
    v_sub_u32 v16, v16, v18
    s_lshl_b32 s32, s12, 3
    v_add_u32 v17, s32, v17
    v_and_b32 v18, 15, v17
    v_xor_b32 v16, v16, v18
    v_lshlrev_b32 v16, 4, v16
    v_lshrrev_b32 v19, 2, v18
    v_lshlrev_b32 v19, 3, v19
    v_and_b32 v20, 3, v18
    v_add_u32 v19, v19, v20
    v_lshrrev_b32 v20, 4, v17
    v_lshlrev_b32 v20, 2, v20
    v_add_u32 v19, v19, v20
    v_mul_u32_u24 v19, 1280, v19
    v_add_u32 v121, v16, v19
    v_and_b32 v16, 15, v1
    v_lshrrev_b32 v17, 4, v1
    v_and_b32 v18, 3, v16
    v_xor_b32 v17, v17, v18
    v_and_b32 v18, 12, v16
    v_mul_u32_u24 v16, 1280, v16
    v_add_u32 v16, 122880, v16
    v_xor_b32 v19, 0, v18
    v_add_u32 v19, v19, v17
    v_lshlrev_b32 v19, 4, v19
    v_add_u32 v122, v19, v16
    v_xor_b32 v19, 4, v18
    v_add_u32 v19, v19, v17
    v_lshlrev_b32 v19, 4, v19
    v_add_u32 v123, v19, v16
    v_xor_b32 v19, 8, v18
    v_add_u32 v19, v19, v17
    v_lshlrev_b32 v19, 4, v19
    v_add_u32 v124, v19, v16
    v_xor_b32 v19, 12, v18
    v_add_u32 v19, v19, v17
    v_lshlrev_b32 v19, 4, v19
    v_add_u32 v125, v19, v16
    s_mul_i32 s46, s12, 10240
    s_add_u32 s46, s46, 122880
    s_mov_b32 s36, s40
    s_mul_i32 s45, s36, 40960
    s_waitcnt lgkmcnt(0)
    s_add_u32 m0, s46, 0
    s_nop 0
    buffer_load_dwordx4 v112, s[20:23], s45 offen lds
    s_add_u32 m0, s46, 1024
    s_nop 0
    buffer_load_dwordx4 v113, s[20:23], s45 offen lds
    s_add_u32 m0, s46, 2048
    s_nop 0
    buffer_load_dwordx4 v114, s[20:23], s45 offen lds
    s_add_u32 m0, s46, 3072
    s_nop 0
    buffer_load_dwordx4 v115, s[20:23], s45 offen lds
    s_add_u32 m0, s46, 4096
    s_nop 0
    buffer_load_dwordx4 v116, s[20:23], s45 offen lds
    s_add_u32 m0, s46, 5120
    s_nop 0
    buffer_load_dwordx4 v117, s[20:23], s45 offen lds
    s_add_u32 m0, s46, 6144
    s_nop 0
    buffer_load_dwordx4 v118, s[20:23], s45 offen lds
    s_add_u32 m0, s46, 7168
    s_nop 0
    buffer_load_dwordx4 v119, s[20:23], s45 offen lds
    s_add_u32 m0, s46, 8192
    s_nop 0
    buffer_load_dwordx4 v120, s[20:23], s45 offen lds
    s_add_u32 m0, s46, 9216
    s_nop 0
    buffer_load_dwordx4 v121, s[20:23], s45 offen lds
    s_add_u32 m0, s42, 0
    s_add_u32 s37, s41, 0
    buffer_load_dwordx4 v9, s[16:19], s37 offen lds
    s_add_u32 m0, s42, 1024
    s_add_u32 s37, s41, 0
    buffer_load_dwordx4 v10, s[16:19], s37 offen lds
    s_add_u32 m0, s42, 2048
    s_add_u32 s37, s41, 0
    buffer_load_dwordx4 v11, s[16:19], s37 offen lds
    s_add_u32 m0, s42, 3072
    s_add_u32 s37, s41, 98304
    buffer_load_dwordx4 v9, s[16:19], s37 offen lds
    s_add_u32 m0, s42, 4096
    s_add_u32 s37, s41, 98304
    buffer_load_dwordx4 v10, s[16:19], s37 offen lds
    s_add_u32 m0, s42, 5120
    s_add_u32 s37, s41, 98304
    buffer_load_dwordx4 v11, s[16:19], s37 offen lds
    s_add_u32 m0, s44, 24576
    s_add_u32 s37, s43, 0
    buffer_load_dwordx4 v4, s[24:27], s37 offen offset:0 lds
    buffer_load_dwordx4 v4, s[24:27], s37 offen offset:1024 lds
    buffer_load_dwordx4 v4, s[24:27], s37 offen offset:2048 lds
    buffer_load_dwordx4 v4, s[24:27], s37 offen offset:3072 lds
    s_add_u32 m0, m0, 4096
    s_add_u32 s37, s37, 4096
    buffer_load_dwordx4 v4, s[24:27], s37 offen lds
    s_add_u32 m0, s42, 45056
    s_add_u32 s37, s41, 786432
    buffer_load_dwordx4 v9, s[16:19], s37 offen lds
    s_add_u32 m0, s42, 46080
    s_add_u32 s37, s41, 786432
    buffer_load_dwordx4 v10, s[16:19], s37 offen lds
    s_add_u32 m0, s42, 47104
    s_add_u32 s37, s41, 786432
    buffer_load_dwordx4 v11, s[16:19], s37 offen lds
    s_add_u32 m0, s42, 48128
    s_add_u32 s37, s41, 884736
    buffer_load_dwordx4 v9, s[16:19], s37 offen lds
    s_add_u32 m0, s42, 49152
    s_add_u32 s37, s41, 884736
    buffer_load_dwordx4 v10, s[16:19], s37 offen lds
    s_add_u32 m0, s42, 50176
    s_add_u32 s37, s41, 884736
    buffer_load_dwordx4 v11, s[16:19], s37 offen lds
    s_add_u32 m0, s44, 69632
    s_add_u32 s37, s43, 20480
    buffer_load_dwordx4 v4, s[24:27], s37 offen offset:0 lds
    buffer_load_dwordx4 v4, s[24:27], s37 offen offset:1024 lds
    buffer_load_dwordx4 v4, s[24:27], s37 offen offset:2048 lds
    buffer_load_dwordx4 v4, s[24:27], s37 offen offset:3072 lds
    s_add_u32 m0, m0, 4096
    s_add_u32 s37, s37, 4096
    buffer_load_dwordx4 v4, s[24:27], s37 offen lds
    s_add_u32 m0, s42, 90112
    s_add_u32 s37, s41, 1572864
    buffer_load_dwordx4 v9, s[16:19], s37 offen lds
    s_add_u32 m0, s42, 91136
    s_add_u32 s37, s41, 1572864
    buffer_load_dwordx4 v10, s[16:19], s37 offen lds
    s_add_u32 m0, s42, 92160
    s_add_u32 s37, s41, 1572864
    buffer_load_dwordx4 v11, s[16:19], s37 offen lds
    s_add_u32 m0, s42, 93184
    s_add_u32 s37, s41, 1671168
    buffer_load_dwordx4 v9, s[16:19], s37 offen lds
    s_add_u32 m0, s42, 94208
    s_add_u32 s37, s41, 1671168
    buffer_load_dwordx4 v10, s[16:19], s37 offen lds
    s_add_u32 m0, s42, 95232
    s_add_u32 s37, s41, 1671168
    buffer_load_dwordx4 v11, s[16:19], s37 offen lds
    s_waitcnt vmcnt(22)
    s_barrier
    v_add_u32 v3, 0, v12
    ds_read_b64_tr_b16 a[0:1], v3 offset:0
    ds_read_b64_tr_b16 a[2:3], v3 offset:1536
    ds_read_b64_tr_b16 a[12:13], v3 offset:12288
    ds_read_b64_tr_b16 a[14:15], v3 offset:13824
    ds_read_b64_tr_b16 a[4:5], v3 offset:32
    ds_read_b64_tr_b16 a[6:7], v3 offset:1568
    ds_read_b64_tr_b16 v[16:17], v3 offset:12320
    ds_read_b64_tr_b16 v[18:19], v3 offset:13856
    ds_read_b64_tr_b16 a[8:9], v3 offset:64
    ds_read_b64_tr_b16 a[10:11], v3 offset:1600
    ds_read_b64_tr_b16 a[16:17], v3 offset:12352
    ds_read_b64_tr_b16 a[18:19], v3 offset:13888
    s_waitcnt lgkmcnt(0)
    s_waitcnt vmcnt(17)
    s_barrier
    v_add_u32 v3, 24576, v13
    ds_read_b64_tr_b16 a[192:193], v3 offset:0
    ds_read_b64_tr_b16 a[212:213], v3 offset:32
    ds_read_b64_tr_b16 a[232:233], v3 offset:64
    ds_read_b64_tr_b16 a[252:253], v3 offset:96
    ds_read_b64_tr_b16 v[80:81], v3 offset:128
    ds_read_b64_tr_b16 v[160:161], v3 offset:160
    ds_read_b64_tr_b16 v[180:181], v3 offset:192
    ds_read_b64_tr_b16 v[200:201], v3 offset:224
    ds_read_b64_tr_b16 v[220:221], v3 offset:256
    ds_read_b64_tr_b16 v[104:105], v3 offset:288
    s_add_u32 m0, s44, 0
    s_add_u32 s37, s43, 40960
    buffer_load_dwordx4 v4, s[24:27], s37 offen offset:0 lds
    buffer_load_dwordx4 v4, s[24:27], s37 offen offset:1024 lds
    buffer_load_dwordx4 v4, s[24:27], s37 offen offset:2048 lds
    buffer_load_dwordx4 v4, s[24:27], s37 offen offset:3072 lds
    s_add_u32 m0, m0, 4096
    s_add_u32 s37, s37, 4096
    buffer_load_dwordx4 v4, s[24:27], s37 offen lds
    s_waitcnt lgkmcnt(0)
    s_waitcnt vmcnt(16)
    s_barrier
    v_add_u32 v3, 45056, v12
    ds_read_b64_tr_b16 a[20:21], v3 offset:0
    ds_read_b64_tr_b16 a[22:23], v3 offset:1536
    ds_read_b64_tr_b16 v[20:21], v3 offset:12288
    ds_read_b64_tr_b16 v[22:23], v3 offset:13824
    ds_read_b64_tr_b16 a[24:25], v3 offset:32
    ds_read_b64_tr_b16 a[26:27], v3 offset:1568
    ds_read_b64_tr_b16 a[32:33], v3 offset:12320
    ds_read_b64_tr_b16 a[34:35], v3 offset:13856
    ds_read_b64_tr_b16 a[28:29], v3 offset:64
    ds_read_b64_tr_b16 a[30:31], v3 offset:1600
    ds_read_b64_tr_b16 a[36:37], v3 offset:12352
    ds_read_b64_tr_b16 a[38:39], v3 offset:13888
    s_add_u32 m0, s42, 20480
    s_add_u32 s37, s41, 2359296
    buffer_load_dwordx4 v9, s[16:19], s37 offen lds
    s_add_u32 m0, s42, 21504
    s_add_u32 s37, s41, 2359296
    buffer_load_dwordx4 v10, s[16:19], s37 offen lds
    s_add_u32 m0, s42, 22528
    s_add_u32 s37, s41, 2359296
    buffer_load_dwordx4 v11, s[16:19], s37 offen lds
    s_add_u32 m0, s42, 23552
    s_add_u32 s37, s41, 2457600
    buffer_load_dwordx4 v9, s[16:19], s37 offen lds
    s_add_u32 m0, s42, 24576
    s_add_u32 s37, s41, 2457600
    buffer_load_dwordx4 v10, s[16:19], s37 offen lds
    s_add_u32 m0, s42, 25600
    s_add_u32 s37, s41, 2457600
    buffer_load_dwordx4 v11, s[16:19], s37 offen lds
    s_waitcnt lgkmcnt(0)
    s_waitcnt vmcnt(17)
    s_barrier
    v_add_u32 v3, 69632, v13
    ds_read_b64_tr_b16 a[194:195], v3 offset:0
    ds_read_b64_tr_b16 a[214:215], v3 offset:32
    ds_read_b64_tr_b16 a[234:235], v3 offset:64
    ds_read_b64_tr_b16 a[254:255], v3 offset:96
    ds_read_b64_tr_b16 v[82:83], v3 offset:128
    ds_read_b64_tr_b16 v[162:163], v3 offset:160
    ds_read_b64_tr_b16 v[182:183], v3 offset:192
    ds_read_b64_tr_b16 v[202:203], v3 offset:224
    ds_read_b64_tr_b16 v[222:223], v3 offset:256
    ds_read_b64_tr_b16 v[106:107], v3 offset:288
    s_add_u32 m0, s44, 45056
    s_add_u32 s37, s43, 61440
    buffer_load_dwordx4 v4, s[24:27], s37 offen offset:0 lds
    buffer_load_dwordx4 v4, s[24:27], s37 offen offset:1024 lds
    buffer_load_dwordx4 v4, s[24:27], s37 offen offset:2048 lds
    buffer_load_dwordx4 v4, s[24:27], s37 offen offset:3072 lds
    s_add_u32 m0, m0, 4096
    s_add_u32 s37, s37, 4096
    buffer_load_dwordx4 v4, s[24:27], s37 offen lds
    s_waitcnt lgkmcnt(0)
    s_waitcnt vmcnt(16)
    s_barrier
    v_add_u32 v3, 90112, v12
    ds_read_b64_tr_b16 a[40:41], v3 offset:0
    ds_read_b64_tr_b16 a[42:43], v3 offset:1536
    ds_read_b64_tr_b16 a[48:49], v3 offset:12288
    ds_read_b64_tr_b16 a[50:51], v3 offset:13824
    ds_read_b64_tr_b16 a[44:45], v3 offset:32
    ds_read_b64_tr_b16 a[46:47], v3 offset:1568
    ds_read_b64_tr_b16 a[52:53], v3 offset:12320
    ds_read_b64_tr_b16 a[54:55], v3 offset:13856
    ds_read_b64_tr_b16 v[24:25], v3 offset:64
    ds_read_b64_tr_b16 v[26:27], v3 offset:1600
    ds_read_b64_tr_b16 a[56:57], v3 offset:12352
    ds_read_b64_tr_b16 a[58:59], v3 offset:13888
    s_add_u32 m0, s42, 65536
    s_add_u32 s37, s41, 3145728
    buffer_load_dwordx4 v9, s[16:19], s37 offen lds
    s_add_u32 m0, s42, 66560
    s_add_u32 s37, s41, 3145728
    buffer_load_dwordx4 v10, s[16:19], s37 offen lds
    s_add_u32 m0, s42, 67584
    s_add_u32 s37, s41, 3145728
    buffer_load_dwordx4 v11, s[16:19], s37 offen lds
    s_add_u32 m0, s42, 68608
    s_add_u32 s37, s41, 3244032
    buffer_load_dwordx4 v9, s[16:19], s37 offen lds
    s_add_u32 m0, s42, 69632
    s_add_u32 s37, s41, 3244032
    buffer_load_dwordx4 v10, s[16:19], s37 offen lds
    s_add_u32 m0, s42, 70656
    s_add_u32 s37, s41, 3244032
    buffer_load_dwordx4 v11, s[16:19], s37 offen lds
    s_waitcnt lgkmcnt(0)
    s_waitcnt vmcnt(17)
    s_barrier
    v_add_u32 v3, 0, v13
    ds_read_b64_tr_b16 v[64:65], v3 offset:0
    ds_read_b64_tr_b16 a[224:225], v3 offset:32
    ds_read_b64_tr_b16 a[244:245], v3 offset:64
    ds_read_b64_tr_b16 v[136:137], v3 offset:96
    ds_read_b64_tr_b16 v[156:157], v3 offset:128
    ds_read_b64_tr_b16 v[88:89], v3 offset:160
    ds_read_b64_tr_b16 v[192:193], v3 offset:192
    ds_read_b64_tr_b16 v[212:213], v3 offset:224
    ds_read_b64_tr_b16 v[232:233], v3 offset:256
    ds_read_b64_tr_b16 v[252:253], v3 offset:288
    s_add_u32 m0, s44, 90112
    s_add_u32 s37, s43, 81920
    buffer_load_dwordx4 v4, s[24:27], s37 offen offset:0 lds
    buffer_load_dwordx4 v4, s[24:27], s37 offen offset:1024 lds
    buffer_load_dwordx4 v4, s[24:27], s37 offen offset:2048 lds
    buffer_load_dwordx4 v4, s[24:27], s37 offen offset:3072 lds
    s_add_u32 m0, m0, 4096
    s_add_u32 s37, s37, 4096
    buffer_load_dwordx4 v4, s[24:27], s37 offen lds
    s_waitcnt lgkmcnt(0)
    s_waitcnt vmcnt(16)
    s_barrier
    v_add_u32 v3, 20480, v12
    ds_read_b64_tr_b16 a[60:61], v3 offset:0
    ds_read_b64_tr_b16 a[62:63], v3 offset:1536
    ds_read_b64_tr_b16 a[68:69], v3 offset:12288
    ds_read_b64_tr_b16 a[70:71], v3 offset:13824
    ds_read_b64_tr_b16 v[28:29], v3 offset:32
    ds_read_b64_tr_b16 v[30:31], v3 offset:1568
    ds_read_b64_tr_b16 a[72:73], v3 offset:12320
    ds_read_b64_tr_b16 a[74:75], v3 offset:13856
    ds_read_b64_tr_b16 a[64:65], v3 offset:64
    ds_read_b64_tr_b16 a[66:67], v3 offset:1600
    ds_read_b64_tr_b16 a[76:77], v3 offset:12352
    ds_read_b64_tr_b16 a[78:79], v3 offset:13888
    s_waitcnt lgkmcnt(0)
    s_waitcnt vmcnt(11)
    s_barrier
    v_add_u32 v3, 45056, v13
    ds_read_b64_tr_b16 a[196:197], v3 offset:0
    ds_read_b64_tr_b16 a[216:217], v3 offset:32
    ds_read_b64_tr_b16 a[236:237], v3 offset:64
    ds_read_b64_tr_b16 v[76:77], v3 offset:96
    ds_read_b64_tr_b16 v[144:145], v3 offset:128
    ds_read_b64_tr_b16 v[164:165], v3 offset:160
    ds_read_b64_tr_b16 v[184:185], v3 offset:192
    ds_read_b64_tr_b16 v[204:205], v3 offset:224
    ds_read_b64_tr_b16 v[100:101], v3 offset:256
    ds_read_b64_tr_b16 v[240:241], v3 offset:288
    s_add_u32 m0, s42, 0
    s_add_u32 s37, s41, 3932160
    buffer_load_dwordx4 v9, s[16:19], s37 offen lds
    s_add_u32 m0, s42, 1024
    s_add_u32 s37, s41, 3932160
    buffer_load_dwordx4 v10, s[16:19], s37 offen lds
    s_add_u32 m0, s42, 2048
    s_add_u32 s37, s41, 3932160
    buffer_load_dwordx4 v11, s[16:19], s37 offen lds
    s_add_u32 m0, s42, 3072
    s_add_u32 s37, s41, 4030464
    buffer_load_dwordx4 v9, s[16:19], s37 offen lds
    s_add_u32 m0, s42, 4096
    s_add_u32 s37, s41, 4030464
    buffer_load_dwordx4 v10, s[16:19], s37 offen lds
    s_add_u32 m0, s42, 5120
    s_add_u32 s37, s41, 4030464
    buffer_load_dwordx4 v11, s[16:19], s37 offen lds
    s_add_u32 m0, s44, 24576
    s_add_u32 s37, s43, 102400
    buffer_load_dwordx4 v4, s[24:27], s37 offen offset:0 lds
    buffer_load_dwordx4 v4, s[24:27], s37 offen offset:1024 lds
    buffer_load_dwordx4 v4, s[24:27], s37 offen offset:2048 lds
    buffer_load_dwordx4 v4, s[24:27], s37 offen offset:3072 lds
    s_add_u32 m0, m0, 4096
    s_add_u32 s37, s37, 4096
    buffer_load_dwordx4 v4, s[24:27], s37 offen lds
    s_waitcnt lgkmcnt(0)
    s_waitcnt vmcnt(16)
    s_barrier
    v_add_u32 v3, 65536, v12
    ds_read_b64_tr_b16 v[32:33], v3 offset:0
    ds_read_b64_tr_b16 v[34:35], v3 offset:1536
    ds_read_b64_tr_b16 a[88:89], v3 offset:12288
    ds_read_b64_tr_b16 a[90:91], v3 offset:13824
    ds_read_b64_tr_b16 a[80:81], v3 offset:32
    ds_read_b64_tr_b16 a[82:83], v3 offset:1568
    ds_read_b64_tr_b16 a[92:93], v3 offset:12320
    ds_read_b64_tr_b16 a[94:95], v3 offset:13856
    ds_read_b64_tr_b16 a[84:85], v3 offset:64
    ds_read_b64_tr_b16 a[86:87], v3 offset:1600
    ds_read_b64_tr_b16 v[36:37], v3 offset:12352
    ds_read_b64_tr_b16 v[38:39], v3 offset:13888
    s_waitcnt lgkmcnt(0)
    s_waitcnt vmcnt(11)
    s_barrier
    v_add_u32 v3, 90112, v13
    ds_read_b64_tr_b16 a[198:199], v3 offset:0
    ds_read_b64_tr_b16 a[218:219], v3 offset:32
    ds_read_b64_tr_b16 a[238:239], v3 offset:64
    ds_read_b64_tr_b16 v[78:79], v3 offset:96
    ds_read_b64_tr_b16 v[146:147], v3 offset:128
    ds_read_b64_tr_b16 v[166:167], v3 offset:160
    ds_read_b64_tr_b16 v[186:187], v3 offset:192
    ds_read_b64_tr_b16 v[206:207], v3 offset:224
    ds_read_b64_tr_b16 v[102:103], v3 offset:256
    ds_read_b64_tr_b16 v[242:243], v3 offset:288
    s_add_u32 m0, s42, 45056
    s_add_u32 s37, s41, 4718592
    buffer_load_dwordx4 v9, s[16:19], s37 offen lds
    s_add_u32 m0, s42, 46080
    s_add_u32 s37, s41, 4718592
    buffer_load_dwordx4 v10, s[16:19], s37 offen lds
    s_add_u32 m0, s42, 47104
    s_add_u32 s37, s41, 4718592
    buffer_load_dwordx4 v11, s[16:19], s37 offen lds
    s_add_u32 m0, s42, 48128
    s_add_u32 s37, s41, 4816896
    buffer_load_dwordx4 v9, s[16:19], s37 offen lds
    s_add_u32 m0, s42, 49152
    s_add_u32 s37, s41, 4816896
    buffer_load_dwordx4 v10, s[16:19], s37 offen lds
    s_add_u32 m0, s42, 50176
    s_add_u32 s37, s41, 4816896
    buffer_load_dwordx4 v11, s[16:19], s37 offen lds
    s_add_u32 m0, s44, 69632
    s_add_u32 s37, s43, 122880
    buffer_load_dwordx4 v4, s[24:27], s37 offen offset:0 lds
    buffer_load_dwordx4 v4, s[24:27], s37 offen offset:1024 lds
    buffer_load_dwordx4 v4, s[24:27], s37 offen offset:2048 lds
    buffer_load_dwordx4 v4, s[24:27], s37 offen offset:3072 lds
    s_add_u32 m0, m0, 4096
    s_add_u32 s37, s37, 4096
    buffer_load_dwordx4 v4, s[24:27], s37 offen lds
    s_waitcnt lgkmcnt(0)
    s_waitcnt vmcnt(16)
    s_barrier
    v_add_u32 v3, 0, v12
    ds_read_b64_tr_b16 a[96:97], v3 offset:0
    ds_read_b64_tr_b16 a[98:99], v3 offset:1536
    ds_read_b64_tr_b16 a[108:109], v3 offset:12288
    ds_read_b64_tr_b16 a[110:111], v3 offset:13824
    ds_read_b64_tr_b16 a[100:101], v3 offset:32
    ds_read_b64_tr_b16 a[102:103], v3 offset:1568
    ds_read_b64_tr_b16 v[40:41], v3 offset:12320
    ds_read_b64_tr_b16 v[42:43], v3 offset:13856
    ds_read_b64_tr_b16 a[104:105], v3 offset:64
    ds_read_b64_tr_b16 a[106:107], v3 offset:1600
    ds_read_b64_tr_b16 a[112:113], v3 offset:12352
    ds_read_b64_tr_b16 a[114:115], v3 offset:13888
    s_add_u32 m0, s42, 90112
    s_add_u32 s37, s41, 5505024
    buffer_load_dwordx4 v9, s[16:19], s37 offen lds
    s_add_u32 m0, s42, 91136
    s_add_u32 s37, s41, 5505024
    buffer_load_dwordx4 v10, s[16:19], s37 offen lds
    s_add_u32 m0, s42, 92160
    s_add_u32 s37, s41, 5505024
    buffer_load_dwordx4 v11, s[16:19], s37 offen lds
    s_add_u32 m0, s42, 93184
    s_add_u32 s37, s41, 5603328
    buffer_load_dwordx4 v9, s[16:19], s37 offen lds
    s_add_u32 m0, s42, 94208
    s_add_u32 s37, s41, 5603328
    buffer_load_dwordx4 v10, s[16:19], s37 offen lds
    s_add_u32 m0, s42, 95232
    s_add_u32 s37, s41, 5603328
    buffer_load_dwordx4 v11, s[16:19], s37 offen lds
    s_waitcnt lgkmcnt(0)
    s_waitcnt vmcnt(17)
    s_barrier
    v_add_u32 v3, 24576, v13
    ds_read_b64_tr_b16 v[66:67], v3 offset:0
    ds_read_b64_tr_b16 a[226:227], v3 offset:32
    ds_read_b64_tr_b16 a[246:247], v3 offset:64
    ds_read_b64_tr_b16 v[138:139], v3 offset:96
    ds_read_b64_tr_b16 v[158:159], v3 offset:128
    ds_read_b64_tr_b16 v[90:91], v3 offset:160
    ds_read_b64_tr_b16 v[194:195], v3 offset:192
    ds_read_b64_tr_b16 v[214:215], v3 offset:224
    ds_read_b64_tr_b16 v[234:235], v3 offset:256
    ds_read_b64_tr_b16 v[254:255], v3 offset:288
    s_add_u32 m0, s44, 0
    s_add_u32 s37, s43, 143360
    buffer_load_dwordx4 v4, s[24:27], s37 offen offset:0 lds
    buffer_load_dwordx4 v4, s[24:27], s37 offen offset:1024 lds
    buffer_load_dwordx4 v4, s[24:27], s37 offen offset:2048 lds
    buffer_load_dwordx4 v4, s[24:27], s37 offen offset:3072 lds
    s_add_u32 m0, m0, 4096
    s_add_u32 s37, s37, 4096
    buffer_load_dwordx4 v4, s[24:27], s37 offen lds
    s_waitcnt lgkmcnt(0)
    s_waitcnt vmcnt(16)
    s_barrier
    v_add_u32 v3, 45056, v12
    ds_read_b64_tr_b16 a[116:117], v3 offset:0
    ds_read_b64_tr_b16 a[118:119], v3 offset:1536
    ds_read_b64_tr_b16 v[44:45], v3 offset:12288
    ds_read_b64_tr_b16 v[46:47], v3 offset:13824
    ds_read_b64_tr_b16 a[120:121], v3 offset:32
    ds_read_b64_tr_b16 a[122:123], v3 offset:1568
    ds_read_b64_tr_b16 a[128:129], v3 offset:12320
    ds_read_b64_tr_b16 a[130:131], v3 offset:13856
    ds_read_b64_tr_b16 a[124:125], v3 offset:64
    ds_read_b64_tr_b16 a[126:127], v3 offset:1600
    ds_read_b64_tr_b16 a[132:133], v3 offset:12352
    ds_read_b64_tr_b16 a[134:135], v3 offset:13888
    s_add_u32 m0, s42, 20480
    s_add_u32 s37, s41, 6291456
    buffer_load_dwordx4 v9, s[16:19], s37 offen lds
    s_add_u32 m0, s42, 21504
    s_add_u32 s37, s41, 6291456
    buffer_load_dwordx4 v10, s[16:19], s37 offen lds
    s_add_u32 m0, s42, 22528
    s_add_u32 s37, s41, 6291456
    buffer_load_dwordx4 v11, s[16:19], s37 offen lds
    s_add_u32 m0, s42, 23552
    s_add_u32 s37, s41, 6389760
    buffer_load_dwordx4 v9, s[16:19], s37 offen lds
    s_add_u32 m0, s42, 24576
    s_add_u32 s37, s41, 6389760
    buffer_load_dwordx4 v10, s[16:19], s37 offen lds
    s_add_u32 m0, s42, 25600
    s_add_u32 s37, s41, 6389760
    buffer_load_dwordx4 v11, s[16:19], s37 offen lds
    s_waitcnt lgkmcnt(0)
    s_waitcnt vmcnt(17)
    s_barrier
    v_add_u32 v3, 69632, v13
    ds_read_b64_tr_b16 a[200:201], v3 offset:0
    ds_read_b64_tr_b16 a[220:221], v3 offset:32
    ds_read_b64_tr_b16 v[72:73], v3 offset:64
    ds_read_b64_tr_b16 v[128:129], v3 offset:96
    ds_read_b64_tr_b16 v[148:149], v3 offset:128
    ds_read_b64_tr_b16 v[168:169], v3 offset:160
    ds_read_b64_tr_b16 v[188:189], v3 offset:192
    ds_read_b64_tr_b16 v[96:97], v3 offset:224
    ds_read_b64_tr_b16 v[224:225], v3 offset:256
    ds_read_b64_tr_b16 v[244:245], v3 offset:288
    s_add_u32 m0, s44, 45056
    s_add_u32 s37, s43, 163840
    buffer_load_dwordx4 v4, s[24:27], s37 offen offset:0 lds
    buffer_load_dwordx4 v4, s[24:27], s37 offen offset:1024 lds
    buffer_load_dwordx4 v4, s[24:27], s37 offen offset:2048 lds
    buffer_load_dwordx4 v4, s[24:27], s37 offen offset:3072 lds
    s_add_u32 m0, m0, 4096
    s_add_u32 s37, s37, 4096
    buffer_load_dwordx4 v4, s[24:27], s37 offen lds
    s_waitcnt lgkmcnt(0)
    s_waitcnt vmcnt(16)
    s_barrier
    v_add_u32 v3, 90112, v12
    ds_read_b64_tr_b16 a[136:137], v3 offset:0
    ds_read_b64_tr_b16 a[138:139], v3 offset:1536
    ds_read_b64_tr_b16 a[144:145], v3 offset:12288
    ds_read_b64_tr_b16 a[146:147], v3 offset:13824
    ds_read_b64_tr_b16 a[140:141], v3 offset:32
    ds_read_b64_tr_b16 a[142:143], v3 offset:1568
    ds_read_b64_tr_b16 a[148:149], v3 offset:12320
    ds_read_b64_tr_b16 a[150:151], v3 offset:13856
    ds_read_b64_tr_b16 v[48:49], v3 offset:64
    ds_read_b64_tr_b16 v[50:51], v3 offset:1600
    ds_read_b64_tr_b16 a[152:153], v3 offset:12352
    ds_read_b64_tr_b16 a[154:155], v3 offset:13888
    s_add_u32 m0, s42, 65536
    s_add_u32 s37, s41, 7077888
    buffer_load_dwordx4 v9, s[16:19], s37 offen lds
    s_add_u32 m0, s42, 66560
    s_add_u32 s37, s41, 7077888
    buffer_load_dwordx4 v10, s[16:19], s37 offen lds
    s_add_u32 m0, s42, 67584
    s_add_u32 s37, s41, 7077888
    buffer_load_dwordx4 v11, s[16:19], s37 offen lds
    s_add_u32 m0, s42, 68608
    s_add_u32 s37, s41, 7176192
    buffer_load_dwordx4 v9, s[16:19], s37 offen lds
    s_add_u32 m0, s42, 69632
    s_add_u32 s37, s41, 7176192
    buffer_load_dwordx4 v10, s[16:19], s37 offen lds
    s_add_u32 m0, s42, 70656
    s_add_u32 s37, s41, 7176192
    buffer_load_dwordx4 v11, s[16:19], s37 offen lds
    s_waitcnt lgkmcnt(0)
    s_waitcnt vmcnt(17)
    s_barrier
    v_add_u32 v3, 0, v13
    ds_read_b64_tr_b16 a[202:203], v3 offset:0
    ds_read_b64_tr_b16 a[222:223], v3 offset:32
    ds_read_b64_tr_b16 v[74:75], v3 offset:64
    ds_read_b64_tr_b16 v[130:131], v3 offset:96
    ds_read_b64_tr_b16 v[150:151], v3 offset:128
    ds_read_b64_tr_b16 v[170:171], v3 offset:160
    ds_read_b64_tr_b16 v[190:191], v3 offset:192
    ds_read_b64_tr_b16 v[98:99], v3 offset:224
    ds_read_b64_tr_b16 v[226:227], v3 offset:256
    ds_read_b64_tr_b16 v[246:247], v3 offset:288
    s_add_u32 m0, s44, 90112
    s_add_u32 s37, s43, 184320
    buffer_load_dwordx4 v4, s[24:27], s37 offen offset:0 lds
    buffer_load_dwordx4 v4, s[24:27], s37 offen offset:1024 lds
    buffer_load_dwordx4 v4, s[24:27], s37 offen offset:2048 lds
    buffer_load_dwordx4 v4, s[24:27], s37 offen offset:3072 lds
    s_add_u32 m0, m0, 4096
    s_add_u32 s37, s37, 4096
    buffer_load_dwordx4 v4, s[24:27], s37 offen lds
    s_waitcnt lgkmcnt(0)
    s_waitcnt vmcnt(16)
    s_barrier
    v_add_u32 v3, 20480, v12
    ds_read_b64_tr_b16 a[156:157], v3 offset:0
    ds_read_b64_tr_b16 a[158:159], v3 offset:1536
    ds_read_b64_tr_b16 a[164:165], v3 offset:12288
    ds_read_b64_tr_b16 a[166:167], v3 offset:13824
    ds_read_b64_tr_b16 v[52:53], v3 offset:32
    ds_read_b64_tr_b16 v[54:55], v3 offset:1568
    ds_read_b64_tr_b16 a[168:169], v3 offset:12320
    ds_read_b64_tr_b16 a[170:171], v3 offset:13856
    ds_read_b64_tr_b16 a[160:161], v3 offset:64
    ds_read_b64_tr_b16 a[162:163], v3 offset:1600
    ds_read_b64_tr_b16 a[172:173], v3 offset:12352
    ds_read_b64_tr_b16 a[174:175], v3 offset:13888
    s_add_u32 m0, s44, 0
    s_add_u32 s37, s43, 204800
    buffer_load_dwordx4 v4, s[24:27], s37 offen offset:0 lds
    buffer_load_dwordx4 v4, s[24:27], s37 offen offset:1024 lds
    buffer_load_dwordx4 v4, s[24:27], s37 offen offset:2048 lds
    buffer_load_dwordx4 v4, s[24:27], s37 offen offset:3072 lds
    s_add_u32 m0, m0, 4096
    s_add_u32 s37, s37, 4096
    buffer_load_dwordx4 v4, s[24:27], s37 offen lds
    s_waitcnt lgkmcnt(0)
    s_waitcnt vmcnt(16)
    s_barrier
    v_add_u32 v3, 45056, v13
    ds_read_b64_tr_b16 a[208:209], v3 offset:0
    ds_read_b64_tr_b16 a[228:229], v3 offset:32
    ds_read_b64_tr_b16 a[248:249], v3 offset:64
    ds_read_b64_tr_b16 v[140:141], v3 offset:96
    ds_read_b64_tr_b16 v[84:85], v3 offset:128
    ds_read_b64_tr_b16 v[176:177], v3 offset:160
    ds_read_b64_tr_b16 v[196:197], v3 offset:192
    ds_read_b64_tr_b16 v[216:217], v3 offset:224
    ds_read_b64_tr_b16 v[236:237], v3 offset:256
    ds_read_b64_tr_b16 v[108:109], v3 offset:288
    s_add_u32 m0, s44, 20480
    s_add_u32 s37, s43, 225280
    buffer_load_dwordx4 v4, s[24:27], s37 offen offset:0 lds
    buffer_load_dwordx4 v4, s[24:27], s37 offen offset:1024 lds
    buffer_load_dwordx4 v4, s[24:27], s37 offen offset:2048 lds
    buffer_load_dwordx4 v4, s[24:27], s37 offen offset:3072 lds
    s_add_u32 m0, m0, 4096
    s_add_u32 s37, s37, 4096
    buffer_load_dwordx4 v4, s[24:27], s37 offen lds
    s_waitcnt lgkmcnt(0)
    s_waitcnt vmcnt(15)
    s_barrier
    v_add_u32 v3, 65536, v12
    ds_read_b64_tr_b16 v[56:57], v3 offset:0
    ds_read_b64_tr_b16 v[58:59], v3 offset:1536
    ds_read_b64_tr_b16 a[184:185], v3 offset:12288
    ds_read_b64_tr_b16 a[186:187], v3 offset:13824
    ds_read_b64_tr_b16 a[176:177], v3 offset:32
    ds_read_b64_tr_b16 a[178:179], v3 offset:1568
    ds_read_b64_tr_b16 a[188:189], v3 offset:12320
    ds_read_b64_tr_b16 a[190:191], v3 offset:13856
    ds_read_b64_tr_b16 a[180:181], v3 offset:64
    ds_read_b64_tr_b16 a[182:183], v3 offset:1600
    ds_read_b64_tr_b16 v[60:61], v3 offset:12352
    ds_read_b64_tr_b16 v[62:63], v3 offset:13888
    s_waitcnt lgkmcnt(0)
    s_waitcnt vmcnt(10)
    s_barrier
    v_add_u32 v3, 90112, v13
    ds_read_b64_tr_b16 a[204:205], v3 offset:0
    ds_read_b64_tr_b16 v[68:69], v3 offset:32
    ds_read_b64_tr_b16 a[240:241], v3 offset:64
    ds_read_b64_tr_b16 v[132:133], v3 offset:96
    ds_read_b64_tr_b16 v[152:153], v3 offset:128
    ds_read_b64_tr_b16 v[172:173], v3 offset:160
    ds_read_b64_tr_b16 v[92:93], v3 offset:192
    ds_read_b64_tr_b16 v[208:209], v3 offset:224
    ds_read_b64_tr_b16 v[228:229], v3 offset:256
    ds_read_b64_tr_b16 v[248:249], v3 offset:288
    s_waitcnt lgkmcnt(0)
    s_waitcnt vmcnt(5)
    s_barrier
    v_add_u32 v3, 0, v13
    ds_read_b64_tr_b16 a[206:207], v3 offset:0
    ds_read_b64_tr_b16 v[70:71], v3 offset:32
    ds_read_b64_tr_b16 a[242:243], v3 offset:64
    ds_read_b64_tr_b16 v[134:135], v3 offset:96
    ds_read_b64_tr_b16 v[154:155], v3 offset:128
    ds_read_b64_tr_b16 v[174:175], v3 offset:160
    ds_read_b64_tr_b16 v[94:95], v3 offset:192
    ds_read_b64_tr_b16 v[210:211], v3 offset:224
    ds_read_b64_tr_b16 v[230:231], v3 offset:256
    ds_read_b64_tr_b16 v[250:251], v3 offset:288
    s_waitcnt lgkmcnt(0)
    s_waitcnt vmcnt(0)
    s_barrier
    v_add_u32 v3, 20480, v13
    ds_read_b64_tr_b16 a[210:211], v3 offset:0
    ds_read_b64_tr_b16 a[230:231], v3 offset:32
    ds_read_b64_tr_b16 a[250:251], v3 offset:64
    ds_read_b64_tr_b16 v[142:143], v3 offset:96
    ds_read_b64_tr_b16 v[86:87], v3 offset:128
    ds_read_b64_tr_b16 v[178:179], v3 offset:160
    ds_read_b64_tr_b16 v[198:199], v3 offset:192
    ds_read_b64_tr_b16 v[218:219], v3 offset:224
    ds_read_b64_tr_b16 v[238:239], v3 offset:256
    ds_read_b64_tr_b16 v[110:111], v3 offset:288
    s_waitcnt lgkmcnt(0)
    s_barrier
    s_mul_i32 s32, s12, 24576
    v_add_u32 v5, s32, v4
    ds_write_b128 v5, v[16:19] offset:0
    ds_write_b128 v5, v[20:23] offset:1024
    ds_write_b128 v5, v[24:27] offset:2048
    ds_write_b128 v5, v[28:31] offset:3072
    ds_write_b128 v5, v[32:35] offset:4096
    ds_write_b128 v5, v[36:39] offset:5120
    ds_write_b128 v5, v[40:43] offset:6144
    ds_write_b128 v5, v[44:47] offset:7168
    s_waitcnt lgkmcnt(0)
    ds_write_b128 v5, v[48:51] offset:8192
    ds_write_b128 v5, v[52:55] offset:9216
    ds_write_b128 v5, v[56:59] offset:10240
    ds_write_b128 v5, v[60:63] offset:11264
    ds_write_b128 v5, v[64:67] offset:12288
    ds_write_b128 v5, v[68:71] offset:13312
    ds_write_b128 v5, v[72:75] offset:14336
    ds_write_b128 v5, v[76:79] offset:15360
    s_waitcnt lgkmcnt(0)
    ds_write_b128 v5, v[80:83] offset:16384
    ds_write_b128 v5, v[84:87] offset:17408
    ds_write_b128 v5, v[88:91] offset:18432
    ds_write_b128 v5, v[92:95] offset:19456
    ds_write_b128 v5, v[96:99] offset:20480
    ds_write_b128 v5, v[100:103] offset:21504
    ds_write_b128 v5, v[104:107] offset:22528
    ds_write_b128 v5, v[108:111] offset:23552
    s_waitcnt lgkmcnt(0)
    v_mov_b32 v3, 128
    s_mov_b32 s39, 0
dw_154:
    buffer_load_dword v2, v3, s[8:11], 0 offen sc1
    s_waitcnt vmcnt(0)
    v_readfirstlane_b32 s32, v2
    s_cmp_ge_u32 s32, 40
    s_cbranch_scc1 dwo_155
    s_sleep 4
    s_add_u32 s39, s39, 1
    s_cmp_lt_u32 s39, 20000
    s_cbranch_scc1 dw_154
    s_branch L_end3
dwo_155:
    s_lshl_b32 s32, s40, 5
    s_add_u32 s32, s32, s14
    s_lshl_b32 s32, s32, 7
    s_add_u32 s32, s32, 2170880
    v_mov_b32 v6, s32
    s_mul_i32 s32, s12, 3072
    s_add_u32 s32, s32, 98304
    v_add_u32 v7, s32, v4
    v_add_u32 v8, 98304, v4
    s_lshl_b32 s47, s14, 10
    s_mul_i32 s32, s12, 327680
    s_add_u32 s47, s47, s32
    s_add_u32 s47, s47, 79691776
vu_loop_156:
    s_waitcnt vmcnt(6)
    s_barrier
    ds_read_b128 v[40:43], v122 offset:0
    ds_read_b128 v[44:47], v122 offset:20480
    ds_read_b128 v[48:51], v123 offset:0
    ds_read_b128 v[52:55], v123 offset:20480
    ds_read_b128 v[56:59], v124 offset:0
    ds_read_b128 v[60:63], v124 offset:20480
    ds_read_b128 v[72:75], v5 offset:0
    ds_read_b128 v[76:79], v5 offset:1024
    ds_read_b128 v[80:83], v5 offset:2048
    ds_read_b128 v[64:67], v125 offset:0
    ds_read_b128 v[68:71], v125 offset:20480
    s_waitcnt lgkmcnt(9)
    v_mfma_f32_16x16x32_bf16 v[16:19], a[0:3], v[40:43], 0
    v_mfma_f32_16x16x32_bf16 v[20:23], a[0:3], v[44:47], 0
    v_mfma_f32_16x16x32_bf16 v[24:27], a[4:7], v[40:43], 0
    v_mfma_f32_16x16x32_bf16 v[28:31], a[4:7], v[44:47], 0
    v_mfma_f32_16x16x32_bf16 v[32:35], a[8:11], v[40:43], 0
    v_mfma_f32_16x16x32_bf16 v[36:39], a[8:11], v[44:47], 0
    ds_read_b128 v[40:43], v122 offset:256
    ds_read_b128 v[44:47], v122 offset:20736
    s_waitcnt lgkmcnt(9)
    v_mfma_f32_16x16x32_bf16 v[16:19], a[12:15], v[48:51], v[16:19]
    v_mfma_f32_16x16x32_bf16 v[20:23], a[12:15], v[52:55], v[20:23]
    s_waitcnt lgkmcnt(6)
    v_mfma_f32_16x16x32_bf16 v[24:27], v[72:75], v[48:51], v[24:27]
    v_mfma_f32_16x16x32_bf16 v[28:31], v[72:75], v[52:55], v[28:31]
    ds_read_b128 v[84:87], v5 offset:3072
    v_mfma_f32_16x16x32_bf16 v[32:35], a[16:19], v[48:51], v[32:35]
    v_mfma_f32_16x16x32_bf16 v[36:39], a[16:19], v[52:55], v[36:39]
    ds_read_b128 v[48:51], v123 offset:256
    ds_read_b128 v[52:55], v123 offset:20736
    v_mfma_f32_16x16x32_bf16 v[16:19], a[20:23], v[56:59], v[16:19]
    v_mfma_f32_16x16x32_bf16 v[20:23], a[20:23], v[60:63], v[20:23]
    v_mfma_f32_16x16x32_bf16 v[24:27], a[24:27], v[56:59], v[24:27]
    v_mfma_f32_16x16x32_bf16 v[28:31], a[24:27], v[60:63], v[28:31]
    v_mfma_f32_16x16x32_bf16 v[32:35], a[28:31], v[56:59], v[32:35]
    v_mfma_f32_16x16x32_bf16 v[36:39], a[28:31], v[60:63], v[36:39]
    ds_read_b128 v[56:59], v124 offset:256
    ds_read_b128 v[60:63], v124 offset:20736
    s_waitcnt lgkmcnt(7)
    v_mfma_f32_16x16x32_bf16 v[16:19], v[76:79], v[64:67], v[16:19]
    v_mfma_f32_16x16x32_bf16 v[20:23], v[76:79], v[68:71], v[20:23]
    ds_read_b128 v[72:75], v5 offset:4096
    v_mfma_f32_16x16x32_bf16 v[24:27], a[32:35], v[64:67], v[24:27]
    v_mfma_f32_16x16x32_bf16 v[28:31], a[32:35], v[68:71], v[28:31]
    v_mfma_f32_16x16x32_bf16 v[32:35], a[36:39], v[64:67], v[32:35]
    v_mfma_f32_16x16x32_bf16 v[36:39], a[36:39], v[68:71], v[36:39]
    ds_read_b128 v[64:67], v125 offset:256
    ds_read_b128 v[68:71], v125 offset:20736
    s_waitcnt lgkmcnt(8)
    v_mfma_f32_16x16x32_bf16 v[16:19], a[40:43], v[40:43], v[16:19]
    v_mfma_f32_16x16x32_bf16 v[20:23], a[40:43], v[44:47], v[20:23]
    v_mfma_f32_16x16x32_bf16 v[24:27], a[44:47], v[40:43], v[24:27]
    v_mfma_f32_16x16x32_bf16 v[28:31], a[44:47], v[44:47], v[28:31]
    v_mfma_f32_16x16x32_bf16 v[32:35], v[80:83], v[40:43], v[32:35]
    v_mfma_f32_16x16x32_bf16 v[36:39], v[80:83], v[44:47], v[36:39]
    ds_read_b128 v[76:79], v5 offset:5120
    ds_read_b128 v[40:43], v122 offset:512
    ds_read_b128 v[44:47], v122 offset:20992
    s_waitcnt lgkmcnt(8)
    v_mfma_f32_16x16x32_bf16 v[16:19], a[48:51], v[48:51], v[16:19]
    v_mfma_f32_16x16x32_bf16 v[20:23], a[48:51], v[52:55], v[20:23]
    v_mfma_f32_16x16x32_bf16 v[24:27], a[52:55], v[48:51], v[24:27]
    v_mfma_f32_16x16x32_bf16 v[28:31], a[52:55], v[52:55], v[28:31]
    v_mfma_f32_16x16x32_bf16 v[32:35], a[56:59], v[48:51], v[32:35]
    v_mfma_f32_16x16x32_bf16 v[36:39], a[56:59], v[52:55], v[36:39]
    ds_read_b128 v[48:51], v123 offset:512
    ds_read_b128 v[52:55], v123 offset:20992
    s_waitcnt lgkmcnt(8)
    v_mfma_f32_16x16x32_bf16 v[16:19], a[60:63], v[56:59], v[16:19]
    v_mfma_f32_16x16x32_bf16 v[20:23], a[60:63], v[60:63], v[20:23]
    v_mfma_f32_16x16x32_bf16 v[24:27], v[84:87], v[56:59], v[24:27]
    v_mfma_f32_16x16x32_bf16 v[28:31], v[84:87], v[60:63], v[28:31]
    ds_read_b128 v[80:83], v5 offset:6144
    v_mfma_f32_16x16x32_bf16 v[32:35], a[64:67], v[56:59], v[32:35]
    v_mfma_f32_16x16x32_bf16 v[36:39], a[64:67], v[60:63], v[36:39]
    ds_read_b128 v[56:59], v124 offset:512
    ds_read_b128 v[60:63], v124 offset:20992
    s_waitcnt lgkmcnt(8)
    v_mfma_f32_16x16x32_bf16 v[16:19], a[68:71], v[64:67], v[16:19]
    v_mfma_f32_16x16x32_bf16 v[20:23], a[68:71], v[68:71], v[20:23]
    v_mfma_f32_16x16x32_bf16 v[24:27], a[72:75], v[64:67], v[24:27]
    v_mfma_f32_16x16x32_bf16 v[28:31], a[72:75], v[68:71], v[28:31]
    v_mfma_f32_16x16x32_bf16 v[32:35], a[76:79], v[64:67], v[32:35]
    v_mfma_f32_16x16x32_bf16 v[36:39], a[76:79], v[68:71], v[36:39]
    ds_read_b128 v[64:67], v125 offset:512
    ds_read_b128 v[68:71], v125 offset:20992
    s_waitcnt lgkmcnt(7)
    v_mfma_f32_16x16x32_bf16 v[16:19], v[72:75], v[40:43], v[16:19]
    v_mfma_f32_16x16x32_bf16 v[20:23], v[72:75], v[44:47], v[20:23]
    ds_read_b128 v[84:87], v5 offset:7168
    v_mfma_f32_16x16x32_bf16 v[24:27], a[80:83], v[40:43], v[24:27]
    v_mfma_f32_16x16x32_bf16 v[28:31], a[80:83], v[44:47], v[28:31]
    v_mfma_f32_16x16x32_bf16 v[32:35], a[84:87], v[40:43], v[32:35]
    v_mfma_f32_16x16x32_bf16 v[36:39], a[84:87], v[44:47], v[36:39]
    ds_read_b128 v[40:43], v122 offset:768
    ds_read_b128 v[44:47], v122 offset:21248
    s_waitcnt lgkmcnt(8)
    v_mfma_f32_16x16x32_bf16 v[16:19], a[88:91], v[48:51], v[16:19]
    v_mfma_f32_16x16x32_bf16 v[20:23], a[88:91], v[52:55], v[20:23]
    v_mfma_f32_16x16x32_bf16 v[24:27], a[92:95], v[48:51], v[24:27]
    v_mfma_f32_16x16x32_bf16 v[28:31], a[92:95], v[52:55], v[28:31]
    v_mfma_f32_16x16x32_bf16 v[32:35], v[76:79], v[48:51], v[32:35]
    v_mfma_f32_16x16x32_bf16 v[36:39], v[76:79], v[52:55], v[36:39]
    ds_read_b128 v[72:75], v5 offset:8192
    ds_read_b128 v[48:51], v123 offset:768
    ds_read_b128 v[52:55], v123 offset:21248
    s_waitcnt lgkmcnt(8)
    v_mfma_f32_16x16x32_bf16 v[16:19], a[96:99], v[56:59], v[16:19]
    v_mfma_f32_16x16x32_bf16 v[20:23], a[96:99], v[60:63], v[20:23]
    v_mfma_f32_16x16x32_bf16 v[24:27], a[100:103], v[56:59], v[24:27]
    v_mfma_f32_16x16x32_bf16 v[28:31], a[100:103], v[60:63], v[28:31]
    v_mfma_f32_16x16x32_bf16 v[32:35], a[104:107], v[56:59], v[32:35]
    v_mfma_f32_16x16x32_bf16 v[36:39], a[104:107], v[60:63], v[36:39]
    ds_read_b128 v[56:59], v124 offset:768
    ds_read_b128 v[60:63], v124 offset:21248
    s_waitcnt lgkmcnt(8)
    v_mfma_f32_16x16x32_bf16 v[16:19], a[108:111], v[64:67], v[16:19]
    v_mfma_f32_16x16x32_bf16 v[20:23], a[108:111], v[68:71], v[20:23]
    v_mfma_f32_16x16x32_bf16 v[24:27], v[80:83], v[64:67], v[24:27]
    v_mfma_f32_16x16x32_bf16 v[28:31], v[80:83], v[68:71], v[28:31]
    ds_read_b128 v[76:79], v5 offset:9216
    v_mfma_f32_16x16x32_bf16 v[32:35], a[112:115], v[64:67], v[32:35]
    v_mfma_f32_16x16x32_bf16 v[36:39], a[112:115], v[68:71], v[36:39]
    ds_read_b128 v[64:67], v125 offset:768
    ds_read_b128 v[68:71], v125 offset:21248
    s_waitcnt lgkmcnt(8)
    v_mfma_f32_16x16x32_bf16 v[16:19], a[116:119], v[40:43], v[16:19]
    v_mfma_f32_16x16x32_bf16 v[20:23], a[116:119], v[44:47], v[20:23]
    v_mfma_f32_16x16x32_bf16 v[24:27], a[120:123], v[40:43], v[24:27]
    v_mfma_f32_16x16x32_bf16 v[28:31], a[120:123], v[44:47], v[28:31]
    v_mfma_f32_16x16x32_bf16 v[32:35], a[124:127], v[40:43], v[32:35]
    v_mfma_f32_16x16x32_bf16 v[36:39], a[124:127], v[44:47], v[36:39]
    ds_read_b128 v[40:43], v122 offset:1024
    ds_read_b128 v[44:47], v122 offset:21504
    s_waitcnt lgkmcnt(7)
    v_mfma_f32_16x16x32_bf16 v[16:19], v[84:87], v[48:51], v[16:19]
    v_mfma_f32_16x16x32_bf16 v[20:23], v[84:87], v[52:55], v[20:23]
    ds_read_b128 v[80:83], v5 offset:10240
    v_mfma_f32_16x16x32_bf16 v[24:27], a[128:131], v[48:51], v[24:27]
    v_mfma_f32_16x16x32_bf16 v[28:31], a[128:131], v[52:55], v[28:31]
    v_mfma_f32_16x16x32_bf16 v[32:35], a[132:135], v[48:51], v[32:35]
    v_mfma_f32_16x16x32_bf16 v[36:39], a[132:135], v[52:55], v[36:39]
    ds_read_b128 v[48:51], v123 offset:1024
    ds_read_b128 v[52:55], v123 offset:21504
    s_waitcnt lgkmcnt(8)
    v_mfma_f32_16x16x32_bf16 v[16:19], a[136:139], v[56:59], v[16:19]
    v_mfma_f32_16x16x32_bf16 v[20:23], a[136:139], v[60:63], v[20:23]
    v_mfma_f32_16x16x32_bf16 v[24:27], a[140:143], v[56:59], v[24:27]
    v_mfma_f32_16x16x32_bf16 v[28:31], a[140:143], v[60:63], v[28:31]
    v_mfma_f32_16x16x32_bf16 v[32:35], v[72:75], v[56:59], v[32:35]
    v_mfma_f32_16x16x32_bf16 v[36:39], v[72:75], v[60:63], v[36:39]
    ds_read_b128 v[84:87], v5 offset:11264
    ds_read_b128 v[56:59], v124 offset:1024
    ds_read_b128 v[60:63], v124 offset:21504
    s_waitcnt lgkmcnt(8)
    v_mfma_f32_16x16x32_bf16 v[16:19], a[144:147], v[64:67], v[16:19]
    v_mfma_f32_16x16x32_bf16 v[20:23], a[144:147], v[68:71], v[20:23]
    v_mfma_f32_16x16x32_bf16 v[24:27], a[148:151], v[64:67], v[24:27]
    v_mfma_f32_16x16x32_bf16 v[28:31], a[148:151], v[68:71], v[28:31]
    v_mfma_f32_16x16x32_bf16 v[32:35], a[152:155], v[64:67], v[32:35]
    v_mfma_f32_16x16x32_bf16 v[36:39], a[152:155], v[68:71], v[36:39]
    ds_read_b128 v[64:67], v125 offset:1024
    ds_read_b128 v[68:71], v125 offset:21504
    s_waitcnt lgkmcnt(8)
    v_mfma_f32_16x16x32_bf16 v[16:19], a[156:159], v[40:43], v[16:19]
    v_mfma_f32_16x16x32_bf16 v[20:23], a[156:159], v[44:47], v[20:23]
    v_mfma_f32_16x16x32_bf16 v[24:27], v[76:79], v[40:43], v[24:27]
    v_mfma_f32_16x16x32_bf16 v[28:31], v[76:79], v[44:47], v[28:31]
    ds_read_b128 v[72:75], v5 offset:12288
    v_mfma_f32_16x16x32_bf16 v[32:35], a[160:163], v[40:43], v[32:35]
    v_mfma_f32_16x16x32_bf16 v[36:39], a[160:163], v[44:47], v[36:39]
    s_waitcnt lgkmcnt(6)
    v_mfma_f32_16x16x32_bf16 v[16:19], a[164:167], v[48:51], v[16:19]
    v_mfma_f32_16x16x32_bf16 v[20:23], a[164:167], v[52:55], v[20:23]
    v_mfma_f32_16x16x32_bf16 v[24:27], a[168:171], v[48:51], v[24:27]
    v_mfma_f32_16x16x32_bf16 v[28:31], a[168:171], v[52:55], v[28:31]
    v_mfma_f32_16x16x32_bf16 v[32:35], a[172:175], v[48:51], v[32:35]
    v_mfma_f32_16x16x32_bf16 v[36:39], a[172:175], v[52:55], v[36:39]
    s_waitcnt lgkmcnt(3)
    v_mfma_f32_16x16x32_bf16 v[16:19], v[80:83], v[56:59], v[16:19]
    v_mfma_f32_16x16x32_bf16 v[20:23], v[80:83], v[60:63], v[20:23]
    ds_read_b128 v[76:79], v5 offset:13312
    v_mfma_f32_16x16x32_bf16 v[24:27], a[176:179], v[56:59], v[24:27]
    v_mfma_f32_16x16x32_bf16 v[28:31], a[176:179], v[60:63], v[28:31]
    v_mfma_f32_16x16x32_bf16 v[32:35], a[180:183], v[56:59], v[32:35]
    v_mfma_f32_16x16x32_bf16 v[36:39], a[180:183], v[60:63], v[36:39]
    s_waitcnt lgkmcnt(2)
    v_mfma_f32_16x16x32_bf16 v[16:19], a[184:187], v[64:67], v[16:19]
    v_mfma_f32_16x16x32_bf16 v[20:23], a[184:187], v[68:71], v[20:23]
    v_mfma_f32_16x16x32_bf16 v[24:27], a[188:191], v[64:67], v[24:27]
    v_mfma_f32_16x16x32_bf16 v[28:31], a[188:191], v[68:71], v[28:31]
    v_mfma_f32_16x16x32_bf16 v[32:35], v[84:87], v[64:67], v[32:35]
    v_mfma_f32_16x16x32_bf16 v[36:39], v[84:87], v[68:71], v[36:39]
    ds_read_b128 v[80:83], v5 offset:14336
    s_nop 1
    v_cvt_pk_bf16_f32 v40, v16, v17
    v_cvt_pk_bf16_f32 v41, v18, v19
    v_cvt_pk_bf16_f32 v42, v24, v25
    v_cvt_pk_bf16_f32 v43, v26, v27
    v_cvt_pk_bf16_f32 v48, v32, v33
    v_cvt_pk_bf16_f32 v49, v34, v35
    v_cvt_pk_bf16_f32 v44, v20, v21
    v_cvt_pk_bf16_f32 v45, v22, v23
    v_cvt_pk_bf16_f32 v46, v28, v29
    v_cvt_pk_bf16_f32 v47, v30, v31
    v_cvt_pk_bf16_f32 v50, v36, v37
    v_cvt_pk_bf16_f32 v51, v38, v39
    ds_write_b128 v7, v[40:43] offset:0
    ds_write_b128 v7, v[44:47] offset:1024
    ds_write_b128 v7, v[48:51] offset:2048
    s_add_u32 s34, s36, 2
    s_min_u32 s34, s34, 63
    s_mul_i32 s45, s34, 40960
    s_mul_i32 s35, s36, 1310720
    s_add_u32 s35, s35, s47
    s_waitcnt vmcnt(0)
    s_waitcnt lgkmcnt(0)
    s_barrier
    ds_read_b128 v[16:19], v8 offset:0
    ds_read_b128 v[40:43], v8 offset:1024
    ds_read_b128 v[20:23], v8 offset:3072
    ds_read_b128 v[44:47], v8 offset:4096
    ds_read_b128 v[24:27], v8 offset:6144
    ds_read_b128 v[48:51], v8 offset:7168
    ds_read_b128 v[28:31], v8 offset:9216
    ds_read_b128 v[52:55], v8 offset:10240
    s_cmp_lg_u32 s12, 0
    s_cbranch_scc1 nofl_157
    v_mov_b32 v2, s36
    s_mov_b64 exec, 1
    buffer_store_dword v2, v6, s[4:7], 0 offen sc1
    s_mov_b64 exec, -1
nofl_157:
    ds_read_b64 v[32:33], v8 offset:2048
    ds_read_b64 v[34:35], v8 offset:5120
    ds_read_b64 v[56:57], v8 offset:2056
    ds_read_b64 v[58:59], v8 offset:5128
    ds_read_b64 v[36:37], v8 offset:8192
    ds_read_b64 v[38:39], v8 offset:11264
    ds_read_b64 v[60:61], v8 offset:8200
    ds_read_b64 v[62:63], v8 offset:11272
    s_waitcnt lgkmcnt(14)
    v_mfma_f32_16x16x32_bf16 v[96:99], v[16:19], a[192:195], 0
    v_mfma_f32_16x16x32_bf16 v[100:103], v[40:43], a[192:195], 0
    s_add_u32 m0, s46, 0
    s_nop 0
    buffer_load_dwordx4 v112, s[20:23], s45 offen lds
    s_waitcnt lgkmcnt(12)
    v_mfma_f32_16x16x32_bf16 v[96:99], v[20:23], a[196:199], v[96:99]
    v_mfma_f32_16x16x32_bf16 v[100:103], v[44:47], a[196:199], v[100:103]
    s_waitcnt lgkmcnt(10)
    v_mfma_f32_16x16x32_bf16 v[96:99], v[24:27], a[200:203], v[96:99]
    v_mfma_f32_16x16x32_bf16 v[100:103], v[48:51], a[200:203], v[100:103]
    s_add_u32 m0, s46, 1024
    s_nop 0
    buffer_load_dwordx4 v113, s[20:23], s45 offen lds
    s_waitcnt lgkmcnt(8)
    v_mfma_f32_16x16x32_bf16 v[96:99], v[28:31], a[204:207], v[96:99]
    v_mfma_f32_16x16x32_bf16 v[100:103], v[52:55], a[204:207], v[100:103]
    s_waitcnt lgkmcnt(4)
    v_mfma_f32_16x16x32_bf16 v[96:99], v[32:35], v[72:75], v[96:99]
    v_mfma_f32_16x16x32_bf16 v[100:103], v[56:59], v[72:75], v[100:103]
    ds_read_b128 v[84:87], v5 offset:15360
    s_waitcnt lgkmcnt(1)
    v_mfma_f32_16x16x32_bf16 v[96:99], v[36:39], a[208:211], v[96:99]
    v_mfma_f32_16x16x32_bf16 v[100:103], v[60:63], a[208:211], v[100:103]
    v_mfma_f32_16x16x32_bf16 v[104:107], v[16:19], a[212:215], 0
    v_mfma_f32_16x16x32_bf16 v[108:111], v[40:43], a[212:215], 0
    s_add_u32 m0, s46, 2048
    s_nop 0
    buffer_load_dwordx4 v114, s[20:23], s45 offen lds
    v_mfma_f32_16x16x32_bf16 v[104:107], v[20:23], a[216:219], v[104:107]
    v_mfma_f32_16x16x32_bf16 v[108:111], v[44:47], a[216:219], v[108:111]
    v_mfma_f32_16x16x32_bf16 v[104:107], v[24:27], a[220:223], v[104:107]
    v_mfma_f32_16x16x32_bf16 v[108:111], v[48:51], a[220:223], v[108:111]
    s_add_u32 m0, s46, 3072
    s_nop 0
    buffer_load_dwordx4 v115, s[20:23], s45 offen lds
    v_mfma_f32_16x16x32_bf16 v[104:107], v[28:31], v[76:79], v[104:107]
    v_mfma_f32_16x16x32_bf16 v[108:111], v[52:55], v[76:79], v[108:111]
    ds_read_b128 v[72:75], v5 offset:16384
    v_mfma_f32_16x16x32_bf16 v[104:107], v[32:35], a[224:227], v[104:107]
    v_mfma_f32_16x16x32_bf16 v[108:111], v[56:59], a[224:227], v[108:111]
    v_cvt_pk_bf16_f32 v88, v96, v97
    v_cvt_pk_bf16_f32 v89, v100, v101
    v_cvt_pk_bf16_f32 v90, v98, v99
    v_cvt_pk_bf16_f32 v91, v102, v103
    buffer_store_dwordx4 v[88:91], v4, s[4:7], s35 offen sc1
    s_add_u32 s35, s35, 32768
    v_mfma_f32_16x16x32_bf16 v[104:107], v[36:39], a[228:231], v[104:107]
    v_mfma_f32_16x16x32_bf16 v[108:111], v[60:63], a[228:231], v[108:111]
    v_mfma_f32_16x16x32_bf16 v[96:99], v[16:19], a[232:235], 0
    v_mfma_f32_16x16x32_bf16 v[100:103], v[40:43], a[232:235], 0
    s_add_u32 m0, s46, 4096
    s_nop 0
    buffer_load_dwordx4 v116, s[20:23], s45 offen lds
    v_mfma_f32_16x16x32_bf16 v[96:99], v[20:23], a[236:239], v[96:99]
    v_mfma_f32_16x16x32_bf16 v[100:103], v[44:47], a[236:239], v[100:103]
    v_mfma_f32_16x16x32_bf16 v[96:99], v[24:27], v[80:83], v[96:99]
    v_mfma_f32_16x16x32_bf16 v[100:103], v[48:51], v[80:83], v[100:103]
    ds_read_b128 v[76:79], v5 offset:17408
    s_add_u32 m0, s46, 5120
    s_nop 0
    buffer_load_dwordx4 v117, s[20:23], s45 offen lds
    v_mfma_f32_16x16x32_bf16 v[96:99], v[28:31], a[240:243], v[96:99]
    v_mfma_f32_16x16x32_bf16 v[100:103], v[52:55], a[240:243], v[100:103]
    v_mfma_f32_16x16x32_bf16 v[96:99], v[32:35], a[244:247], v[96:99]
    v_mfma_f32_16x16x32_bf16 v[100:103], v[56:59], a[244:247], v[100:103]
    v_cvt_pk_bf16_f32 v92, v104, v105
    v_cvt_pk_bf16_f32 v93, v108, v109
    v_cvt_pk_bf16_f32 v94, v106, v107
    v_cvt_pk_bf16_f32 v95, v110, v111
    buffer_store_dwordx4 v[92:95], v4, s[4:7], s35 offen sc1
    s_add_u32 s35, s35, 32768
    v_mfma_f32_16x16x32_bf16 v[96:99], v[36:39], a[248:251], v[96:99]
    v_mfma_f32_16x16x32_bf16 v[100:103], v[60:63], a[248:251], v[100:103]
    v_mfma_f32_16x16x32_bf16 v[104:107], v[16:19], a[252:255], 0
    v_mfma_f32_16x16x32_bf16 v[108:111], v[40:43], a[252:255], 0
    s_add_u32 m0, s46, 6144
    s_nop 0
    buffer_load_dwordx4 v118, s[20:23], s45 offen lds
    s_waitcnt lgkmcnt(2)
    v_mfma_f32_16x16x32_bf16 v[104:107], v[20:23], v[84:87], v[104:107]
    v_mfma_f32_16x16x32_bf16 v[108:111], v[44:47], v[84:87], v[108:111]
    ds_read_b128 v[80:83], v5 offset:18432
    v_mfma_f32_16x16x32_bf16 v[104:107], v[24:27], v[128:131], v[104:107]
    v_mfma_f32_16x16x32_bf16 v[108:111], v[48:51], v[128:131], v[108:111]
    s_add_u32 m0, s46, 7168
    s_nop 0
    buffer_load_dwordx4 v119, s[20:23], s45 offen lds
    v_mfma_f32_16x16x32_bf16 v[104:107], v[28:31], v[132:135], v[104:107]
    v_mfma_f32_16x16x32_bf16 v[108:111], v[52:55], v[132:135], v[108:111]
    v_mfma_f32_16x16x32_bf16 v[104:107], v[32:35], v[136:139], v[104:107]
    v_mfma_f32_16x16x32_bf16 v[108:111], v[56:59], v[136:139], v[108:111]
    v_cvt_pk_bf16_f32 v88, v96, v97
    v_cvt_pk_bf16_f32 v89, v100, v101
    v_cvt_pk_bf16_f32 v90, v98, v99
    v_cvt_pk_bf16_f32 v91, v102, v103
    buffer_store_dwordx4 v[88:91], v4, s[4:7], s35 offen sc1
    s_add_u32 s35, s35, 32768
    v_mfma_f32_16x16x32_bf16 v[104:107], v[36:39], v[140:143], v[104:107]
    v_mfma_f32_16x16x32_bf16 v[108:111], v[60:63], v[140:143], v[108:111]
    s_waitcnt lgkmcnt(2)
    v_mfma_f32_16x16x32_bf16 v[96:99], v[16:19], v[72:75], 0
    v_mfma_f32_16x16x32_bf16 v[100:103], v[40:43], v[72:75], 0
    ds_read_b128 v[84:87], v5 offset:19456
    s_add_u32 m0, s46, 8192
    s_nop 0
    buffer_load_dwordx4 v120, s[20:23], s45 offen lds
    v_mfma_f32_16x16x32_bf16 v[96:99], v[20:23], v[144:147], v[96:99]
    v_mfma_f32_16x16x32_bf16 v[100:103], v[44:47], v[144:147], v[100:103]
    v_mfma_f32_16x16x32_bf16 v[96:99], v[24:27], v[148:151], v[96:99]
    v_mfma_f32_16x16x32_bf16 v[100:103], v[48:51], v[148:151], v[100:103]
    s_add_u32 m0, s46, 9216
    s_nop 0
    buffer_load_dwordx4 v121, s[20:23], s45 offen lds
    v_mfma_f32_16x16x32_bf16 v[96:99], v[28:31], v[152:155], v[96:99]
    v_mfma_f32_16x16x32_bf16 v[100:103], v[52:55], v[152:155], v[100:103]
    v_mfma_f32_16x16x32_bf16 v[96:99], v[32:35], v[156:159], v[96:99]
    v_mfma_f32_16x16x32_bf16 v[100:103], v[56:59], v[156:159], v[100:103]
    v_cvt_pk_bf16_f32 v92, v104, v105
    v_cvt_pk_bf16_f32 v93, v108, v109
    v_cvt_pk_bf16_f32 v94, v106, v107
    v_cvt_pk_bf16_f32 v95, v110, v111
    buffer_store_dwordx4 v[92:95], v4, s[4:7], s35 offen sc1
    s_add_u32 s35, s35, 32768
    s_waitcnt lgkmcnt(2)
    v_mfma_f32_16x16x32_bf16 v[96:99], v[36:39], v[76:79], v[96:99]
    v_mfma_f32_16x16x32_bf16 v[100:103], v[60:63], v[76:79], v[100:103]
    ds_read_b128 v[72:75], v5 offset:20480
    v_mfma_f32_16x16x32_bf16 v[104:107], v[16:19], v[160:163], 0
    v_mfma_f32_16x16x32_bf16 v[108:111], v[40:43], v[160:163], 0
    v_mfma_f32_16x16x32_bf16 v[104:107], v[20:23], v[164:167], v[104:107]
    v_mfma_f32_16x16x32_bf16 v[108:111], v[44:47], v[164:167], v[108:111]
    v_mfma_f32_16x16x32_bf16 v[104:107], v[24:27], v[168:171], v[104:107]
    v_mfma_f32_16x16x32_bf16 v[108:111], v[48:51], v[168:171], v[108:111]
    v_mfma_f32_16x16x32_bf16 v[104:107], v[28:31], v[172:175], v[104:107]
    v_mfma_f32_16x16x32_bf16 v[108:111], v[52:55], v[172:175], v[108:111]
    s_waitcnt lgkmcnt(2)
    v_mfma_f32_16x16x32_bf16 v[104:107], v[32:35], v[80:83], v[104:107]
    v_mfma_f32_16x16x32_bf16 v[108:111], v[56:59], v[80:83], v[108:111]
    ds_read_b128 v[76:79], v5 offset:21504
    v_cvt_pk_bf16_f32 v88, v96, v97
    v_cvt_pk_bf16_f32 v89, v100, v101
    v_cvt_pk_bf16_f32 v90, v98, v99
    v_cvt_pk_bf16_f32 v91, v102, v103
    buffer_store_dwordx4 v[88:91], v4, s[4:7], s35 offen sc1
    s_add_u32 s35, s35, 32768
    v_mfma_f32_16x16x32_bf16 v[104:107], v[36:39], v[176:179], v[104:107]
    v_mfma_f32_16x16x32_bf16 v[108:111], v[60:63], v[176:179], v[108:111]
    v_mfma_f32_16x16x32_bf16 v[96:99], v[16:19], v[180:183], 0
    v_mfma_f32_16x16x32_bf16 v[100:103], v[40:43], v[180:183], 0
    v_mfma_f32_16x16x32_bf16 v[96:99], v[20:23], v[184:187], v[96:99]
    v_mfma_f32_16x16x32_bf16 v[100:103], v[44:47], v[184:187], v[100:103]
    v_mfma_f32_16x16x32_bf16 v[96:99], v[24:27], v[188:191], v[96:99]
    v_mfma_f32_16x16x32_bf16 v[100:103], v[48:51], v[188:191], v[100:103]
    s_waitcnt lgkmcnt(2)
    v_mfma_f32_16x16x32_bf16 v[96:99], v[28:31], v[84:87], v[96:99]
    v_mfma_f32_16x16x32_bf16 v[100:103], v[52:55], v[84:87], v[100:103]
    ds_read_b128 v[80:83], v5 offset:22528
    v_mfma_f32_16x16x32_bf16 v[96:99], v[32:35], v[192:195], v[96:99]
    v_mfma_f32_16x16x32_bf16 v[100:103], v[56:59], v[192:195], v[100:103]
    v_cvt_pk_bf16_f32 v92, v104, v105
    v_cvt_pk_bf16_f32 v93, v108, v109
    v_cvt_pk_bf16_f32 v94, v106, v107
    v_cvt_pk_bf16_f32 v95, v110, v111
    buffer_store_dwordx4 v[92:95], v4, s[4:7], s35 offen sc1
    s_add_u32 s35, s35, 32768
    v_mfma_f32_16x16x32_bf16 v[96:99], v[36:39], v[196:199], v[96:99]
    v_mfma_f32_16x16x32_bf16 v[100:103], v[60:63], v[196:199], v[100:103]
    v_mfma_f32_16x16x32_bf16 v[104:107], v[16:19], v[200:203], 0
    v_mfma_f32_16x16x32_bf16 v[108:111], v[40:43], v[200:203], 0
    v_mfma_f32_16x16x32_bf16 v[104:107], v[20:23], v[204:207], v[104:107]
    v_mfma_f32_16x16x32_bf16 v[108:111], v[44:47], v[204:207], v[108:111]
    s_waitcnt lgkmcnt(2)
    v_mfma_f32_16x16x32_bf16 v[104:107], v[24:27], v[72:75], v[104:107]
    v_mfma_f32_16x16x32_bf16 v[108:111], v[48:51], v[72:75], v[108:111]
    ds_read_b128 v[84:87], v5 offset:23552
    v_mfma_f32_16x16x32_bf16 v[104:107], v[28:31], v[208:211], v[104:107]
    v_mfma_f32_16x16x32_bf16 v[108:111], v[52:55], v[208:211], v[108:111]
    v_mfma_f32_16x16x32_bf16 v[104:107], v[32:35], v[212:215], v[104:107]
    v_mfma_f32_16x16x32_bf16 v[108:111], v[56:59], v[212:215], v[108:111]
    v_cvt_pk_bf16_f32 v88, v96, v97
    v_cvt_pk_bf16_f32 v89, v100, v101
    v_cvt_pk_bf16_f32 v90, v98, v99
    v_cvt_pk_bf16_f32 v91, v102, v103
    buffer_store_dwordx4 v[88:91], v4, s[4:7], s35 offen sc1
    s_add_u32 s35, s35, 32768
    v_mfma_f32_16x16x32_bf16 v[104:107], v[36:39], v[216:219], v[104:107]
    v_mfma_f32_16x16x32_bf16 v[108:111], v[60:63], v[216:219], v[108:111]
    v_mfma_f32_16x16x32_bf16 v[96:99], v[16:19], v[220:223], 0
    v_mfma_f32_16x16x32_bf16 v[100:103], v[40:43], v[220:223], 0
    s_waitcnt lgkmcnt(2)
    v_mfma_f32_16x16x32_bf16 v[96:99], v[20:23], v[76:79], v[96:99]
    v_mfma_f32_16x16x32_bf16 v[100:103], v[44:47], v[76:79], v[100:103]
    v_mfma_f32_16x16x32_bf16 v[96:99], v[24:27], v[224:227], v[96:99]
    v_mfma_f32_16x16x32_bf16 v[100:103], v[48:51], v[224:227], v[100:103]
    v_mfma_f32_16x16x32_bf16 v[96:99], v[28:31], v[228:231], v[96:99]
    v_mfma_f32_16x16x32_bf16 v[100:103], v[52:55], v[228:231], v[100:103]
    v_mfma_f32_16x16x32_bf16 v[96:99], v[32:35], v[232:235], v[96:99]
    v_mfma_f32_16x16x32_bf16 v[100:103], v[56:59], v[232:235], v[100:103]
    v_cvt_pk_bf16_f32 v92, v104, v105
    v_cvt_pk_bf16_f32 v93, v108, v109
    v_cvt_pk_bf16_f32 v94, v106, v107
    v_cvt_pk_bf16_f32 v95, v110, v111
    buffer_store_dwordx4 v[92:95], v4, s[4:7], s35 offen sc1
    s_add_u32 s35, s35, 32768
    v_mfma_f32_16x16x32_bf16 v[96:99], v[36:39], v[236:239], v[96:99]
    v_mfma_f32_16x16x32_bf16 v[100:103], v[60:63], v[236:239], v[100:103]
    s_waitcnt lgkmcnt(1)
    v_mfma_f32_16x16x32_bf16 v[104:107], v[16:19], v[80:83], 0
    v_mfma_f32_16x16x32_bf16 v[108:111], v[40:43], v[80:83], 0
    v_mfma_f32_16x16x32_bf16 v[104:107], v[20:23], v[240:243], v[104:107]
    v_mfma_f32_16x16x32_bf16 v[108:111], v[44:47], v[240:243], v[108:111]
    v_mfma_f32_16x16x32_bf16 v[104:107], v[24:27], v[244:247], v[104:107]
    v_mfma_f32_16x16x32_bf16 v[108:111], v[48:51], v[244:247], v[108:111]
    v_mfma_f32_16x16x32_bf16 v[104:107], v[28:31], v[248:251], v[104:107]
    v_mfma_f32_16x16x32_bf16 v[108:111], v[52:55], v[248:251], v[108:111]
    v_mfma_f32_16x16x32_bf16 v[104:107], v[32:35], v[252:255], v[104:107]
    v_mfma_f32_16x16x32_bf16 v[108:111], v[56:59], v[252:255], v[108:111]
    v_cvt_pk_bf16_f32 v88, v96, v97
    v_cvt_pk_bf16_f32 v89, v100, v101
    v_cvt_pk_bf16_f32 v90, v98, v99
    v_cvt_pk_bf16_f32 v91, v102, v103
    buffer_store_dwordx4 v[88:91], v4, s[4:7], s35 offen sc1
    s_add_u32 s35, s35, 32768
    s_waitcnt lgkmcnt(0)
    v_mfma_f32_16x16x32_bf16 v[104:107], v[36:39], v[84:87], v[104:107]
    v_mfma_f32_16x16x32_bf16 v[108:111], v[60:63], v[84:87], v[108:111]
    s_nop 6
    v_cvt_pk_bf16_f32 v92, v104, v105
    v_cvt_pk_bf16_f32 v93, v108, v109
    v_cvt_pk_bf16_f32 v94, v106, v107
    v_cvt_pk_bf16_f32 v95, v110, v111
    buffer_store_dwordx4 v[92:95], v4, s[4:7], s35 offen sc1
    s_add_u32 s35, s35, 32768
    s_add_u32 s36, s36, 2
    s_cmp_ge_u32 s36, 4
    s_cbranch_scc1 nf_158
    s_waitcnt vmcnt(0)
    s_barrier
    s_cmp_lg_u32 s12, 0
    s_cbranch_scc1 nofl_159
    v_mov_b32 v2, s36
    s_mov_b64 exec, 1
    buffer_store_dword v2, v6, s[4:7], 0 offen sc1
    s_mov_b64 exec, -1
nofl_159:
nf_158:
    s_cmp_lt_u32 s36, 64
    s_cbranch_scc1 vu_loop_156
    s_waitcnt vmcnt(0)
    s_barrier
    s_cmp_lg_u32 s12, 0
    s_cbranch_scc1 nofl_160
    v_mov_b32 v2, s36
    s_mov_b64 exec, 1
    buffer_store_dword v2, v6, s[4:7], 0 offen sc1
    s_mov_b64 exec, -1
nofl_160:
    s_branch L_o
.section .rodata,"a"
.p2align 6
.amdhsa_kernel gated_mix__memory_aug_recurrent_mem_tr__moe_arch_mod__prompt_kernel
  .amdhsa_next_free_vgpr 512
  .amdhsa_next_free_sgpr 102
  .amdhsa_accum_offset 256
  .amdhsa_group_segment_fixed_size 0
  .amdhsa_kernarg_size 128
  .amdhsa_user_sgpr_count 2
  .amdhsa_user_sgpr_kernarg_segment_ptr 1
  .amdhsa_system_sgpr_workgroup_id_x 1
  .amdhsa_float_denorm_mode_32 3
.end_amdhsa_kernel
.text
```
